```python
import torch

def _softmax(x, axis=-1):
    return torch.softmax(x, dim=axis)

def _gelu(x):
    return torch.nn.functional.gelu(x, approximate='tanh')

def _silu(x):
    return torch.nn.functional.silu(x)

def _sigmoid(x):
    return torch.sigmoid(x)

def _layernorm(x, axis=-1, eps=1e-05):
    m = x.mean(dim=axis, keepdim=True)
    v = x.var(dim=axis, keepdim=True, unbiased=False)
    return (x - m) / torch.sqrt(v + eps)

def _scatter_add(tgt, idx, src, axis=0):
    return tgt.clone().index_add_(axis, idx, src)

def _segment_sum(src, seg, n):
    out = torch.zeros((n,) + src.shape[1:], dtype=src.dtype)
    return out.index_add_(0, seg, src)

def _pad(x, pw):
    flat = tuple((v for pair in reversed(pw) for v in pair))
    return torch.nn.functional.pad(x, flat)
kernel_name = 'adaLN_cond__ssm_conv_s4d__glu_gated_glu__prompt'

def setup_inputs():

    _w = lambda a: (lambda t: t.to(torch.bfloat16) if t.is_floating_point() else t)(torch.as_tensor(a))

    def _A_setup():
        Bsz, L, D, N = (1, 2048, 512, 128)
        return {'u': _w((lambda *s: torch.randn(*s, dtype=torch.bfloat16) * 0.05)(Bsz, L, D)), 'log_A_real': _w((lambda *s: torch.randn(*s, dtype=torch.bfloat16) * 3.2)(D, N) * 0.5), 'A_imag': _w((lambda *s: torch.randn(*s, dtype=torch.bfloat16) * 0.1)(D, N) * 3.14), 'C_real': _w((lambda *s: torch.randn(*s, dtype=torch.bfloat16) * 0.4)(D, N) / N ** 0.5), 'C_imag': _w((lambda *s: torch.randn(*s, dtype=torch.bfloat16) * 0.4)(D, N) / N ** 0.5), 'log_dt': _w((lambda *s: torch.randn(*s, dtype=torch.bfloat16) * 0.1)(D) * 0.5 - 4.0), 'D_skip': _w((lambda *s: torch.randn(*s, dtype=torch.bfloat16) * 0.1)(D))}
    _A_in = _A_setup()

    def _B_setup():
        B, S, D, F = (1, 2048, 512, 1792)
        return {'x': _w((lambda *s: torch.randn(*s, dtype=torch.bfloat16) * 0.05)(B, S, D)), 'w_gate': _w((lambda *s: torch.randn(*s, dtype=torch.bfloat16) * 0.05)(D, F)), 'w_up': _w((lambda *s: torch.randn(*s, dtype=torch.bfloat16) * 0.05)(D, F)), 'w_down': _w((lambda *s: torch.randn(*s, dtype=torch.bfloat16) * 0.05)(F, D))}
    _B_in = _B_setup()
    return {'A_u': _A_in['u'], 'A_log_A_real': _A_in['log_A_real'], 'A_A_imag': _A_in['A_imag'], 'A_C_real': _A_in['C_real'], 'A_C_imag': _A_in['C_imag'], 'A_log_dt': _A_in['log_dt'], 'A_D_skip': _A_in['D_skip'], 'B_x': _B_in['x'], 'B_w_gate': _B_in['w_gate'], 'B_w_up': _B_in['w_up'], 'B_w_down': _B_in['w_down'], 'c': _w((lambda *s: torch.randn(*s, dtype=torch.bfloat16) * 0.1)(1, 512) * 8.0), 'w_mod': _w((lambda *s: torch.randn(*s, dtype=torch.bfloat16) * 0.1)(512, 6 * 512) * 512 ** (-0.5) * 8.0)}

def reference(A_u, A_log_A_real, A_A_imag, A_C_real, A_C_imag, A_log_dt, A_D_skip, B_x, B_w_gate, B_w_up, B_w_down, c, w_mod):

    def _A_ref(u, log_A_real, A_imag, C_real, C_imag, log_dt, D_skip):
        L = u.shape[1]
        dt = torch.exp(log_dt)
        A = -torch.exp(log_A_real) + 1j * A_imag
        C = (C_real + 1j * C_imag) * dt[:, None]
        pos = (lambda x, dt: x.to(dt))(torch.arange(L), log_dt.dtype)
        P = torch.exp((A * dt[:, None])[:, :, None] * pos[None, None, :])
        K = 2.0 * torch.einsum('dn,dnl->dl', C, P).real
        L2 = 2 * L
        u_t = (lambda x, *d: x.permute(*d))(u, 0, 2, 1)
        Kf = (lambda x, *a, **k: torch.fft.rfft(x.float(), *a, **k))(K, L2)
        Uf = (lambda x, *a, **k: torch.fft.rfft(x.float(), *a, **k))(u_t, L2)
        y = (lambda x, *a, **k: torch.fft.irfft(x, *a, **k).to(torch.bfloat16))(Uf * Kf[None, :, :], L2)[:, :, :L]
        y = (lambda x, *d: x.permute(*d))(y, 0, 2, 1)
        return y + u * D_skip[None, None, :]

    def _B_ref(x, w_gate, w_up, w_down):
        g = torch.einsum('bsd,df->bsf', x, w_gate)
        u = torch.einsum('bsd,df->bsf', x, w_up)
        h = _sigmoid(g) * u
        return torch.einsum('bsf,fd->bsd', h, w_down)
    x = A_u
    mod = (_silu(c) @ w_mod).reshape(c.shape[0], 6, 1, -1)
    sa, ca, ga, sb, cb, gb = (mod[:, 0].clone(), mod[:, 1].clone(), mod[:, 2].clone(), mod[:, 3].clone(), mod[:, 4].clone(), mod[:, 5].clone())
    h = _layernorm(x, axis=-1) * (1 + ca) + sa
    x = x + ga * _A_ref(h, A_log_A_real, A_A_imag, A_C_real, A_C_imag, A_log_dt, A_D_skip)
    h = _layernorm(x, axis=-1) * (1 + cb) + sb
    x = x + gb * _B_ref(h, B_w_gate, B_w_up, B_w_down)
    return x
```

```asm
; @launch grid=(256,1,1) block=(512,1,1) lds=163840
.amdgcn_target "amdgcn-amd-amdhsa--gfx950"
.text
.globl adaLN_cond__ssm_conv_s4d__glu_gated_glu__prompt_kernel
.p2align 8
.type adaLN_cond__ssm_conv_s4d__glu_gated_glu__prompt_kernel,@function
adaLN_cond__ssm_conv_s4d__glu_gated_glu__prompt_kernel:
    s_cmp_ge_u32 s2, 256
    s_cbranch_scc1 END
    s_load_dwordx16 s[48:63], s[0:1], 0
    s_load_dwordx16 s[64:79], s[0:1], 64
    v_lshrrev_b32 v2, 6, v0
    v_and_b32 v1, 63, v0
    s_and_b32 s42, s2, 7
    v_readfirstlane_b32 s3, v2
    s_lshr_b32 s43, s2, 3
    v_lshlrev_b32 v26, 4, v1
    s_mov_b32 s15, 0x20000
    s_cmp_lt_u32 s3, 4
    s_cbranch_scc1 ISS_KGEN
    s_cmp_eq_u32 s3, 5
    s_cbranch_scc1 ISS_MOD
    s_cmp_gt_u32 s3, 5
    s_cbranch_scc1 ISS_PRE
    s_mov_b32 s14, 2097152
    s_lshl_b32 s20, s2, 13
    s_add_u32 s21, s20, 4096
    s_mov_b32 m0, 65536
    s_waitcnt lgkmcnt(0)
    s_mov_b64 s[12:13], s[48:49]
    buffer_load_dwordx4 v26, s[12:15], s20 offen offset:0 nt lds
    s_add_u32 m0, m0, 64
    s_nop 0
    buffer_load_dwordx4 v26, s[12:15], s20 offen offset:1024 nt lds
    s_add_u32 m0, m0, 64
    s_nop 0
    buffer_load_dwordx4 v26, s[12:15], s20 offen offset:2048 nt lds
    s_add_u32 m0, m0, 64
    s_nop 0
    buffer_load_dwordx4 v26, s[12:15], s20 offen offset:3072 nt lds
    s_add_u32 m0, m0, 4160
    s_nop 0
    buffer_load_dwordx4 v26, s[12:15], s21 offen offset:0 nt lds
    s_add_u32 m0, m0, 64
    s_nop 0
    buffer_load_dwordx4 v26, s[12:15], s21 offen offset:1024 nt lds
    s_add_u32 m0, m0, 64
    s_nop 0
    buffer_load_dwordx4 v26, s[12:15], s21 offen offset:2048 nt lds
    s_add_u32 m0, m0, 64
    s_nop 0
    buffer_load_dwordx4 v26, s[12:15], s21 offen offset:3072 nt lds
    s_setprio 3
    s_barrier
    s_branch ROLE_ROWS
ISS_KGEN:
    s_mov_b32 s14, 131072
    s_mov_b64 s[22:23], s[14:15]
    s_mov_b64 s[26:27], s[14:15]
    s_mov_b64 s[30:31], s[14:15]
    s_lshl_b32 s41, s42, 5
    s_add_u32 s41, s41, s43
    s_lshl_b32 s8, s41, 9
    s_lshl_b32 s9, s3, 7
    s_add_u32 s8, s8, s9
    v_lshlrev_b32 v2, 1, v1
    s_lshl_b32 s9, s41, 2
    s_waitcnt lgkmcnt(0)
    s_mov_b64 s[12:13], s[50:51]
    s_mov_b64 s[20:21], s[52:53]
    s_mov_b64 s[24:25], s[54:55]
    s_mov_b64 s[28:29], s[56:57]
    buffer_load_ushort v32, v2, s[12:15], s8 offen nt
    buffer_load_ushort v33, v2, s[20:23], s8 offen nt
    buffer_load_ushort v34, v2, s[24:27], s8 offen nt
    buffer_load_ushort v35, v2, s[28:31], s8 offen nt
    s_load_dword s0, s[58:59], s9
    s_load_dword s1, s[60:61], s9
    s_branch SETUP0
ISS_MOD:
    s_mov_b32 s23, s15
    s_mov_b32 s22, 1024
    s_cmp_ge_u32 s2, 192
    s_cselect_b32 s14, 0, 3145728
    s_mul_i32 s0, s2, 1366
    s_lshr_b32 s0, s0, 16
    s_mul_i32 s1, s0, 48
    s_sub_u32 s1, s2, s1
    v_lshrrev_b32 v2, 3, v1
    v_and_b32 v3, 7, v1
    v_and_b32 v4, 6, v2
    v_xor_b32 v3, v3, v4
    v_mul_u32_u24 v2, 6144, v2
    v_lshl_add_u32 v2, v3, 4, v2
    s_mul_i32 s24, s0, 786432
    s_lshl_b32 s25, s1, 7
    s_add_u32 s24, s24, s25
    s_lshl_b32 s25, s0, 8
    v_lshlrev_b32 v6, 2, v1
    s_mov_b32 m0, 74496
    s_mov_b32 s26, 0
    s_waitcnt lgkmcnt(0)
    s_mov_b64 s[12:13], s[72:73]
    s_mov_b64 s[20:21], s[70:71]
    s_barrier
    buffer_load_dword v36, v6, s[20:23], s25 offen
    s_mov_b32 m0, 74496
    s_mov_b32 s26, 0
MODLP:
    buffer_load_dwordx4 v2, s[12:15], s24 offen nt lds
    s_add_u32 m0, m0, 1024
    s_add_u32 s24, s24, 49152
    s_add_u32 s26, s26, 1
    s_cmp_lt_u32 s26, 16
    s_cbranch_scc1 MODLP
    s_branch SETUP
ISS_PRE:
    s_getpc_b64 s[12:13]
PCREF:
    s_and_b32 s14, s43, 15
    s_lshl_b32 s14, s14, 1
    s_add_u32 s14, s14, s3
    s_sub_u32 s14, s14, 6
    s_lshl_b32 s14, s14, 11
    v_and_b32 v2, 15, v1
    v_lshl_add_u32 v2, v2, 7, s14
    v_min_u32 v2, END-adaLN_cond__ssm_conv_s4d__glu_gated_glu__prompt_kernel, v2
    v_subrev_u32 v2, PCREF-adaLN_cond__ssm_conv_s4d__glu_gated_glu__prompt_kernel, v2
    v_ashrrev_i32 v3, 31, v2
    v_lshl_add_u64 v[2:3], v[2:3], 0, s[12:13]
    global_load_dword v36, v[2:3], off
    v_mov_b32 v4, 0
    v_mov_b32 v5, 0
    v_mov_b32 v6, 0
    v_mov_b32 v7, 0
    ds_write_b128 v4, v[4:7] offset:64896
    s_waitcnt lgkmcnt(0)
SETUP0:
    s_barrier
SETUP:
    s_mov_b32 s6, 33554432
    s_mov_b32 s7, 0x20000
    s_mov_b64 s[4:5], s[78:79]
    s_load_dword s40, s[4:5], 0
    s_bfe_u32 s12, s42, 0x10001
    s_and_b32 s13, s42, 1
    s_mul_i32 s12, s12, 1792
    s_mul_i32 s13, s13, 768
    s_add_u32 s12, s12, s13
    s_mul_i32 s32, s43, 28672
    s_add_u32 s32, s32, s12
    s_lshl_b32 s41, s42, 5
    s_add_u32 s41, s41, s43
    s_and_b32 s12, s43, 7
    s_lshr_b32 s13, s43, 3
    s_lshr_b32 s44, s42, 2
    s_lshl_b32 s44, s44, 3
    s_add_u32 s44, s44, s12
    s_bfe_u32 s46, s42, 0x10001
    s_and_b32 s14, s42, 1
    s_mul_i32 s45, s46, 7
    s_mul_i32 s15, s14, 3
    s_add_u32 s45, s45, s15
    s_add_u32 s45, s45, s13
    s_mul_i32 s15, s14, 7
    s_lshr_b32 s34, s43, 2
    s_xor_b32 s34, s34, s15
    s_lshr_b32 s47, s42, 1
    s_lshl_b32 s47, s47, 2
    s_and_b32 s15, s43, 3
    s_add_u32 s47, s47, s15
    s_lshl_b32 s47, s47, 1
    s_add_u32 s47, s47, s14
    s_xor_b32 s47, s47, 1
    s_lshr_b32 s35, s43, 2
    s_lshl_b32 s33, s45, 8
    s_bitcmp1_b32 s3, 0
    s_cselect_b64 s[16:17], s[66:67], s[64:65]
    s_mov_b32 s18, 1835008
    s_mov_b32 s19, 0x20000
    s_mov_b32 s38, 1835008
    s_mov_b32 s39, 0x20000
    s_mov_b64 s[36:37], s[68:69]
    s_mov_b32 s10, 2097152
    s_mov_b32 s11, 0x20000
    s_mov_b64 s[8:9], s[74:75]
    v_sub_u32 v2, 511, v0
    v_lshlrev_b32 v2, 2, v2
    v_add_u32 v8, 3, v2
    v_max_i32 v40, 0, v8
    v_cvt_f32_u32 v40, v40
    v_add_u32 v9, 2, v2
    v_max_i32 v41, 0, v9
    v_cvt_f32_u32 v41, v41
    v_add_u32 v10, 1, v2
    v_max_i32 v42, 0, v10
    v_cvt_f32_u32 v42, v42
    v_add_u32 v11, 0, v2
    v_max_i32 v43, 0, v11
    v_cvt_f32_u32 v43, v43
    v_add_u32 v12, -1, v2
    v_max_i32 v44, 0, v12
    v_cvt_f32_u32 v44, v44
    v_add_u32 v13, -2, v2
    v_max_i32 v45, 0, v13
    v_cvt_f32_u32 v45, v45
    v_add_u32 v14, -3, v2
    v_max_i32 v46, 0, v14
    v_cvt_f32_u32 v46, v46
    v_cvt_pk_bf16_f32 v48, v40, v41
    v_cvt_pk_bf16_f32 v50, v42, v43
    v_cvt_pk_bf16_f32 v52, v44, v45
    v_cvt_pk_bf16_f32 v54, v46, v46
    s_mov_b32 s12, 8464
    v_and_b32 v40, 0xffff, v48
    v_subrev_u32 v40, 17024, v40
    v_min_i32 v8, 128, v8
    v_max_i32 v8, v40, v8
    v_lshl_add_u32 v8, v8, 2, s12
    v_lshrrev_b32 v41, 16, v48
    v_subrev_u32 v41, 17024, v41
    v_min_i32 v9, 128, v9
    v_max_i32 v9, v41, v9
    v_lshl_add_u32 v9, v9, 2, s12
    v_and_b32 v42, 0xffff, v50
    v_subrev_u32 v42, 17024, v42
    v_min_i32 v10, 128, v10
    v_max_i32 v10, v42, v10
    v_lshl_add_u32 v10, v10, 2, s12
    v_lshrrev_b32 v43, 16, v50
    v_subrev_u32 v43, 17024, v43
    v_min_i32 v11, 128, v11
    v_max_i32 v11, v43, v11
    v_lshl_add_u32 v11, v11, 2, s12
    v_and_b32 v44, 0xffff, v52
    v_subrev_u32 v44, 17024, v44
    v_min_i32 v12, 128, v12
    v_max_i32 v12, v44, v12
    v_lshl_add_u32 v12, v12, 2, s12
    v_lshrrev_b32 v45, 16, v52
    v_subrev_u32 v45, 17024, v45
    v_min_i32 v13, 128, v13
    v_max_i32 v13, v45, v13
    v_lshl_add_u32 v13, v13, 2, s12
    v_and_b32 v46, 0xffff, v54
    v_subrev_u32 v46, 17024, v46
    v_min_i32 v14, 128, v14
    v_max_i32 v14, v46, v14
    v_lshl_add_u32 v14, v14, 2, s12
    v_and_b32 v2, 1, v0
    v_lshrrev_b32 v3, 2, v0
    v_lshl_add_u32 v2, v3, 1, v2
    v_bfe_u32 v4, v0, 1, 1
    s_and_b32 s12, s41, 1
    s_lshl_b32 s12, s12, 5
    v_lshl_add_u32 v16, v2, 6, s12
    v_lshl_add_u32 v16, v4, 4, v16
    v_mul_u32_u24 v20, 29248, v4
    v_lshl_add_u32 v20, v2, 4, v20
    v_and_b32 v5, 3, v0
    v_lshlrev_b32 v15, 14, v3
    v_lshl_add_u32 v15, v5, 4, v15
    s_lshl_b32 s12, s3, 10
    s_add_u32 s12, s12, 98304
    v_lshl_add_u32 v18, v1, 3, s12
    v_and_b32 v2, 31, v2
    v_lshl_add_u32 v19, v2, 5, s12
    v_and_b32 v2, 1, v0
    v_and_b32 v6, 15, v3
    s_lshl_b32 s12, s3, 9
    s_add_u32 s12, s12, 23040
    v_lshl_add_u32 v6, v6, 4, s12
    v_lshl_add_u32 v6, v2, 8, v6
    v_mul_u32_u24 v2, 33280, v4
    v_add_u32 v21, v2, v6
    v_lshrrev_b32 v2, 2, v1
    v_mul_u32_u24 v6, 24576, v5
    v_lshl_add_u32 v17, v2, 12, v6
    v_bfe_u32 v3, v1, 3, 2
    s_and_b32 s13, s3, 3
    v_xor_b32 v3, s13, v3
    v_lshlrev_b32 v2, 7, v2
    v_lshl_add_u32 v2, v3, 5, v2
    v_lshl_add_u32 v25, v5, 3, v2
    v_lshrrev_b32 v2, 3, v1
    v_and_b32 v3, 7, v1
    v_and_b32 v4, 6, v2
    v_xor_b32 v3, v3, v4
    v_mul_u32_u24 v2, 3584, v2
    v_lshl_add_u32 v27, v3, 4, v2
    v_add_u32 v28, 27648, v27
    v_add_u32 v29, 55296, v27
    v_add_u32 v30, 82944, v27
    v_bfe_u32 v3, v0, 3, 2
    v_bfe_u32 v4, v0, 2, 1
    v_mul_u32_u24 v6, 14592, v3
    v_and_b32 v3, 1, v3
    v_lshl_add_u32 v6, v3, 7, v6
    v_mul_u32_u24 v4, 4160, v4
    v_lshlrev_b32 v5, 3, v5
    v_add3_u32 v31, v6, v4, v5
    s_bfe_u32 s12, s3, 0x10001
    s_and_b32 s13, s3, 1
    v_bfe_u32 v2, v1, 1, 1
    v_and_b32 v3, 1, v1
    v_mul_u32_u24 v2, 14720, v2
    v_mul_u32_u24 v3, 4160, v3
    v_and_b32 v4, 12, v1
    v_lshrrev_b32 v5, 4, v1
    v_lshlrev_b32 v6, 3, v5
    v_sub_u32 v4, v6, v4
    v_lshl_add_u32 v2, v4, 1, v2
    s_mul_i32 s14, s12, 29184
    s_lshl_b32 s15, s13, 8
    s_sub_u32 s14, s14, s15
    s_add_u32 s14, s14, 280
    v_add3_u32 v22, v2, v3, s14
    v_and_b32 v2, 15, v1
    v_lshlrev_b32 v3, 5, v2
    v_lshl_add_u32 v3, v5, 4, v3
    s_mul_i32 s14, s12, 29248
    s_sub_u32 s14, s14, s15
    s_add_u32 s14, s14, 8704
    v_add_u32 v23, s14, v3
    v_lshrrev_b32 v3, 5, v1
    v_lshlrev_b32 v2, 4, v2
    v_lshl_add_u32 v2, v3, 8, v2
    v_and_b32 v3, 1, v5
    v_lshl_add_u32 v2, v3, 3, v2
    s_lshl_b32 s14, s3, 12
    s_add_u32 s14, s14, 48128
    s_cmp_eq_u32 s3, 0
    s_cselect_b32 s14, 23040, s14
    v_add_u32 v24, s14, v2
    s_waitcnt lgkmcnt(0)
    s_mul_i32 s40, s40, 1664525
    s_add_u32 s40, s40, 1013904223
    s_cmp_lt_u32 s3, 4
    s_cbranch_scc1 ROLE_KGEN
    s_cmp_eq_u32 s3, 5
    s_cbranch_scc1 ROLE_MOD
    s_cmp_eq_u32 s3, 4
    s_cbranch_scc1 JOIN_A
    s_cmp_eq_u32 s34, 7
    s_cbranch_scc1 JOIN_A
    v_mov_b32 v2, 0
    s_mov_b32 s15, 0
    s_branch RWC
RW:
    s_sleep 2
RWC:
    ds_read_b32 v3, v2 offset:64904
    s_add_u32 s15, s15, 1
    s_waitcnt lgkmcnt(0)
    v_cmp_gt_u32 vcc, 1, v3
    s_cmp_gt_u32 s15, 200000
    s_cbranch_scc1 RWX
    s_cbranch_vccnz RW
RWX:
    s_and_b32 s13, s3, 1
    s_lshl_b32 s13, s13, 14
    s_bfe_u32 s14, s3, 0x1
    s_mul_i32 s12, s14, 458752
    s_add_u32 s12, s12, s33
    s_add_u32 s12, s12, 128
    s_mul_i32 s14, s14, 16384
    s_add_u32 s13, s13, s14
    s_add_u32 m0, s13, 131072
    s_nop 0
    buffer_load_dwordx4 v27, s[16:19], s12 offen offset:0 lds
    buffer_load_dwordx4 v28, s[16:19], s12 offen offset:1024 lds
    buffer_load_dwordx4 v29, s[16:19], s12 offen offset:2048 lds
    buffer_load_dwordx4 v30, s[16:19], s12 offen offset:3072 lds
    s_add_u32 m0, m0, 4096
    s_add_u32 s12, s12, 114688
    buffer_load_dwordx4 v27, s[16:19], s12 offen offset:0 lds
    buffer_load_dwordx4 v28, s[16:19], s12 offen offset:1024 lds
    buffer_load_dwordx4 v29, s[16:19], s12 offen offset:2048 lds
    buffer_load_dwordx4 v30, s[16:19], s12 offen offset:3072 lds
    s_add_u32 m0, m0, 4096
    s_add_u32 s12, s12, 114688
    buffer_load_dwordx4 v27, s[16:19], s12 offen offset:0 lds
    buffer_load_dwordx4 v28, s[16:19], s12 offen offset:1024 lds
    buffer_load_dwordx4 v29, s[16:19], s12 offen offset:2048 lds
    buffer_load_dwordx4 v30, s[16:19], s12 offen offset:3072 lds
    s_add_u32 m0, m0, 4096
    s_add_u32 s12, s12, 114688
    buffer_load_dwordx4 v27, s[16:19], s12 offen offset:0 lds
    buffer_load_dwordx4 v28, s[16:19], s12 offen offset:1024 lds
    buffer_load_dwordx4 v29, s[16:19], s12 offen offset:2048 lds
    buffer_load_dwordx4 v30, s[16:19], s12 offen offset:3072 lds
    s_branch JOIN_A
.p2align 12
ROLE_ROWS:
    s_mov_b32 s6, 33554432
    s_mov_b32 s7, 0x20000
    s_mov_b64 s[4:5], s[78:79]
    s_load_dword s40, s[4:5], 0
    s_bfe_u32 s12, s42, 0x10001
    s_and_b32 s13, s42, 1
    s_mul_i32 s12, s12, 1792
    s_mul_i32 s13, s13, 768
    s_add_u32 s12, s12, s13
    s_mul_i32 s32, s43, 28672
    s_add_u32 s32, s32, s12
    s_mov_b32 s22, 1835008
    s_mov_b32 s23, 0x20000
    s_mov_b32 s26, 1835008
    s_mov_b32 s27, 0x20000
    s_mov_b64 s[20:21], s[64:65]
    s_mov_b64 s[24:25], s[66:67]
    v_bfe_u32 v2, v1, 2, 2
    v_lshrrev_b32 v3, 4, v1
    v_and_b32 v4, 3, v1
    v_mul_u32_u24 v2, 1088, v2
    v_lshl_add_u32 v2, v3, 5, v2
    v_lshl_add_u32 v2, v4, 3, v2
    v_add_u32 v2, 65536, v2
    v_lshrrev_b32 v3, 2, v1
    v_lshlrev_b32 v3, 14, v3
    v_lshl_add_u32 v3, v4, 4, v3
    v_lshrrev_b32 v4, 3, v1
    v_and_b32 v5, 7, v1
    v_mul_u32_u24 v4, 1088, v4
    v_lshl_add_u32 v4, v5, 4, v4
    v_add_u32 v4, 65536, v4
    s_lshl_b32 s13, s2, 6
    s_add_u32 s14, s13, 4096
    s_add_u32 s13, s13, 1048576
    s_waitcnt vmcnt(0)
    ds_read_b64_tr_b16 v[32:33], v2 offset:0
    ds_read_b64_tr_b16 v[34:35], v2 offset:4352
    ds_read_b64_tr_b16 v[36:37], v2 offset:128
    ds_read_b64_tr_b16 v[38:39], v2 offset:4480
    ds_read_b64_tr_b16 v[40:41], v2 offset:256
    ds_read_b64_tr_b16 v[42:43], v2 offset:4608
    ds_read_b64_tr_b16 v[44:45], v2 offset:384
    ds_read_b64_tr_b16 v[46:47], v2 offset:4736
    ds_read_b64_tr_b16 v[48:49], v2 offset:512
    ds_read_b64_tr_b16 v[50:51], v2 offset:4864
    ds_read_b64_tr_b16 v[52:53], v2 offset:640
    ds_read_b64_tr_b16 v[54:55], v2 offset:4992
    ds_read_b64_tr_b16 v[56:57], v2 offset:768
    ds_read_b64_tr_b16 v[58:59], v2 offset:5120
    ds_read_b64_tr_b16 v[60:61], v2 offset:896
    ds_read_b64_tr_b16 v[62:63], v2 offset:5248
    s_waitcnt lgkmcnt(0)
    buffer_store_dwordx4 v[32:35], v3, s[4:7], s13 offen sc1
    s_add_u32 s13, s13, 262144
    buffer_store_dwordx4 v[36:39], v3, s[4:7], s13 offen sc1
    s_add_u32 s13, s13, 262144
    buffer_store_dwordx4 v[40:43], v3, s[4:7], s13 offen sc1
    s_add_u32 s13, s13, 262144
    buffer_store_dwordx4 v[44:47], v3, s[4:7], s13 offen sc1
    s_add_u32 s13, s13, 262144
    buffer_store_dwordx4 v[48:51], v3, s[4:7], s13 offen sc1
    s_add_u32 s13, s13, 262144
    buffer_store_dwordx4 v[52:55], v3, s[4:7], s13 offen sc1
    s_add_u32 s13, s13, 262144
    buffer_store_dwordx4 v[56:59], v3, s[4:7], s13 offen sc1
    s_add_u32 s13, s13, 262144
    buffer_store_dwordx4 v[60:63], v3, s[4:7], s13 offen sc1
    s_mul_i32 s13, s2, 384
    s_add_u32 s13, s13, 196608
    v_mov_b32 v96, 0
    v_mov_b32 v97, 0
    v_mov_b32 v98, 0
    v_mov_b32 v99, 0
    s_mov_b64 exec, 0xffffff
    buffer_store_dwordx4 v[96:99], v26, s[4:7], s13 offen sc1
    s_mov_b64 exec, -1
    ds_read_b128 v[64:67], v4 offset:0
    ds_read_b128 v[68:71], v4 offset:128
    ds_read_b128 v[72:75], v4 offset:256
    ds_read_b128 v[76:79], v4 offset:384
    ds_read_b128 v[80:83], v4 offset:512
    ds_read_b128 v[84:87], v4 offset:640
    ds_read_b128 v[88:91], v4 offset:768
    ds_read_b128 v[92:95], v4 offset:896
    s_mov_b32 s12, s32
    buffer_load_dwordx4 v[128:131], v26, s[20:23], s12 offen
    buffer_load_dwordx4 v[132:135], v26, s[24:27], s12 offen
    s_add_u32 s12, s12, 3584
    buffer_load_dwordx4 v[136:139], v26, s[20:23], s12 offen
    buffer_load_dwordx4 v[140:143], v26, s[24:27], s12 offen
    s_add_u32 s12, s12, 3584
    buffer_load_dwordx4 v[144:147], v26, s[20:23], s12 offen
    buffer_load_dwordx4 v[148:151], v26, s[24:27], s12 offen
    s_add_u32 s12, s12, 3584
    buffer_load_dwordx4 v[152:155], v26, s[20:23], s12 offen
    buffer_load_dwordx4 v[156:159], v26, s[24:27], s12 offen
    s_add_u32 s12, s12, 3584
    buffer_load_dwordx4 v[160:163], v26, s[20:23], s12 offen
    buffer_load_dwordx4 v[164:167], v26, s[24:27], s12 offen
    s_add_u32 s12, s12, 3584
    buffer_load_dwordx4 v[168:171], v26, s[20:23], s12 offen
    buffer_load_dwordx4 v[172:175], v26, s[24:27], s12 offen
    s_add_u32 s12, s12, 3584
    buffer_load_dwordx4 v[176:179], v26, s[20:23], s12 offen
    buffer_load_dwordx4 v[180:183], v26, s[24:27], s12 offen
    s_add_u32 s12, s12, 3584
    buffer_load_dwordx4 v[184:187], v26, s[20:23], s12 offen
    buffer_load_dwordx4 v[188:191], v26, s[24:27], s12 offen
    s_add_u32 s12, s12, 892416
    s_mul_i32 s40, s40, 1664525
    s_add_u32 s40, s40, 1013904223
    s_setprio 0
    v_mov_b32 v4, 0
    v_mov_b32 v5, 0
    v_mov_b32 v6, 0
    v_mov_b32 v7, 0
    s_mov_b32 s12, 0x3f803f80
    s_waitcnt lgkmcnt(7)
    v_dot2c_f32_bf16 v4, s12, v64
    v_dot2c_f32_bf16 v5, v64, v64
    v_dot2c_f32_bf16 v6, s12, v65
    v_dot2c_f32_bf16 v7, v65, v65
    v_dot2c_f32_bf16 v4, s12, v66
    v_dot2c_f32_bf16 v5, v66, v66
    v_dot2c_f32_bf16 v6, s12, v67
    v_dot2c_f32_bf16 v7, v67, v67
    s_waitcnt lgkmcnt(6)
    v_dot2c_f32_bf16 v4, s12, v68
    v_dot2c_f32_bf16 v5, v68, v68
    v_dot2c_f32_bf16 v6, s12, v69
    v_dot2c_f32_bf16 v7, v69, v69
    v_dot2c_f32_bf16 v4, s12, v70
    v_dot2c_f32_bf16 v5, v70, v70
    v_dot2c_f32_bf16 v6, s12, v71
    v_dot2c_f32_bf16 v7, v71, v71
    s_waitcnt lgkmcnt(5)
    v_dot2c_f32_bf16 v4, s12, v72
    v_dot2c_f32_bf16 v5, v72, v72
    v_dot2c_f32_bf16 v6, s12, v73
    v_dot2c_f32_bf16 v7, v73, v73
    v_dot2c_f32_bf16 v4, s12, v74
    v_dot2c_f32_bf16 v5, v74, v74
    v_dot2c_f32_bf16 v6, s12, v75
    v_dot2c_f32_bf16 v7, v75, v75
    s_waitcnt lgkmcnt(4)
    v_dot2c_f32_bf16 v4, s12, v76
    v_dot2c_f32_bf16 v5, v76, v76
    v_dot2c_f32_bf16 v6, s12, v77
    v_dot2c_f32_bf16 v7, v77, v77
    v_dot2c_f32_bf16 v4, s12, v78
    v_dot2c_f32_bf16 v5, v78, v78
    v_dot2c_f32_bf16 v6, s12, v79
    v_dot2c_f32_bf16 v7, v79, v79
    s_waitcnt lgkmcnt(3)
    v_dot2c_f32_bf16 v4, s12, v80
    v_dot2c_f32_bf16 v5, v80, v80
    v_dot2c_f32_bf16 v6, s12, v81
    v_dot2c_f32_bf16 v7, v81, v81
    v_dot2c_f32_bf16 v4, s12, v82
    v_dot2c_f32_bf16 v5, v82, v82
    v_dot2c_f32_bf16 v6, s12, v83
    v_dot2c_f32_bf16 v7, v83, v83
    s_waitcnt lgkmcnt(2)
    v_dot2c_f32_bf16 v4, s12, v84
    v_dot2c_f32_bf16 v5, v84, v84
    v_dot2c_f32_bf16 v6, s12, v85
    v_dot2c_f32_bf16 v7, v85, v85
    v_dot2c_f32_bf16 v4, s12, v86
    v_dot2c_f32_bf16 v5, v86, v86
    v_dot2c_f32_bf16 v6, s12, v87
    v_dot2c_f32_bf16 v7, v87, v87
    s_waitcnt lgkmcnt(1)
    v_dot2c_f32_bf16 v4, s12, v88
    v_dot2c_f32_bf16 v5, v88, v88
    v_dot2c_f32_bf16 v6, s12, v89
    v_dot2c_f32_bf16 v7, v89, v89
    v_dot2c_f32_bf16 v4, s12, v90
    v_dot2c_f32_bf16 v5, v90, v90
    v_dot2c_f32_bf16 v6, s12, v91
    v_dot2c_f32_bf16 v7, v91, v91
    s_waitcnt lgkmcnt(0)
    v_dot2c_f32_bf16 v4, s12, v92
    v_dot2c_f32_bf16 v5, v92, v92
    v_dot2c_f32_bf16 v6, s12, v93
    v_dot2c_f32_bf16 v7, v93, v93
    v_dot2c_f32_bf16 v4, s12, v94
    v_dot2c_f32_bf16 v5, v94, v94
    v_dot2c_f32_bf16 v6, s12, v95
    v_dot2c_f32_bf16 v7, v95, v95
    s_nop 1
    v_add_f32 v4, v4, v6
    v_add_f32 v5, v5, v7
    s_nop 0
    v_add_f32_dpp v4, v4, v4 quad_perm:[1,0,3,2] row_mask:0xf bank_mask:0xf
    v_add_f32_dpp v5, v5, v5 quad_perm:[1,0,3,2] row_mask:0xf bank_mask:0xf
    s_nop 0
    v_add_f32_dpp v4, v4, v4 quad_perm:[2,3,0,1] row_mask:0xf bank_mask:0xf
    v_add_f32_dpp v5, v5, v5 quad_perm:[2,3,0,1] row_mask:0xf bank_mask:0xf
    s_nop 0
    v_add_f32_dpp v4, v4, v4 row_half_mirror row_mask:0xf bank_mask:0xf
    v_add_f32_dpp v5, v5, v5 row_half_mirror row_mask:0xf bank_mask:0xf
    v_mul_f32 v4, 0x3b000000, v4
    v_mul_f32 v5, 0x3b000000, v5
    v_fma_f32 v5, -v4, v4, v5
    v_max_f32 v5, 0, v5
    v_cvt_pk_bf16_f32 v5, v5, v5
    v_lshlrev_b32 v5, 16, v5
    v_add_f32 v5, 0x3727c5ac, v5
    v_cvt_pk_bf16_f32 v5, v5, v5
    v_lshlrev_b32 v5, 16, v5
    v_sqrt_f32 v5, v5
    s_nop 0
    v_cvt_pk_bf16_f32 v5, v4, v5
    v_lshlrev_b32 v6, 5, v1
    ds_bpermute_b32 v4, v6, v5
    v_lshlrev_b32 v6, 3, v1
    s_waitcnt lgkmcnt(0)
    s_waitcnt vmcnt(16)
    v_mov_b32 v5, s40
    s_mov_b64 exec, 0xff
    buffer_store_dwordx2 v[4:5], v6, s[4:7], s14 offen sc1
    s_mov_b64 exec, -1
    v_mov_b32 v2, 0
    v_mov_b32 v3, 1
    s_mov_b64 exec, 1
    ds_add_u32 v2, v3 offset:64904
    s_mov_b64 exec, -1
    s_waitcnt lgkmcnt(0)
    s_setprio 0
    s_branch SETUP
ROLE_MOD:
    s_waitcnt vmcnt(16)
    v_lshlrev_b32 v2, 16, v36
    v_and_b32 v3, 0xffff0000, v36
    v_mul_f32 v4, 0x3fb8aa3b, v2
    v_mul_f32 v5, 0x3fb8aa3b, v3
    v_exp_f32 v4, -v4
    v_exp_f32 v5, -v5
    v_add_f32 v4, 1.0, v4
    v_add_f32 v5, 1.0, v5
    v_rcp_f32 v4, v4
    v_rcp_f32 v5, v5
    v_lshlrev_b32 v6, 2, v1
    v_mul_f32 v2, v2, v4
    v_mul_f32 v3, v3, v5
    v_cvt_pk_bf16_f32 v2, v2, v3
    ds_write_b32 v6, v2 offset:64512
    v_lshrrev_b32 v2, 4, v1
    v_lshlrev_b32 v2, 3, v2
    v_add_u32 v2, 64512, v2
    ds_read2_b64 v[32:35], v2 offset0:0 offset1:4
    ds_read2_b64 v[36:39], v2 offset0:8 offset1:12
    ds_read2_b64 v[40:43], v2 offset0:16 offset1:20
    ds_read2_b64 v[44:47], v2 offset0:24 offset1:28
    v_add_u32 v3, 74496, v25
    v_xor_b32 v2, 32, v3
    v_xor_b32 v4, 96, v3
    v_xor_b32 v5, 64, v3
    s_mul_i32 s24, s0, 24576
    s_lshl_b32 s25, s1, 9
    s_add_u32 s24, s24, s25
    s_add_u32 s24, s24, 32768
    s_cmp_ge_u32 s2, 192
    s_cselect_b32 s24, 33554432, s24
    s_waitcnt vmcnt(0)
    ds_read_b64_tr_b16 v[64:65], v2 offset:0
    ds_read_b64_tr_b16 v[66:67], v2 offset:2048
    ds_read_b64_tr_b16 v[68:69], v3 offset:0
    ds_read_b64_tr_b16 v[70:71], v3 offset:2048
    ds_read_b64_tr_b16 v[72:73], v4 offset:0
    ds_read_b64_tr_b16 v[74:75], v4 offset:2048
    ds_read_b64_tr_b16 v[76:77], v5 offset:0
    ds_read_b64_tr_b16 v[78:79], v5 offset:2048
    ds_read_b64_tr_b16 v[80:81], v2 offset:4096
    ds_read_b64_tr_b16 v[82:83], v2 offset:6144
    ds_read_b64_tr_b16 v[84:85], v3 offset:4096
    ds_read_b64_tr_b16 v[86:87], v3 offset:6144
    ds_read_b64_tr_b16 v[88:89], v4 offset:4096
    ds_read_b64_tr_b16 v[90:91], v4 offset:6144
    ds_read_b64_tr_b16 v[92:93], v5 offset:4096
    ds_read_b64_tr_b16 v[94:95], v5 offset:6144
    ds_read_b64_tr_b16 v[96:97], v2 offset:8192
    ds_read_b64_tr_b16 v[98:99], v2 offset:10240
    ds_read_b64_tr_b16 v[100:101], v3 offset:8192
    ds_read_b64_tr_b16 v[102:103], v3 offset:10240
    ds_read_b64_tr_b16 v[104:105], v4 offset:8192
    ds_read_b64_tr_b16 v[106:107], v4 offset:10240
    ds_read_b64_tr_b16 v[108:109], v5 offset:8192
    ds_read_b64_tr_b16 v[110:111], v5 offset:10240
    ds_read_b64_tr_b16 v[112:113], v2 offset:12288
    ds_read_b64_tr_b16 v[114:115], v2 offset:14336
    ds_read_b64_tr_b16 v[116:117], v3 offset:12288
    ds_read_b64_tr_b16 v[118:119], v3 offset:14336
    ds_read_b64_tr_b16 v[120:121], v4 offset:12288
    ds_read_b64_tr_b16 v[122:123], v4 offset:14336
    ds_read_b64_tr_b16 v[124:125], v5 offset:12288
    ds_read_b64_tr_b16 v[126:127], v5 offset:14336
    s_waitcnt lgkmcnt(15)
    v_mfma_f32_16x16x32_bf16 v[48:51], v[32:35], v[64:67], 0
    v_mfma_f32_16x16x32_bf16 v[52:55], v[32:35], v[68:71], 0
    v_mfma_f32_16x16x32_bf16 v[56:59], v[32:35], v[72:75], 0
    v_mfma_f32_16x16x32_bf16 v[60:63], v[32:35], v[76:79], 0
    v_mfma_f32_16x16x32_bf16 v[48:51], v[36:39], v[80:83], v[48:51]
    v_mfma_f32_16x16x32_bf16 v[52:55], v[36:39], v[84:87], v[52:55]
    v_mfma_f32_16x16x32_bf16 v[56:59], v[36:39], v[88:91], v[56:59]
    v_mfma_f32_16x16x32_bf16 v[60:63], v[36:39], v[92:95], v[60:63]
    s_waitcnt lgkmcnt(14)
    v_mfma_f32_16x16x32_bf16 v[48:51], v[40:43], v[96:99], v[48:51]
    s_waitcnt lgkmcnt(12)
    v_mfma_f32_16x16x32_bf16 v[52:55], v[40:43], v[100:103], v[52:55]
    s_waitcnt lgkmcnt(10)
    v_mfma_f32_16x16x32_bf16 v[56:59], v[40:43], v[104:107], v[56:59]
    s_waitcnt lgkmcnt(8)
    v_mfma_f32_16x16x32_bf16 v[60:63], v[40:43], v[108:111], v[60:63]
    s_waitcnt lgkmcnt(6)
    v_mfma_f32_16x16x32_bf16 v[48:51], v[44:47], v[112:115], v[48:51]
    s_waitcnt lgkmcnt(4)
    v_mfma_f32_16x16x32_bf16 v[52:55], v[44:47], v[116:119], v[52:55]
    s_waitcnt lgkmcnt(2)
    v_mfma_f32_16x16x32_bf16 v[56:59], v[44:47], v[120:123], v[56:59]
    s_waitcnt lgkmcnt(0)
    v_mfma_f32_16x16x32_bf16 v[60:63], v[44:47], v[124:127], v[60:63]
    v_lshlrev_b32 v6, 3, v1
    v_mov_b32 v3, s40
    v_cmp_gt_u32 vcc, 16, v1
    v_cmp_gt_u32_e64 s[26:27], 48, v1
    s_nop 0
    v_cndmask_b32 v48, v52, v48, vcc
    s_nop 1
    v_cndmask_b32_e64 v56, v60, v56, s[26:27]
    v_cmp_gt_u32 vcc, 32, v1
    s_nop 1
    v_cndmask_b32 v2, v56, v48, vcc
    buffer_store_dwordx2 v[2:3], v6, s[4:7], s24 offen sc1
    s_branch JOIN_A
.p2align 12
ROLE_KGEN:
    s_mul_i32 s14, s3, 14592
    s_mov_b32 m0, s14
    s_lshl_b32 s12, s0, 16
    s_and_b32 s0, s0, 0xffff0000
    s_lshl_b32 s13, s1, 16
    s_and_b32 s1, s1, 0xffff0000
    s_cmp_lt_u32 s3, 2
    s_cselect_b32 s0, s12, s0
    s_cselect_b32 s1, s13, s1
    s_bitcmp1_b32 s3, 0
    s_cselect_b32 s1, 0, s1
    v_mov_b32 v3, 0x3fb8aa3b
    v_mul_f32 v3, s0, v3
    v_exp_f32 v3, v3
    v_mov_b32 v64, 0
    v_cvt_pk_bf16_f32 v3, v3, v3
    v_writelane_b32 v64, s1, 0
    v_lshlrev_b32 v3, 16, v3
    v_mov_b32 v65, 0
    v_mov_b32 v66, 0
    v_mov_b32 v67, 0
    v_mov_b32 v68, 0
    v_mov_b32 v69, 0
    v_mov_b32 v70, 0
    v_mov_b32 v71, 0
    v_mov_b32 v72, 0
    v_mov_b32 v73, 0
    v_mov_b32 v74, 0
    v_mov_b32 v75, 0
    v_mov_b32 v76, 0
    v_mov_b32 v77, 0
    v_mov_b32 v78, 0
    v_mov_b32 v79, 0
    v_and_b32 v4, 31, v1
    v_lshrrev_b32 v5, 5, v1
    v_mul_u32_u24 v6, 272, v4
    v_lshl_add_u32 v6, v5, 4, v6
    v_add_u32 v128, s14, v6
    v_lshlrev_b32 v6, 5, v4
    v_lshl_add_u32 v6, v5, 4, v6
    s_add_u32 s14, s14, 8464
    v_add_u32 v129, s14, v6
    v_cmp_gt_u32 vcc, 32, v1
    v_lshlrev_b32 v6, 4, v4
    v_lshlrev_b32 v7, 3, v4
    v_add_u32 v130, 1024, v6
    v_add_u32 v131, 1032, v6
    v_add_u32 v132, 1536, v7
    v_add_u32 v133, 1792, v7
    v_cndmask_b32 v130, v132, v130, vcc
    v_cndmask_b32 v131, v133, v131, vcc
    v_add_u32 v130, s14, v130
    v_add_u32 v131, s14, v131
    v_lshlrev_b32 v6, 2, v4
    v_lshl_add_u32 v6, v5, 9, v6
    v_add_u32 v6, 2048, v6
    v_add_u32 v132, s14, v6
    s_sub_u32 s12, s14, 16
    v_mov_b32 v133, s12
    s_waitcnt vmcnt(0)
    v_lshlrev_b32 v32, 16, v32
    v_lshlrev_b32 v33, 16, v33
    v_mul_f32 v32, 0x3fb8aa3b, v32
    v_exp_f32 v32, v32
    v_mul_f32 v33, v33, v3
    v_cvt_pk_bf16_f32 v32, v32, v32
    v_mul_f32 v37, 0.15915494, v33
    v_lshlrev_b32 v32, 16, v32
    v_mul_f32 v32, v32, v3
    v_add_f32 v3, v3, v3
    v_mul_f32 v36, 0xbfb8aa3b, v32
    v_lshlrev_b32 v34, 16, v34
    v_lshlrev_b32 v35, 16, v35
    v_mul_f32 v34, v34, v3
    v_mul_f32 v35, v35, v3
    v_mul_f32 v4, 0x41000000, v36
    v_mul_f32 v5, 0x41000000, v37
    v_exp_f32 v4, v4
    v_fract_f32 v5, v5
    v_cos_f32 v38, v5
    v_sin_f32 v39, v5
    v_mul_f32 v38, v38, v4
    v_mul_f32 v39, v39, v4
    v_exp_f32 v6, v36
    v_fract_f32 v7, v37
    v_cos_f32 v42, v7
    v_sin_f32 v43, v7
    v_mul_f32 v42, v42, v6
    v_mul_f32 v43, v43, v6
    v_mul_f32 v4, 0x43800000, v36
    v_mul_f32 v5, 0x43800000, v37
    v_exp_f32 v4, v4
    v_fract_f32 v5, v5
    v_cos_f32 v40, v5
    v_sin_f32 v41, v5
    v_mul_f32 v40, v40, v4
    v_mul_f32 v41, v41, v4
.p2align 3
    v_cvt_pk_bf16_f32 v136, v34, -v35
    ds_write_addtid_b32 v136 offset:5712
    v_mov_b32 v144, 0x3f80
    v_pk_mul_f32 v[56:57], v[34:35], v[38:39] op_sel:[0,0] op_sel_hi:[0,1]
    v_pk_fma_f32 v[56:57], v[34:35], v[38:39], v[56:57] op_sel:[1,1,0] op_sel_hi:[1,0,1] neg_lo:[1,0,0]
    ds_write_addtid_b32 v144 offset:0
    v_cvt_pk_bf16_f32 v137, v56, -v57
    v_cvt_pk_bf16_f32 v140, v42, v43
    ds_write_addtid_b32 v137 offset:5984
    v_pk_mul_f32 v[34:35], v[56:57], v[38:39] op_sel:[0,0] op_sel_hi:[0,1]
    ds_write_addtid_b32 v140 offset:272
    v_pk_fma_f32 v[34:35], v[56:57], v[38:39], v[34:35] op_sel:[1,1,0] op_sel_hi:[1,0,1] neg_lo:[1,0,0]
    v_cvt_pk_bf16_f32 v138, v34, -v35
    v_pk_mul_f32 v[44:45], v[42:43], v[42:43] op_sel:[0,0] op_sel_hi:[0,1]
    ds_write_addtid_b32 v138 offset:6256
    v_pk_fma_f32 v[44:45], v[42:43], v[42:43], v[44:45] op_sel:[1,1,0] op_sel_hi:[1,0,1] neg_lo:[1,0,0]
    v_pk_mul_f32 v[56:57], v[34:35], v[38:39] op_sel:[0,0] op_sel_hi:[0,1]
    v_pk_fma_f32 v[56:57], v[34:35], v[38:39], v[56:57] op_sel:[1,1,0] op_sel_hi:[1,0,1] neg_lo:[1,0,0]
    v_cvt_pk_bf16_f32 v141, v44, v45
    v_cvt_pk_bf16_f32 v139, v56, -v57
    ds_write_addtid_b32 v141 offset:544
    ds_write_addtid_b32 v139 offset:6528
    v_pk_mul_f32 v[34:35], v[56:57], v[38:39] op_sel:[0,0] op_sel_hi:[0,1]
    v_pk_mul_f32 v[46:47], v[44:45], v[42:43] op_sel:[0,0] op_sel_hi:[0,1]
    v_pk_fma_f32 v[34:35], v[56:57], v[38:39], v[34:35] op_sel:[1,1,0] op_sel_hi:[1,0,1] neg_lo:[1,0,0]
    v_cvt_pk_bf16_f32 v136, v34, -v35
    v_pk_fma_f32 v[46:47], v[44:45], v[42:43], v[46:47] op_sel:[1,1,0] op_sel_hi:[1,0,1] neg_lo:[1,0,0]
    ds_write_addtid_b32 v136 offset:6800
    v_cvt_pk_bf16_f32 v142, v46, v47
    v_pk_mul_f32 v[56:57], v[34:35], v[38:39] op_sel:[0,0] op_sel_hi:[0,1]
    v_pk_fma_f32 v[56:57], v[34:35], v[38:39], v[56:57] op_sel:[1,1,0] op_sel_hi:[1,0,1] neg_lo:[1,0,0]
    ds_write_addtid_b32 v142 offset:816
    v_cvt_pk_bf16_f32 v137, v56, -v57
    v_pk_mul_f32 v[48:49], v[46:47], v[42:43] op_sel:[0,0] op_sel_hi:[0,1]
    ds_write_addtid_b32 v137 offset:7072
    v_pk_mul_f32 v[34:35], v[56:57], v[38:39] op_sel:[0,0] op_sel_hi:[0,1]
    v_pk_fma_f32 v[48:49], v[46:47], v[42:43], v[48:49] op_sel:[1,1,0] op_sel_hi:[1,0,1] neg_lo:[1,0,0]
    v_pk_fma_f32 v[34:35], v[56:57], v[38:39], v[34:35] op_sel:[1,1,0] op_sel_hi:[1,0,1] neg_lo:[1,0,0]
    v_cvt_pk_bf16_f32 v138, v34, -v35
    v_cvt_pk_bf16_f32 v143, v48, v49
    ds_write_addtid_b32 v138 offset:7344
    ds_write_addtid_b32 v143 offset:1088
    v_pk_mul_f32 v[56:57], v[34:35], v[38:39] op_sel:[0,0] op_sel_hi:[0,1]
    v_pk_fma_f32 v[56:57], v[34:35], v[38:39], v[56:57] op_sel:[1,1,0] op_sel_hi:[1,0,1] neg_lo:[1,0,0]
    v_pk_mul_f32 v[50:51], v[48:49], v[42:43] op_sel:[0,0] op_sel_hi:[0,1]
    v_cvt_pk_bf16_f32 v139, v56, -v57
    ds_write_addtid_b32 v139 offset:7616
    v_pk_fma_f32 v[50:51], v[48:49], v[42:43], v[50:51] op_sel:[1,1,0] op_sel_hi:[1,0,1] neg_lo:[1,0,0]
    v_pk_mul_f32 v[34:35], v[56:57], v[38:39] op_sel:[0,0] op_sel_hi:[0,1]
    v_cvt_pk_bf16_f32 v140, v50, v51
    v_pk_fma_f32 v[34:35], v[56:57], v[38:39], v[34:35] op_sel:[1,1,0] op_sel_hi:[1,0,1] neg_lo:[1,0,0]
    v_cvt_pk_bf16_f32 v136, v34, -v35
    ds_write_addtid_b32 v140 offset:1360
    ds_write_addtid_b32 v136 offset:7888
    v_pk_mul_f32 v[52:53], v[50:51], v[42:43] op_sel:[0,0] op_sel_hi:[0,1]
    v_pk_mul_f32 v[56:57], v[34:35], v[38:39] op_sel:[0,0] op_sel_hi:[0,1]
    v_pk_fma_f32 v[56:57], v[34:35], v[38:39], v[56:57] op_sel:[1,1,0] op_sel_hi:[1,0,1] neg_lo:[1,0,0]
    v_pk_fma_f32 v[52:53], v[50:51], v[42:43], v[52:53] op_sel:[1,1,0] op_sel_hi:[1,0,1] neg_lo:[1,0,0]
    v_cvt_pk_bf16_f32 v137, v56, -v57
    ds_write_addtid_b32 v137 offset:8160
    v_cvt_pk_bf16_f32 v141, v52, v53
    v_pk_mul_f32 v[34:35], v[56:57], v[38:39] op_sel:[0,0] op_sel_hi:[0,1]
    ds_write_addtid_b32 v141 offset:1632
    v_pk_fma_f32 v[34:35], v[56:57], v[38:39], v[34:35] op_sel:[1,1,0] op_sel_hi:[1,0,1] neg_lo:[1,0,0]
    v_cvt_pk_bf16_f32 v138, v34, -v35
    v_pk_mul_f32 v[54:55], v[52:53], v[42:43] op_sel:[0,0] op_sel_hi:[0,1]
    ds_write_addtid_b32 v138 offset:8432
    v_pk_fma_f32 v[54:55], v[52:53], v[42:43], v[54:55] op_sel:[1,1,0] op_sel_hi:[1,0,1] neg_lo:[1,0,0]
    v_pk_mul_f32 v[56:57], v[34:35], v[38:39] op_sel:[0,0] op_sel_hi:[0,1]
    v_pk_fma_f32 v[56:57], v[34:35], v[38:39], v[56:57] op_sel:[1,1,0] op_sel_hi:[1,0,1] neg_lo:[1,0,0]
    v_cvt_pk_bf16_f32 v142, v54, v55
    v_cvt_pk_bf16_f32 v139, v56, -v57
    ds_write_addtid_b32 v139 offset:8704
    ds_write_addtid_b32 v142 offset:1904
    v_pk_mul_f32 v[34:35], v[56:57], v[38:39] op_sel:[0,0] op_sel_hi:[0,1]
    v_cvt_pk_bf16_f32 v143, v40, v41
    v_pk_fma_f32 v[34:35], v[56:57], v[38:39], v[34:35] op_sel:[1,1,0] op_sel_hi:[1,0,1] neg_lo:[1,0,0]
    v_cvt_pk_bf16_f32 v136, v34, -v35
    ds_write_addtid_b32 v143 offset:2176
    ds_write_addtid_b32 v136 offset:8976
    v_pk_mul_f32 v[56:57], v[34:35], v[38:39] op_sel:[0,0] op_sel_hi:[0,1]
    v_pk_mul_f32 v[58:59], v[40:41], v[44:45] op_sel:[0,0] op_sel_hi:[0,1]
    v_pk_fma_f32 v[56:57], v[34:35], v[38:39], v[56:57] op_sel:[1,1,0] op_sel_hi:[1,0,1] neg_lo:[1,0,0]
    v_pk_fma_f32 v[58:59], v[40:41], v[44:45], v[58:59] op_sel:[1,1,0] op_sel_hi:[1,0,1] neg_lo:[1,0,0]
    v_cvt_pk_bf16_f32 v137, v56, -v57
    ds_write_addtid_b32 v137 offset:9248
    v_cvt_pk_bf16_f32 v140, v58, v59
    v_pk_mul_f32 v[34:35], v[56:57], v[38:39] op_sel:[0,0] op_sel_hi:[0,1]
    ds_write_addtid_b32 v140 offset:2448
    v_pk_fma_f32 v[34:35], v[56:57], v[38:39], v[34:35] op_sel:[1,1,0] op_sel_hi:[1,0,1] neg_lo:[1,0,0]
    v_cvt_pk_bf16_f32 v138, v34, -v35
    v_pk_mul_f32 v[58:59], v[40:41], v[48:49] op_sel:[0,0] op_sel_hi:[0,1]
    ds_write_addtid_b32 v138 offset:9520
    v_pk_mul_f32 v[56:57], v[34:35], v[38:39] op_sel:[0,0] op_sel_hi:[0,1]
    v_pk_fma_f32 v[58:59], v[40:41], v[48:49], v[58:59] op_sel:[1,1,0] op_sel_hi:[1,0,1] neg_lo:[1,0,0]
    v_pk_fma_f32 v[56:57], v[34:35], v[38:39], v[56:57] op_sel:[1,1,0] op_sel_hi:[1,0,1] neg_lo:[1,0,0]
    v_cvt_pk_bf16_f32 v141, v58, v59
    v_cvt_pk_bf16_f32 v139, v56, -v57
    ds_write_addtid_b32 v139 offset:9792
    ds_write_addtid_b32 v141 offset:2720
    v_pk_mul_f32 v[34:35], v[56:57], v[38:39] op_sel:[0,0] op_sel_hi:[0,1]
    v_pk_mul_f32 v[58:59], v[40:41], v[52:53] op_sel:[0,0] op_sel_hi:[0,1]
    v_pk_fma_f32 v[34:35], v[56:57], v[38:39], v[34:35] op_sel:[1,1,0] op_sel_hi:[1,0,1] neg_lo:[1,0,0]
    v_cvt_pk_bf16_f32 v136, v34, -v35
    v_pk_fma_f32 v[58:59], v[40:41], v[52:53], v[58:59] op_sel:[1,1,0] op_sel_hi:[1,0,1] neg_lo:[1,0,0]
    ds_write_addtid_b32 v136 offset:10064
    v_pk_mul_f32 v[56:57], v[34:35], v[38:39] op_sel:[0,0] op_sel_hi:[0,1]
    v_cvt_pk_bf16_f32 v142, v58, v59
    v_pk_fma_f32 v[56:57], v[34:35], v[38:39], v[56:57] op_sel:[1,1,0] op_sel_hi:[1,0,1] neg_lo:[1,0,0]
    ds_write_addtid_b32 v142 offset:2992
    v_cvt_pk_bf16_f32 v137, v56, -v57
    ds_write_addtid_b32 v137 offset:10336
    v_pk_mul_f32 v[60:61], v[40:41], v[40:41] op_sel:[0,0] op_sel_hi:[0,1]
    v_pk_mul_f32 v[34:35], v[56:57], v[38:39] op_sel:[0,0] op_sel_hi:[0,1]
    v_pk_fma_f32 v[34:35], v[56:57], v[38:39], v[34:35] op_sel:[1,1,0] op_sel_hi:[1,0,1] neg_lo:[1,0,0]
    v_pk_fma_f32 v[60:61], v[40:41], v[40:41], v[60:61] op_sel:[1,1,0] op_sel_hi:[1,0,1] neg_lo:[1,0,0]
    v_cvt_pk_bf16_f32 v138, v34, -v35
    v_cvt_pk_bf16_f32 v143, v60, v61
    ds_write_addtid_b32 v138 offset:10608
    v_pk_mul_f32 v[56:57], v[34:35], v[38:39] op_sel:[0,0] op_sel_hi:[0,1]
    ds_write_addtid_b32 v143 offset:3264
    v_pk_fma_f32 v[56:57], v[34:35], v[38:39], v[56:57] op_sel:[1,1,0] op_sel_hi:[1,0,1] neg_lo:[1,0,0]
    v_pk_mul_f32 v[58:59], v[60:61], v[48:49] op_sel:[0,0] op_sel_hi:[0,1]
    v_cvt_pk_bf16_f32 v139, v56, -v57
    ds_write_addtid_b32 v139 offset:10880
    v_pk_fma_f32 v[58:59], v[60:61], v[48:49], v[58:59] op_sel:[1,1,0] op_sel_hi:[1,0,1] neg_lo:[1,0,0]
    v_pk_mul_f32 v[34:35], v[56:57], v[38:39] op_sel:[0,0] op_sel_hi:[0,1]
    v_pk_fma_f32 v[34:35], v[56:57], v[38:39], v[34:35] op_sel:[1,1,0] op_sel_hi:[1,0,1] neg_lo:[1,0,0]
    v_cvt_pk_bf16_f32 v140, v58, v59
    v_cvt_pk_bf16_f32 v136, v34, -v35
    ds_write_addtid_b32 v140 offset:3536
    ds_write_addtid_b32 v136 offset:11152
    v_pk_mul_f32 v[56:57], v[34:35], v[38:39] op_sel:[0,0] op_sel_hi:[0,1]
    v_pk_mul_f32 v[62:63], v[60:61], v[40:41] op_sel:[0,0] op_sel_hi:[0,1]
    v_pk_fma_f32 v[56:57], v[34:35], v[38:39], v[56:57] op_sel:[1,1,0] op_sel_hi:[1,0,1] neg_lo:[1,0,0]
    v_pk_fma_f32 v[62:63], v[60:61], v[40:41], v[62:63] op_sel:[1,1,0] op_sel_hi:[1,0,1] neg_lo:[1,0,0]
    v_cvt_pk_bf16_f32 v137, v56, -v57
    ds_write_addtid_b32 v137 offset:11424
    v_cvt_pk_bf16_f32 v141, v62, v63
    v_pk_mul_f32 v[34:35], v[56:57], v[38:39] op_sel:[0,0] op_sel_hi:[0,1]
    v_pk_fma_f32 v[34:35], v[56:57], v[38:39], v[34:35] op_sel:[1,1,0] op_sel_hi:[1,0,1] neg_lo:[1,0,0]
    ds_write_addtid_b32 v141 offset:3808
    v_cvt_pk_bf16_f32 v138, v34, -v35
    v_pk_mul_f32 v[58:59], v[62:63], v[48:49] op_sel:[0,0] op_sel_hi:[0,1]
    ds_write_addtid_b32 v138 offset:11696
    v_pk_mul_f32 v[56:57], v[34:35], v[38:39] op_sel:[0,0] op_sel_hi:[0,1]
    v_pk_fma_f32 v[58:59], v[62:63], v[48:49], v[58:59] op_sel:[1,1,0] op_sel_hi:[1,0,1] neg_lo:[1,0,0]
    v_pk_fma_f32 v[56:57], v[34:35], v[38:39], v[56:57] op_sel:[1,1,0] op_sel_hi:[1,0,1] neg_lo:[1,0,0]
    v_cvt_pk_bf16_f32 v139, v56, -v57
    v_cvt_pk_bf16_f32 v142, v58, v59
    ds_write_addtid_b32 v139 offset:11968
    ds_write_addtid_b32 v142 offset:4080
    v_pk_mul_f32 v[34:35], v[56:57], v[38:39] op_sel:[0,0] op_sel_hi:[0,1]
    v_pk_fma_f32 v[34:35], v[56:57], v[38:39], v[34:35] op_sel:[1,1,0] op_sel_hi:[1,0,1] neg_lo:[1,0,0]
    v_pk_mul_f32 v[60:61], v[62:63], v[40:41] op_sel:[0,0] op_sel_hi:[0,1]
    v_cvt_pk_bf16_f32 v136, v34, -v35
    v_pk_fma_f32 v[60:61], v[62:63], v[40:41], v[60:61] op_sel:[1,1,0] op_sel_hi:[1,0,1] neg_lo:[1,0,0]
    ds_write_addtid_b32 v136 offset:12240
    v_pk_mul_f32 v[56:57], v[34:35], v[38:39] op_sel:[0,0] op_sel_hi:[0,1]
    v_cvt_pk_bf16_f32 v143, v60, v61
    v_pk_fma_f32 v[56:57], v[34:35], v[38:39], v[56:57] op_sel:[1,1,0] op_sel_hi:[1,0,1] neg_lo:[1,0,0]
    v_cvt_pk_bf16_f32 v137, v56, -v57
    ds_write_addtid_b32 v143 offset:4352
    ds_write_addtid_b32 v137 offset:12512
    v_pk_mul_f32 v[62:63], v[60:61], v[40:41] op_sel:[0,0] op_sel_hi:[0,1]
    v_pk_mul_f32 v[34:35], v[56:57], v[38:39] op_sel:[0,0] op_sel_hi:[0,1]
    v_pk_fma_f32 v[34:35], v[56:57], v[38:39], v[34:35] op_sel:[1,1,0] op_sel_hi:[1,0,1] neg_lo:[1,0,0]
    v_pk_fma_f32 v[62:63], v[60:61], v[40:41], v[62:63] op_sel:[1,1,0] op_sel_hi:[1,0,1] neg_lo:[1,0,0]
    v_cvt_pk_bf16_f32 v138, v34, -v35
    v_cvt_pk_bf16_f32 v140, v62, v63
    ds_write_addtid_b32 v138 offset:12784
    v_pk_mul_f32 v[56:57], v[34:35], v[38:39] op_sel:[0,0] op_sel_hi:[0,1]
    ds_write_addtid_b32 v140 offset:4624
    v_pk_fma_f32 v[56:57], v[34:35], v[38:39], v[56:57] op_sel:[1,1,0] op_sel_hi:[1,0,1] neg_lo:[1,0,0]
    v_cvt_pk_bf16_f32 v139, v56, -v57
    v_pk_mul_f32 v[60:61], v[62:63], v[40:41] op_sel:[0,0] op_sel_hi:[0,1]
    ds_write_addtid_b32 v139 offset:13056
    v_pk_fma_f32 v[60:61], v[62:63], v[40:41], v[60:61] op_sel:[1,1,0] op_sel_hi:[1,0,1] neg_lo:[1,0,0]
    v_pk_mul_f32 v[34:35], v[56:57], v[38:39] op_sel:[0,0] op_sel_hi:[0,1]
    v_pk_fma_f32 v[34:35], v[56:57], v[38:39], v[34:35] op_sel:[1,1,0] op_sel_hi:[1,0,1] neg_lo:[1,0,0]
    v_cvt_pk_bf16_f32 v141, v60, v61
    v_cvt_pk_bf16_f32 v136, v34, -v35
    ds_write_addtid_b32 v136 offset:13328
    ds_write_addtid_b32 v141 offset:4896
    v_pk_mul_f32 v[56:57], v[34:35], v[38:39] op_sel:[0,0] op_sel_hi:[0,1]
    v_pk_mul_f32 v[62:63], v[60:61], v[40:41] op_sel:[0,0] op_sel_hi:[0,1]
    v_pk_fma_f32 v[56:57], v[34:35], v[38:39], v[56:57] op_sel:[1,1,0] op_sel_hi:[1,0,1] neg_lo:[1,0,0]
    v_cvt_pk_bf16_f32 v137, v56, -v57
    v_pk_fma_f32 v[62:63], v[60:61], v[40:41], v[62:63] op_sel:[1,1,0] op_sel_hi:[1,0,1] neg_lo:[1,0,0]
    ds_write_addtid_b32 v137 offset:13600
    v_cvt_pk_bf16_f32 v142, v62, v63
    v_pk_mul_f32 v[34:35], v[56:57], v[38:39] op_sel:[0,0] op_sel_hi:[0,1]
    v_pk_fma_f32 v[34:35], v[56:57], v[38:39], v[34:35] op_sel:[1,1,0] op_sel_hi:[1,0,1] neg_lo:[1,0,0]
    ds_write_addtid_b32 v142 offset:5168
    v_cvt_pk_bf16_f32 v138, v34, -v35
    ds_write_addtid_b32 v138 offset:13872
    v_pk_mul_f32 v[60:61], v[62:63], v[40:41] op_sel:[0,0] op_sel_hi:[0,1]
    v_pk_mul_f32 v[56:57], v[34:35], v[38:39] op_sel:[0,0] op_sel_hi:[0,1]
    v_pk_fma_f32 v[60:61], v[62:63], v[40:41], v[60:61] op_sel:[1,1,0] op_sel_hi:[1,0,1] neg_lo:[1,0,0]
    v_pk_fma_f32 v[56:57], v[34:35], v[38:39], v[56:57] op_sel:[1,1,0] op_sel_hi:[1,0,1] neg_lo:[1,0,0]
    v_cvt_pk_bf16_f32 v139, v56, -v57
    v_cvt_pk_bf16_f32 v143, v60, v61
    ds_write_addtid_b32 v139 offset:14144
    ds_write_addtid_b32 v143 offset:5440
    ds_read_b128 v[160:163], v128 offset:0
    ds_read_b128 v[164:167], v128 offset:5712
    ds_read_b128 v[168:171], v128 offset:32
    ds_read_b128 v[172:175], v128 offset:5744
    ds_read_b128 v[176:179], v128 offset:64
    ds_read_b128 v[180:183], v128 offset:5776
    ds_read_b128 v[184:187], v128 offset:96
    ds_read_b128 v[188:191], v128 offset:5808
    ds_read_b128 v[192:195], v128 offset:128
    ds_read_b128 v[196:199], v128 offset:5840
    ds_read_b128 v[200:203], v128 offset:160
    ds_read_b128 v[204:207], v128 offset:5872
    ds_read_b128 v[208:211], v128 offset:192
    ds_read_b128 v[212:215], v128 offset:5904
    ds_read_b128 v[216:219], v128 offset:224
    ds_read_b128 v[220:223], v128 offset:5936
    s_waitcnt lgkmcnt(14)
    v_mfma_f32_32x32x16_bf16 v[64:79], v[160:163], v[164:167], v[64:79]
    s_waitcnt lgkmcnt(12)
    v_mfma_f32_32x32x16_bf16 v[64:79], v[168:171], v[172:175], v[64:79]
    s_waitcnt lgkmcnt(10)
    v_mfma_f32_32x32x16_bf16 v[64:79], v[176:179], v[180:183], v[64:79]
    s_waitcnt lgkmcnt(8)
    v_mfma_f32_32x32x16_bf16 v[64:79], v[184:187], v[188:191], v[64:79]
    s_waitcnt lgkmcnt(6)
    v_mfma_f32_32x32x16_bf16 v[64:79], v[192:195], v[196:199], v[64:79]
    s_waitcnt lgkmcnt(4)
    v_mfma_f32_32x32x16_bf16 v[64:79], v[200:203], v[204:207], v[64:79]
    s_waitcnt lgkmcnt(2)
    v_mfma_f32_32x32x16_bf16 v[64:79], v[208:211], v[212:215], v[64:79]
    s_waitcnt lgkmcnt(0)
    v_mfma_f32_32x32x16_bf16 v[64:79], v[216:219], v[220:223], v[64:79]
    v_mov_b32 v4, 0
    v_mov_b32 v5, 0
    v_mov_b32 v6, 0
    v_mov_b32 v7, 0
    ds_write_b128 v133, v[4:7]
    s_nop 6
    ds_write_b128 v129, v[64:67]
    ds_write_b64 v130, v[68:69]
    ds_write_b64 v131, v[70:71]
    ds_write2_b32 v132, v72, v73 offset0:0 offset1:32
    ds_write2_b32 v132, v74, v75 offset0:64 offset1:96
    v_mov_b32 v2, 0
    v_mov_b32 v3, 1
    s_mov_b64 exec, 1
    ds_add_u32 v2, v3 offset:64896
    s_mov_b64 exec, -1
    s_waitcnt lgkmcnt(0)
JOIN_A:
    s_lshl_b32 s12, s3, 11
    s_add_u32 s12, s12, 4096
    s_lshl_b32 s13, s41, 4
    s_add_u32 s13, s13, 32768
    s_cmp_eq_u32 s3, 5
    s_cselect_b32 s13, s13, 33554432
    s_cselect_b32 s20, 24, 0
    s_lshr_b32 s14, s41, 1
    s_lshl_b32 s14, s14, 14
    s_add_u32 s14, s14, 1048576
    v_cmp_gt_u32_e64 s[22:23], s20, v1
    v_mov_b32 v2, 33554432
    s_nop 0
    v_cndmask_b32_e64 v17, v2, v17, s[22:23]
    s_setprio 0
    v_mov_b32 v2, 0
    s_mov_b32 s15, 0
    s_branch KWC
KW:
    s_sleep 1
KWC:
    ds_read_b32 v3, v2 offset:64896
    s_add_u32 s15, s15, 1
    s_waitcnt lgkmcnt(0)
    v_cmp_gt_u32 vcc, 4, v3
    s_cmp_gt_u32 s15, 200000
    s_cbranch_scc1 KWX
    s_cbranch_vccnz KW
KWX:
    s_mov_b32 s15, 0
    s_lshl_b32 s21, s47, 3
    s_add_u32 s21, s21, s35
    s_lshl_b32 s21, s21, 3
    s_add_u32 s21, s21, s3
    s_lshl_b32 s21, s21, 10
    s_add_u32 s21, s21, 18874368
    v_mov_b32 v84, -1
    v_mov_b32 v85, -1
    v_mov_b32 v86, -1
    v_mov_b32 v87, -1
    buffer_store_dwordx4 v[84:87], v26, s[4:7], s21 offen sc1
    v_lshlrev_b32 v2, 3, v0
    v_mov_b32 v44, 0
    v_mov_b32 v45, 0
    v_mov_b32 v46, 0
    v_mov_b32 v47, 0
    ds_read2st64_b32 v[48:49], v8 offset0:0 offset1:57
    ds_read2st64_b32 v[50:51], v9 offset0:0 offset1:57
    ds_read2st64_b32 v[52:53], v10 offset0:0 offset1:57
    ds_read2st64_b32 v[54:55], v11 offset0:0 offset1:57
    ds_read2st64_b32 v[56:57], v12 offset0:0 offset1:57
    ds_read2st64_b32 v[58:59], v13 offset0:0 offset1:57
    ds_read2st64_b32 v[60:61], v14 offset0:0 offset1:57
    ds_write_b64 v31, v[44:45] offset:4096
    s_waitcnt lgkmcnt(7)
    v_add_f32 v48, v48, v49
    s_waitcnt lgkmcnt(6)
    v_add_f32 v50, v50, v51
    s_waitcnt lgkmcnt(5)
    v_add_f32 v52, v52, v53
    s_waitcnt lgkmcnt(4)
    v_add_f32 v54, v54, v55
    s_waitcnt lgkmcnt(3)
    v_add_f32 v56, v56, v57
    s_waitcnt lgkmcnt(2)
    v_add_f32 v58, v58, v59
    s_waitcnt lgkmcnt(1)
    v_add_f32 v60, v60, v61
    v_cvt_pk_bf16_f32 v49, v48, v50
    v_cvt_pk_bf16_f32 v51, v50, v52
    v_cvt_pk_bf16_f32 v53, v52, v54
    v_cvt_pk_bf16_f32 v55, v54, v56
    v_cvt_pk_bf16_f32 v57, v56, v58
    v_cvt_pk_bf16_f32 v59, v58, v60
    v_add_u32 v3, 0, v2
    ds_write2_b32 v3, v55, v59 offset0:0 offset1:1
    v_add_u32 v4, 4160, v2
    ds_write2_b32 v4, v53, v57 offset0:0 offset1:1
    v_add_u32 v5, 14720, v2
    ds_write2_b32 v5, v51, v55 offset0:0 offset1:1
    v_add_u32 v6, 18880, v2
    ds_write2_b32 v6, v49, v53 offset0:0 offset1:1
    ds_read2st64_b32 v[64:65], v8 offset0:114 offset1:171
    ds_read2st64_b32 v[66:67], v9 offset0:114 offset1:171
    ds_read2st64_b32 v[68:69], v10 offset0:114 offset1:171
    ds_read2st64_b32 v[70:71], v11 offset0:114 offset1:171
    ds_read2st64_b32 v[72:73], v12 offset0:114 offset1:171
    ds_read2st64_b32 v[74:75], v13 offset0:114 offset1:171
    ds_read2st64_b32 v[76:77], v14 offset0:114 offset1:171
    s_waitcnt lgkmcnt(6)
    v_add_f32 v64, v64, v65
    s_waitcnt lgkmcnt(5)
    v_add_f32 v66, v66, v67
    s_waitcnt lgkmcnt(4)
    v_add_f32 v68, v68, v69
    s_waitcnt lgkmcnt(3)
    v_add_f32 v70, v70, v71
    s_waitcnt lgkmcnt(2)
    v_add_f32 v72, v72, v73
    s_waitcnt lgkmcnt(1)
    v_add_f32 v74, v74, v75
    s_waitcnt lgkmcnt(0)
    v_add_f32 v76, v76, v77
    v_cvt_pk_bf16_f32 v65, v64, v66
    v_cvt_pk_bf16_f32 v67, v66, v68
    v_cvt_pk_bf16_f32 v69, v68, v70
    v_cvt_pk_bf16_f32 v71, v70, v72
    v_cvt_pk_bf16_f32 v73, v72, v74
    v_cvt_pk_bf16_f32 v75, v74, v76
    v_add_u32 v3, 29184, v2
    ds_write2_b32 v3, v71, v75 offset0:0 offset1:1
    v_add_u32 v4, 33344, v2
    ds_write2_b32 v4, v69, v73 offset0:0 offset1:1
    v_add_u32 v5, 43904, v2
    ds_write2_b32 v5, v67, v71 offset0:0 offset1:1
    v_add_u32 v6, 48064, v2
    ds_write2_b32 v6, v65, v69 offset0:0 offset1:1
    buffer_load_dwordx4 v[32:35], v26, s[4:7], s12 offen sc1
    buffer_load_dwordx4 v[36:39], v26, s[4:7], s12 offen offset:1024 sc1
    buffer_load_dwordx4 v[40:43], v17, s[4:7], s13 offen sc1
    s_waitcnt lgkmcnt(0)
    s_branch POLL1C
POLL1:
    buffer_load_dwordx4 v[32:35], v26, s[4:7], s12 offen sc1
    buffer_load_dwordx4 v[36:39], v26, s[4:7], s12 offen offset:1024 sc1
    buffer_load_dwordx4 v[40:43], v17, s[4:7], s13 offen sc1
POLL1C:
    s_add_u32 s15, s15, 1
    s_waitcnt vmcnt(2)
    v_xor_b32 v33, s40, v33
    v_xor_b32 v35, s40, v35
    s_waitcnt vmcnt(1)
    v_xor_b32 v37, s40, v37
    v_xor_b32 v39, s40, v39
    v_or3_b32 v33, v33, v35, v37
    s_waitcnt vmcnt(0)
    v_xor_b32 v41, s40, v41
    v_xor_b32 v43, s40, v43
    v_or_b32 v41, v41, v43
    v_cndmask_b32_e64 v41, 0, v41, s[22:23]
    v_or3_b32 v33, v33, v39, v41
    v_cmp_ne_u32 vcc, 0, v33
    s_cmp_gt_u32 s15, 200000
    s_cbranch_scc1 POLL1X
    s_cbranch_vccnz POLL1
POLL1X:
    buffer_load_dwordx4 v[8:11], v16, s[4:7], s14 offen sc1
    ds_write2_b32 v18, v32, v34 offset0:0 offset1:1
    ds_write2_b32 v18, v36, v38 offset0:128 offset1:129
    ds_read_b128 v[48:51], v19
    ds_read_b128 v[52:55], v19 offset:16
    v_add_f32_dpp v40, v40, v40 quad_perm:[1,0,3,2] row_mask:0xf bank_mask:0xf
    v_add_f32_dpp v42, v42, v42 quad_perm:[1,0,3,2] row_mask:0xf bank_mask:0xf
    v_and_b32 v2, 60, v1
    v_add_u32 v2, 64768, v2
    v_add_f32_dpp v40, v40, v40 quad_perm:[2,3,0,1] row_mask:0xf bank_mask:0xf
    v_add_f32_dpp v42, v42, v42 quad_perm:[2,3,0,1] row_mask:0xf bank_mask:0xf
    v_mov_b32 v3, 64832
    v_cndmask_b32_e64 v2, v3, v2, s[22:23]
    v_cvt_pk_bf16_f32 v40, v40, v42
    ds_write_b32 v2, v40
    v_and_b32 v2, 31, v1
    v_min_u32 v2, 29, v2
    v_lshrrev_b32 v3, 5, v1
    v_mul_u32_u24 v3, 29248, v3
    v_lshl_add_u32 v4, v2, 4, v3
    v_mov_b32 v3, 64768
    s_waitcnt lgkmcnt(0)
    s_barrier
    s_lshr_b32 s12, s3, 1
    s_mul_i32 s12, s12, 7168
    s_add_u32 s12, s12, s32
    s_add_u32 s13, s12, 917504
    buffer_load_dwordx4 v[76:79], v26, s[16:19], s13 offen
    buffer_load_dwordx4 v[80:83], v26, s[16:19], s13 offen offset:3584
    ds_read_b128 v[32:35], v3
    ds_read_b64 v[36:37], v3 offset:16
    ds_write_b128 v4, v[44:47] offset:8448
    v_and_b32 v56, 0xffff0000, v48
    v_rcp_f32 v56, v56
    v_lshlrev_b32 v48, 16, v48
    v_and_b32 v57, 0xffff0000, v49
    v_rcp_f32 v57, v57
    v_lshlrev_b32 v49, 16, v49
    v_and_b32 v58, 0xffff0000, v50
    v_rcp_f32 v58, v58
    v_lshlrev_b32 v50, 16, v50
    v_and_b32 v59, 0xffff0000, v51
    v_rcp_f32 v59, v59
    v_lshlrev_b32 v51, 16, v51
    v_and_b32 v60, 0xffff0000, v52
    v_rcp_f32 v60, v60
    v_lshlrev_b32 v52, 16, v52
    v_and_b32 v61, 0xffff0000, v53
    v_rcp_f32 v61, v61
    v_lshlrev_b32 v53, 16, v53
    v_and_b32 v62, 0xffff0000, v54
    v_rcp_f32 v62, v62
    v_lshlrev_b32 v54, 16, v54
    v_and_b32 v63, 0xffff0000, v55
    v_rcp_f32 v63, v63
    v_lshlrev_b32 v55, 16, v55
    v_and_b32 v2, 2, v0
    v_lshlrev_b32 v2, 3, v2
    s_waitcnt lgkmcnt(1)
    v_lshlrev_b32 v38, 16, v36
    v_and_b32 v39, 0xffff0000, v36
    v_add_f32 v38, 1.0, v38
    v_add_f32 v39, 1.0, v39
    v_cvt_pk_bf16_f32 v4, v38, v39
    v_mov_b32 v5, v35
    v_mov_b32 v6, v37
    v_mov_b32 v7, s40
    s_lshl_b32 s12, s41, 4
    s_add_u32 s12, s12, 327680
    s_cmp_lg_u32 s3, 0
    s_cselect_b32 s12, 33554432, s12
    s_mov_b64 exec, 1
    buffer_store_dwordx4 v[4:7], v26, s[4:7], s12 offen sc1
    s_mov_b64 exec, -1
    v_lshrrev_b32 v32, v2, v32
    v_lshrrev_b32 v33, v2, v33
    v_lshrrev_b32 v42, v2, v34
    v_lshrrev_b32 v43, v2, v4
    v_lshlrev_b32 v33, 16, v33
    v_lshlrev_b32 v32, 16, v32
    v_add_f32 v33, 1.0, v33
    v_lshlrev_b32 v42, 16, v42
    v_cvt_pk_bf16_f32 v33, v33, v33
    v_lshlrev_b32 v43, 16, v43
    v_lshlrev_b32 v33, 16, v33
    v_mul_f32 v56, v56, v33
    v_fma_f32 v48, -v48, v56, v32
    v_mul_f32 v57, v57, v33
    v_fma_f32 v49, -v49, v57, v32
    v_mul_f32 v58, v58, v33
    v_fma_f32 v50, -v50, v58, v32
    v_mul_f32 v59, v59, v33
    v_fma_f32 v51, -v51, v59, v32
    v_mul_f32 v60, v60, v33
    v_fma_f32 v52, -v52, v60, v32
    v_mul_f32 v61, v61, v33
    v_fma_f32 v53, -v53, v61, v32
    v_mul_f32 v62, v62, v33
    v_fma_f32 v54, -v54, v62, v32
    v_mul_f32 v63, v63, v33
    v_fma_f32 v55, -v55, v63, v32
    v_bfe_u32 v2, v0, 1, 1
    v_mul_u32_u24 v2, 25088, v2
    v_sub_u32 v12, v21, v2
    s_cmp_eq_u32 s34, 7
    s_cselect_b32 s18, 0, s18
    s_cmp_lt_u32 s3, 4
    s_cbranch_scc1 CONV
    v_add_u32 v2, 131072, v25
    ds_read_b64_tr_b16 v[128:129], v2 offset:0
    ds_read_b64_tr_b16 v[130:131], v2 offset:2048
    ds_read_b64_tr_b16 v[132:133], v2 offset:16384
    ds_read_b64_tr_b16 v[134:135], v2 offset:18432
    ds_read_b64_tr_b16 v[136:137], v2 offset:4096
    ds_read_b64_tr_b16 v[138:139], v2 offset:6144
    ds_read_b64_tr_b16 v[140:141], v2 offset:20480
    ds_read_b64_tr_b16 v[142:143], v2 offset:22528
    ds_read_b64_tr_b16 v[144:145], v2 offset:8192
    ds_read_b64_tr_b16 v[146:147], v2 offset:10240
    ds_read_b64_tr_b16 v[148:149], v2 offset:24576
    ds_read_b64_tr_b16 v[150:151], v2 offset:26624
    ds_read_b64_tr_b16 v[152:153], v2 offset:12288
    ds_read_b64_tr_b16 v[154:155], v2 offset:14336
    ds_read_b64_tr_b16 v[156:157], v2 offset:28672
    ds_read_b64_tr_b16 v[158:159], v2 offset:30720
    s_waitcnt vmcnt(3)
    v_lshlrev_b32 v34, 16, v8
    v_and_b32 v35, 0xffff0000, v8
    v_lshlrev_b32 v36, 16, v9
    v_and_b32 v37, 0xffff0000, v9
    v_lshlrev_b32 v38, 16, v10
    v_and_b32 v39, 0xffff0000, v10
    v_lshlrev_b32 v40, 16, v11
    v_and_b32 v41, 0xffff0000, v11
    v_fmac_f32 v48, v34, v56
    v_fmac_f32 v49, v35, v57
    v_fmac_f32 v50, v36, v58
    v_fmac_f32 v51, v37, v59
    v_fmac_f32 v52, v38, v60
    v_fmac_f32 v53, v39, v61
    v_fmac_f32 v54, v40, v62
    v_fmac_f32 v55, v41, v63
    v_cvt_pk_bf16_f32 v8, v48, v49
    v_cvt_pk_bf16_f32 v9, v50, v51
    v_cvt_pk_bf16_f32 v10, v52, v53
    v_cvt_pk_bf16_f32 v11, v54, v55
    ds_write_b128 v20, v[8:11] offset:8928
    s_waitcnt lgkmcnt(0)
    s_barrier
    v_and_b32 v13, 255, v0
    v_lshlrev_b32 v13, 4, v13
    s_cmp_lg_u32 s34, 7
    s_cbranch_scc1 STG
    s_and_b32 s12, s43, 3
    s_lshl_b32 s12, s12, 2
    s_and_b32 s13, s3, 3
    s_add_u32 s12, s12, s13
    s_lshl_b32 s12, s12, 12
    s_and_b32 s13, s42, 1
    s_mul_i32 s13, s13, 917504
    s_add_u32 s13, s12, s13
    s_add_u32 s12, s13, 65536
    buffer_load_dwordx4 v[128:131], v26, s[36:39], s12 offen offset:0
    buffer_load_dwordx4 v[132:135], v26, s[36:39], s12 offen offset:1024
    buffer_load_dwordx4 v[136:139], v26, s[36:39], s12 offen offset:2048
    buffer_load_dwordx4 v[140:143], v26, s[36:39], s12 offen offset:3072
    s_add_u32 s12, s13, 196608
    buffer_load_dwordx4 v[144:147], v26, s[36:39], s12 offen offset:0
    buffer_load_dwordx4 v[148:151], v26, s[36:39], s12 offen offset:1024
    buffer_load_dwordx4 v[152:155], v26, s[36:39], s12 offen offset:2048
    buffer_load_dwordx4 v[156:159], v26, s[36:39], s12 offen offset:3072
    s_add_u32 s12, s13, 327680
    buffer_load_dwordx4 v[160:163], v26, s[36:39], s12 offen offset:0
    buffer_load_dwordx4 v[164:167], v26, s[36:39], s12 offen offset:1024
    buffer_load_dwordx4 v[168:171], v26, s[36:39], s12 offen offset:2048
    buffer_load_dwordx4 v[172:175], v26, s[36:39], s12 offen offset:3072
    s_add_u32 s12, s13, 458752
    buffer_load_dwordx4 v[176:179], v26, s[36:39], s12 offen offset:0
    buffer_load_dwordx4 v[180:183], v26, s[36:39], s12 offen offset:1024
    buffer_load_dwordx4 v[184:187], v26, s[36:39], s12 offen offset:2048
    buffer_load_dwordx4 v[188:191], v26, s[36:39], s12 offen offset:3072
    v_lshlrev_b32 v20, 3, v1
    v_and_b32 v2, 15, v1
    v_lshlrev_b32 v19, 4, v2
    v_and_b32 v2, 31, v1
    v_lshrrev_b32 v3, 5, v1
    v_mul_u32_u24 v3, 57344, v3
    v_lshl_add_u32 v18, v2, 4, v3
    v_lshrrev_b32 v2, 3, v1
    v_and_b32 v3, 7, v1
    v_and_b32 v4, 6, v2
    v_xor_b32 v3, v3, v4
    v_lshlrev_b32 v2, 10, v2
    v_lshl_add_u32 v104, v3, 4, v2
    v_add_u32 v105, 7168, v104
    v_add_u32 v106, 14336, v104
    v_add_u32 v107, 21504, v104
    v_and_b32 v2, 1, v1
    v_lshrrev_b32 v3, 4, v1
    v_lshlrev_b32 v2, 4, v2
    v_lshl_add_u32 v2, v3, 5, v2
    v_add_u32 v17, 155648, v2
    s_lshr_b32 s28, s43, 4
    s_lshl_b32 s13, s42, 1
    s_add_u32 s28, s28, s13
    s_lshl_b32 s13, s3, 4
    s_add_u32 s28, s28, s13
    s_mul_i32 s28, s28, 384
    s_and_b32 s30, s2, 15
    s_lshl_b32 s30, s30, 4
    s_and_b32 s13, s3, 3
    s_add_u32 s30, s30, s13
    s_mul_i32 s30, s30, 384
    s_mov_b32 s32, 1
    s_and_b32 s12, s42, 1
    s_mul_i32 s20, s12, 917504
    s_lshl_b32 s14, s35, 7
    s_add_u32 s20, s20, s14
    s_and_b32 s12, s3, 1
    s_lshl_b32 s12, s12, 15
    s_add_u32 s20, s20, s12
    s_and_b32 s27, s3, 3
    s_lshl_b32 s27, s27, 12
    s_lshl_b32 s22, s44, 17
    s_lshl_b32 s14, s46, 16
    s_add_u32 s22, s22, s14
    s_add_u32 s22, s22, s27
    s_add_u32 s22, s22, 5242880
    s_mul_i32 s24, s44, 458752
    s_lshl_b32 s12, s45, 12
    s_lshl_b32 s13, s3, 9
    s_add_u32 s24, s24, s12
    s_add_u32 s24, s24, s13
    s_add_u32 s24, s24, 8388608
    s_lshl_b32 s25, s44, 11
    s_add_u32 s25, s25, 163840
    s_xor_b32 s41, s45, s46
    s_and_b32 s41, s41, 1
    s_lshl_b32 s26, s44, 1
    s_add_u32 s26, s26, s46
    s_lshl_b32 s26, s26, 3
    s_lshr_b32 s12, s3, 2
    s_add_u32 s26, s26, s12
    s_mul_i32 s26, s26, 384
    s_bfe_u32 s12, s3, 0x10001
    s_lshl_b32 s13, s12, 17
    s_add_u32 s20, s20, s13
    s_lshl_b32 s12, s12, 7
    s_add_u32 s26, s26, s12
    s_lshl_b32 s12, s46, 10
    s_add_u32 s13, s12, 159744
    v_add_u32 v124, s13, v19
    s_xor_b32 s12, s12, 1024
    s_lshl_b32 s13, s41, 9
    s_add_u32 s12, s12, s13
    s_add_u32 s13, s12, 159744
    v_add_u32 v7, s13, v19
    s_lshl_b32 s12, s41, 15
    s_xor_b32 s12, s12, 65536
    s_xor_b32 s44, s12, s22
    s_xor_b32 s12, s46, 1
    s_lshl_b32 s12, s12, 1
    s_mul_i32 s13, s46, 229376
    s_add_u32 s12, s12, s41
    s_mul_i32 s45, s12, 114688
    s_xor_b32 s12, s12, 1
    s_mul_i32 s46, s12, 114688
    s_add_u32 s45, s45, s24
    s_add_u32 s46, s46, s24
    s_add_u32 s24, s24, s13
    s_lshr_b32 s12, s3, 2
    s_sub_u32 s12, s41, s12
    s_mul_i32 s12, s12, 384
    s_add_u32 s41, s26, s12
    s_and_b32 s29, s47, -2
    s_and_b32 s13, s42, 1
    s_add_u32 s29, s29, s13
    s_lshl_b32 s29, s29, 3
    s_and_b32 s13, s3, 1
    s_lshl_b32 s13, s13, 1
    s_add_u32 s29, s29, s13
    s_mul_i32 s29, s29, 384
    s_bfe_u32 s13, s3, 0x10001
    s_lshl_b32 s13, s13, 7
    s_add_u32 s29, s29, s13
    s_and_b32 s13, s3, 1
    s_mul_i32 s12, s13, 114688
    s_and_b32 s13, s42, 1
    s_mul_i32 s13, s13, 28672
    s_add_u32 s12, s12, s13
    s_bfe_u32 s14, s3, 0x10001
    s_lshl_b32 s14, s14, 10
    s_add_u32 s12, s12, s14
    s_add_u32 s12, s12, 8388608
    s_mul_i32 s1, s47, 229376
    s_add_u32 s1, s1, s12
    s_xor_b32 s0, s47, 1
    s_mul_i32 s0, s0, 229376
    s_add_u32 s0, s0, s12
    v_add_u32 v16, 57344, v26
    s_lshl_b32 s23, s47, 3
    s_add_u32 s23, s23, s35
    s_lshl_b32 s23, s23, 2
    s_and_b32 s13, s3, 3
    s_add_u32 s23, s23, s13
    s_lshl_b32 s23, s23, 11
    s_xor_b32 s21, s23, 65536
    s_add_u32 s23, s23, 18874368
    s_add_u32 s21, s21, 18874368
    v_bfe_u32 v2, v1, 2, 3
    v_lshrrev_b32 v3, 5, v1
    v_lshlrev_b32 v3, 11, v3
    v_lshl_add_u32 v3, v2, 7, v3
    v_lshrrev_b32 v2, 1, v2
    v_lshl_add_u32 v3, v2, 5, v3
    v_and_b32 v2, 3, v1
    v_lshl_add_u32 v3, v2, 3, v3
    s_bfe_u32 s12, s3, 0x10001
    s_lshl_b32 s12, s12, 12
    v_add_u32 v125, s12, v3
    v_and_b32 v2, 15, v1
    v_lshrrev_b32 v3, 4, v1
    v_xor_b32 v3, v3, v2
    v_lshlrev_b32 v2, 8, v2
    v_lshl_add_u32 v2, v3, 4, v2
    s_and_b32 s12, s3, 3
    s_lshl_b32 s12, s12, 13
    v_add_u32 v126, s12, v2
    v_lshrrev_b32 v2, 3, v1
    s_and_b32 s12, s3, 3
    s_lshl_b32 s12, s12, 4
    v_add_u32 v2, s12, v2
    v_and_b32 v3, 7, v0
    v_lshlrev_b32 v31, 10, v2
    v_lshl_add_u32 v31, v3, 4, v31
    v_lshlrev_b32 v3, 1, v3
    v_and_b32 v127, 15, v2
    v_xor_b32 v3, v3, v127
    v_lshlrev_b32 v3, 4, v3
    v_lshl_add_u32 v127, v2, 8, v3
    s_lshl_b32 s31, s47, 16
    s_lshl_b32 s13, s35, 7
    s_add_u32 s31, s31, s13
    v_and_b32 v2, 255, v0
    v_lshlrev_b32 v5, 3, v2
    v_and_b32 v3, 0x780, v5
    v_add_u32 v5, 157696, v5
    v_bfe_u32 v4, v2, 1, 2
    v_lshl_add_u32 v3, v4, 5, v3
    v_bfe_u32 v4, v2, 3, 1
    v_lshl_add_u32 v3, v4, 3, v3
    v_and_b32 v4, 1, v2
    v_lshl_add_u32 v4, v4, 2, v3
    v_add_u32 v4, 155648, v4
    s_mov_b32 s28, 327680
    s_branch STG_J
STG:
    s_and_b32 s13, s3, 1
    s_lshl_b32 s13, s13, 14
    s_bfe_u32 s14, s3, 0x10001
    s_mul_i32 s12, s14, 229376
    s_add_u32 s12, s12, s33
    s_add_u32 s12, s12, 458880
    s_mul_i32 s14, s14, 8192
    s_add_u32 s13, s13, s14
    s_add_u32 m0, s13, 65536
    s_nop 0
    buffer_load_dwordx4 v27, s[16:19], s12 offen offset:0 lds
    v_lshlrev_b32 v20, 3, v1
    v_and_b32 v2, 15, v1
    v_lshlrev_b32 v19, 4, v2
    v_and_b32 v2, 31, v1
    v_lshrrev_b32 v3, 5, v1
    v_mul_u32_u24 v3, 57344, v3
    buffer_load_dwordx4 v28, s[16:19], s12 offen offset:1024 lds
    v_lshl_add_u32 v18, v2, 4, v3
    v_lshrrev_b32 v2, 3, v1
    v_and_b32 v3, 7, v1
    v_and_b32 v4, 6, v2
    v_xor_b32 v3, v3, v4
    v_lshlrev_b32 v2, 10, v2
    buffer_load_dwordx4 v29, s[16:19], s12 offen offset:2048 lds
    v_lshl_add_u32 v104, v3, 4, v2
    v_add_u32 v105, 7168, v104
    v_add_u32 v106, 14336, v104
    v_add_u32 v107, 21504, v104
    v_and_b32 v2, 1, v1
    v_lshrrev_b32 v3, 4, v1
    buffer_load_dwordx4 v30, s[16:19], s12 offen offset:3072 lds
    v_lshlrev_b32 v2, 4, v2
    v_lshl_add_u32 v2, v3, 5, v2
    v_add_u32 v17, 155648, v2
    s_lshr_b32 s28, s43, 4
    s_lshl_b32 vcc_lo, s42, 1
    s_add_u32 s28, s28, vcc_lo
    s_add_u32 m0, m0, 4096
    s_lshl_b32 vcc_lo, s3, 4
    s_add_u32 s28, s28, vcc_lo
    s_mul_i32 s28, s28, 384
    s_and_b32 s30, s2, 15
    s_lshl_b32 s30, s30, 4
    s_and_b32 vcc_lo, s3, 3
    s_add_u32 s12, s12, 114688
    s_add_u32 s30, s30, vcc_lo
    s_mul_i32 s30, s30, 384
    s_mov_b32 s32, 1
    s_and_b32 s15, s42, 1
    s_mul_i32 s20, s15, 917504
    s_lshl_b32 vcc_hi, s35, 7
    buffer_load_dwordx4 v27, s[16:19], s12 offen offset:0 lds
    s_add_u32 s20, s20, vcc_hi
    s_and_b32 s15, s3, 1
    s_lshl_b32 s15, s15, 15
    s_add_u32 s20, s20, s15
    s_and_b32 s27, s3, 3
    s_lshl_b32 s27, s27, 12
    buffer_load_dwordx4 v28, s[16:19], s12 offen offset:1024 lds
    s_lshl_b32 s22, s44, 17
    s_lshl_b32 vcc_hi, s46, 16
    s_add_u32 s22, s22, vcc_hi
    s_add_u32 s22, s22, s27
    s_add_u32 s22, s22, 5242880
    s_mul_i32 s24, s44, 458752
    buffer_load_dwordx4 v29, s[16:19], s12 offen offset:2048 lds
    s_lshl_b32 s15, s45, 12
    s_lshl_b32 vcc_lo, s3, 9
    s_add_u32 s24, s24, s15
    s_add_u32 s24, s24, vcc_lo
    s_add_u32 s24, s24, 8388608
    s_lshl_b32 s25, s44, 11
    buffer_load_dwordx4 v30, s[16:19], s12 offen offset:3072 lds
    s_add_u32 s25, s25, 163840
    s_xor_b32 s41, s45, s46
    s_and_b32 s41, s41, 1
    s_lshl_b32 s26, s44, 1
    s_add_u32 s26, s26, s46
    s_lshl_b32 s26, s26, 3
    s_and_b32 s13, s3, 1
    s_lshr_b32 s15, s3, 2
    s_add_u32 s26, s26, s15
    s_mul_i32 s26, s26, 384
    s_bfe_u32 s15, s3, 0x10001
    s_lshl_b32 vcc_lo, s15, 17
    s_add_u32 s20, s20, vcc_lo
    s_lshl_b32 s13, s13, 14
    s_lshl_b32 s15, s15, 7
    s_add_u32 s26, s26, s15
    s_lshl_b32 s15, s46, 10
    s_add_u32 vcc_lo, s15, 159744
    v_add_u32 v124, vcc_lo, v19
    s_xor_b32 s15, s15, 1024
    s_bfe_u32 s14, s3, 0x10001
    s_lshl_b32 vcc_lo, s41, 9
    s_add_u32 s15, s15, vcc_lo
    s_add_u32 vcc_lo, s15, 159744
    v_add_u32 v7, vcc_lo, v19
    s_lshl_b32 s15, s41, 15
    s_xor_b32 s15, s15, 65536
    s_mul_i32 s12, s14, 229376
    s_xor_b32 s44, s15, s22
    s_xor_b32 s15, s46, 1
    s_lshl_b32 s15, s15, 1
    s_mul_i32 vcc_lo, s46, 229376
    s_add_u32 s15, s15, s41
    s_mul_i32 s45, s15, 114688
    s_add_u32 s12, s12, s33
    s_xor_b32 s15, s15, 1
    s_mul_i32 s46, s15, 114688
    s_add_u32 s45, s45, s24
    s_add_u32 s46, s46, s24
    s_add_u32 s24, s24, vcc_lo
    s_lshr_b32 s15, s3, 2
    s_add_u32 s12, s12, 917632
    s_sub_u32 s15, s41, s15
    s_mul_i32 s15, s15, 384
    s_add_u32 s41, s26, s15
    s_and_b32 s29, s47, -2
    s_and_b32 vcc_lo, s42, 1
    s_add_u32 s29, s29, vcc_lo
    s_mul_i32 s14, s14, 8192
    s_lshl_b32 s29, s29, 3
    s_and_b32 vcc_lo, s3, 1
    s_lshl_b32 vcc_lo, vcc_lo, 1
    s_add_u32 s29, s29, vcc_lo
    s_mul_i32 s29, s29, 384
    s_bfe_u32 vcc_lo, s3, 0x10001
    s_add_u32 s13, s13, s14
    s_lshl_b32 vcc_lo, vcc_lo, 7
    s_add_u32 s29, s29, vcc_lo
    s_and_b32 vcc_lo, s3, 1
    s_mul_i32 s15, vcc_lo, 114688
    s_and_b32 vcc_lo, s42, 1
    s_mul_i32 vcc_lo, vcc_lo, 28672
    s_add_u32 m0, s13, 98304
    s_add_u32 s15, s15, vcc_lo
    s_bfe_u32 vcc_hi, s3, 0x10001
    s_lshl_b32 vcc_hi, vcc_hi, 10
    s_add_u32 s15, s15, vcc_hi
    s_add_u32 s15, s15, 8388608
    s_mul_i32 s1, s47, 229376
    buffer_load_dwordx4 v27, s[16:19], s12 offen offset:0 lds
    s_add_u32 s1, s1, s15
    s_xor_b32 s0, s47, 1
    s_mul_i32 s0, s0, 229376
    s_add_u32 s0, s0, s15
    v_add_u32 v16, 57344, v26
    s_lshl_b32 s23, s47, 3
    buffer_load_dwordx4 v28, s[16:19], s12 offen offset:1024 lds
    s_add_u32 s23, s23, s35
    s_lshl_b32 s23, s23, 2
    s_and_b32 vcc_lo, s3, 3
    s_add_u32 s23, s23, vcc_lo
    s_lshl_b32 s23, s23, 11
    s_xor_b32 s21, s23, 65536
    buffer_load_dwordx4 v29, s[16:19], s12 offen offset:2048 lds
    s_add_u32 s23, s23, 18874368
    s_add_u32 s21, s21, 18874368
    v_bfe_u32 v2, v1, 2, 3
    v_lshrrev_b32 v3, 5, v1
    v_lshlrev_b32 v3, 11, v3
    v_lshl_add_u32 v3, v2, 7, v3
    buffer_load_dwordx4 v30, s[16:19], s12 offen offset:3072 lds
    v_lshrrev_b32 v2, 1, v2
    v_lshl_add_u32 v3, v2, 5, v3
    v_and_b32 v2, 3, v1
    v_lshl_add_u32 v3, v2, 3, v3
    s_bfe_u32 s15, s3, 0x10001
    s_lshl_b32 s15, s15, 12
    s_add_u32 m0, m0, 4096
    v_add_u32 v125, s15, v3
    v_and_b32 v2, 15, v1
    v_lshrrev_b32 v3, 4, v1
    v_xor_b32 v3, v3, v2
    v_lshlrev_b32 v2, 8, v2
    v_lshl_add_u32 v2, v3, 4, v2
    s_add_u32 s12, s12, 114688
    s_and_b32 s15, s3, 3
    s_lshl_b32 s15, s15, 13
    v_add_u32 v126, s15, v2
    v_lshrrev_b32 v2, 3, v1
    s_and_b32 s15, s3, 3
    s_lshl_b32 s15, s15, 4
    buffer_load_dwordx4 v27, s[16:19], s12 offen offset:0 lds
    v_add_u32 v2, s15, v2
    v_and_b32 v3, 7, v0
    v_lshlrev_b32 v31, 10, v2
    v_lshl_add_u32 v31, v3, 4, v31
    v_lshlrev_b32 v3, 1, v3
    v_and_b32 v127, 15, v2
    buffer_load_dwordx4 v28, s[16:19], s12 offen offset:1024 lds
    v_xor_b32 v3, v3, v127
    v_lshlrev_b32 v3, 4, v3
    v_lshl_add_u32 v127, v2, 8, v3
    s_lshl_b32 s31, s47, 16
    s_lshl_b32 vcc_lo, s35, 7
    s_add_u32 s31, s31, vcc_lo
    buffer_load_dwordx4 v29, s[16:19], s12 offen offset:2048 lds
    v_and_b32 v2, 255, v0
    v_lshlrev_b32 v5, 3, v2
    v_and_b32 v3, 0x780, v5
    v_add_u32 v5, 157696, v5
    v_bfe_u32 v4, v2, 1, 2
    v_lshl_add_u32 v3, v4, 5, v3
    buffer_load_dwordx4 v30, s[16:19], s12 offen offset:3072 lds
    v_bfe_u32 v4, v2, 3, 1
    v_lshl_add_u32 v3, v4, 3, v3
    v_and_b32 v4, 1, v2
    v_lshl_add_u32 v4, v4, 2, v3
    v_add_u32 v4, 155648, v4
    s_mov_b32 s28, 327680
STG_J:
    s_mov_b32 s15, 0
MPOLL:
    buffer_load_dwordx4 v[8:11], v13, s[4:7], s28 offen sc1
    s_add_u32 s15, s15, 1
    s_waitcnt vmcnt(0)
    v_cmp_ne_u32 vcc, s40, v11
    s_cmp_gt_u32 s15, 200000
    s_cbranch_scc1 MPOLLX
    s_cbranch_vccnz MPOLL
MPOLLX:
    v_and_b32 v11, 0xffff0000, v10
    v_lshlrev_b32 v10, 16, v10
    ds_write2_b32 v4, v8, v9 offset0:0 offset1:4
    ds_write_b64 v5, v[10:11]
    v_mov_b32 v2, 161792
    v_mov_b32 v3, 0
    ds_write2_b32 v2, v3, v3 offset0:0 offset1:1
    ds_write2_b32 v2, v3, v3 offset0:2 offset1:3
    s_waitcnt lgkmcnt(0)
    s_branch CONV_DONE
.p2align 12
CONV:
    ds_read_b64 v[128:129], v22 offset:3776
    ds_read_b64 v[130:131], v22 offset:3784
    ds_read_b64 v[136:137], v22 offset:3264
    ds_read_b64 v[138:139], v22 offset:3272
    ds_read_b64 v[144:145], v22 offset:2752
    ds_read_b64 v[146:147], v22 offset:2760
    ds_read_b64 v[152:153], v22 offset:2240
    ds_read_b64 v[154:155], v22 offset:2248
    ds_read_b64 v[160:161], v22 offset:1728
    ds_read_b64 v[162:163], v22 offset:1736
    ds_read_b64 v[168:169], v22 offset:1216
    ds_read_b64 v[170:171], v22 offset:1224
    ds_read_b64 v[176:177], v22 offset:704
    ds_read_b64 v[178:179], v22 offset:712
    ds_read_b64 v[184:185], v22 offset:192
    ds_read_b64 v[186:187], v22 offset:200
    s_waitcnt vmcnt(3)
    v_lshlrev_b32 v34, 16, v8
    v_and_b32 v35, 0xffff0000, v8
    v_lshlrev_b32 v36, 16, v9
    v_and_b32 v37, 0xffff0000, v9
    v_lshlrev_b32 v38, 16, v10
    v_and_b32 v39, 0xffff0000, v10
    v_lshlrev_b32 v40, 16, v11
    v_and_b32 v41, 0xffff0000, v11
    v_fmac_f32 v48, v34, v56
    v_fmac_f32 v49, v35, v57
    v_fmac_f32 v50, v36, v58
    v_fmac_f32 v51, v37, v59
    v_fmac_f32 v52, v38, v60
    v_fmac_f32 v53, v39, v61
    v_fmac_f32 v54, v40, v62
    v_fmac_f32 v55, v41, v63
    v_cvt_pk_bf16_f32 v8, v48, v49
    v_cvt_pk_bf16_f32 v9, v50, v51
    v_cvt_pk_bf16_f32 v10, v52, v53
    v_cvt_pk_bf16_f32 v11, v54, v55
    ds_write_b128 v20, v[8:11] offset:8928
    s_waitcnt lgkmcnt(0)
    s_barrier
    ds_read_b128 v[132:135], v23 offset:192
    ds_read_b128 v[140:143], v23 offset:704
    ds_read_b128 v[148:151], v23 offset:1216
    ds_read_b128 v[156:159], v23 offset:1728
    ds_read_b128 v[164:167], v23 offset:2240
    ds_read_b128 v[172:175], v23 offset:2752
    ds_read_b128 v[180:183], v23 offset:3264
    ds_read_b128 v[188:191], v23 offset:3776
    s_waitcnt lgkmcnt(7)
    v_mfma_f32_16x16x32_bf16 v[44:47], v[128:131], v[132:135], 0
    s_waitcnt lgkmcnt(6)
    v_mfma_f32_16x16x32_bf16 v[48:51], v[128:131], v[140:143], 0
    v_mfma_f32_16x16x32_bf16 v[48:51], v[136:139], v[132:135], v[48:51]
    s_waitcnt lgkmcnt(0)
    v_mfma_f32_16x16x32_bf16 v[52:55], v[128:131], v[148:151], 0
    ds_read_b64 v[192:193], v22 offset:3712
    v_lshlrev_b32 v20, 3, v1
    v_mfma_f32_16x16x32_bf16 v[52:55], v[136:139], v[140:143], v[52:55]
    ds_read_b64 v[194:195], v22 offset:3720
    v_and_b32 v2, 15, v1
    v_mfma_f32_16x16x32_bf16 v[52:55], v[144:147], v[132:135], v[52:55]
    ds_read_b128 v[196:199], v23 offset:128
    v_lshlrev_b32 v19, 4, v2
    v_mfma_f32_16x16x32_bf16 v[56:59], v[128:131], v[156:159], 0
    ds_read_b64 v[200:201], v22 offset:3200
    v_and_b32 v2, 31, v1
    v_mfma_f32_16x16x32_bf16 v[56:59], v[136:139], v[148:151], v[56:59]
    ds_read_b64 v[202:203], v22 offset:3208
    v_lshrrev_b32 v3, 5, v1
    v_mfma_f32_16x16x32_bf16 v[56:59], v[144:147], v[140:143], v[56:59]
    ds_read_b128 v[204:207], v23 offset:640
    v_mul_u32_u24 v3, 57344, v3
    v_mfma_f32_16x16x32_bf16 v[56:59], v[152:155], v[132:135], v[56:59]
    ds_read_b64 v[208:209], v22 offset:2688
    v_lshl_add_u32 v18, v2, 4, v3
    v_mfma_f32_16x16x32_bf16 v[60:63], v[128:131], v[164:167], 0
    ds_read_b64 v[210:211], v22 offset:2696
    v_lshrrev_b32 v2, 3, v1
    v_mfma_f32_16x16x32_bf16 v[60:63], v[136:139], v[156:159], v[60:63]
    ds_read_b128 v[212:215], v23 offset:1152
    v_and_b32 v3, 7, v1
    v_mfma_f32_16x16x32_bf16 v[60:63], v[144:147], v[148:151], v[60:63]
    ds_read_b64 v[216:217], v22 offset:2176
    v_and_b32 v4, 6, v2
    v_mfma_f32_16x16x32_bf16 v[60:63], v[152:155], v[140:143], v[60:63]
    ds_read_b64 v[218:219], v22 offset:2184
    v_xor_b32 v3, v3, v4
    v_mfma_f32_16x16x32_bf16 v[60:63], v[160:163], v[132:135], v[60:63]
    ds_read_b128 v[220:223], v23 offset:1664
    v_lshlrev_b32 v2, 10, v2
    v_mfma_f32_16x16x32_bf16 v[64:67], v[128:131], v[172:175], 0
    ds_read_b64 v[224:225], v22 offset:1664
    v_lshl_add_u32 v104, v3, 4, v2
    v_mfma_f32_16x16x32_bf16 v[64:67], v[136:139], v[164:167], v[64:67]
    ds_read_b64 v[226:227], v22 offset:1672
    v_add_u32 v105, 7168, v104
    v_mfma_f32_16x16x32_bf16 v[64:67], v[144:147], v[156:159], v[64:67]
    ds_read_b128 v[228:231], v23 offset:2176
    v_add_u32 v106, 14336, v104
    v_mfma_f32_16x16x32_bf16 v[64:67], v[152:155], v[148:151], v[64:67]
    ds_read_b64 v[232:233], v22 offset:1152
    v_add_u32 v107, 21504, v104
    v_mfma_f32_16x16x32_bf16 v[64:67], v[160:163], v[140:143], v[64:67]
    ds_read_b64 v[234:235], v22 offset:1160
    v_and_b32 v2, 1, v1
    v_mfma_f32_16x16x32_bf16 v[64:67], v[168:171], v[132:135], v[64:67]
    ds_read_b128 v[236:239], v23 offset:2688
    v_lshrrev_b32 v3, 4, v1
    v_mfma_f32_16x16x32_bf16 v[68:71], v[128:131], v[180:183], 0
    ds_read_b64 v[240:241], v22 offset:640
    v_lshlrev_b32 v2, 4, v2
    v_mfma_f32_16x16x32_bf16 v[68:71], v[136:139], v[172:175], v[68:71]
    ds_read_b64 v[242:243], v22 offset:648
    v_lshl_add_u32 v2, v3, 5, v2
    v_mfma_f32_16x16x32_bf16 v[68:71], v[144:147], v[164:167], v[68:71]
    ds_read_b128 v[244:247], v23 offset:3200
    v_add_u32 v17, 155648, v2
    v_mfma_f32_16x16x32_bf16 v[68:71], v[152:155], v[156:159], v[68:71]
    ds_read_b64 v[248:249], v22 offset:128
    s_lshr_b32 s28, s43, 4
    v_mfma_f32_16x16x32_bf16 v[68:71], v[160:163], v[148:151], v[68:71]
    ds_read_b64 v[250:251], v22 offset:136
    s_lshl_b32 s13, s42, 1
    v_mfma_f32_16x16x32_bf16 v[68:71], v[168:171], v[140:143], v[68:71]
    ds_read_b128 v[252:255], v23 offset:3712
    s_add_u32 s28, s28, s13
    v_mfma_f32_16x16x32_bf16 v[68:71], v[176:179], v[132:135], v[68:71]
    s_lshl_b32 s13, s3, 4
    s_add_u32 s28, s28, s13
    v_mfma_f32_16x16x32_bf16 v[72:75], v[128:131], v[188:191], 0
    s_mul_i32 s28, s28, 384
    s_and_b32 s30, s2, 15
    v_mfma_f32_16x16x32_bf16 v[72:75], v[136:139], v[180:183], v[72:75]
    s_lshl_b32 s30, s30, 4
    s_and_b32 s13, s3, 3
    v_mfma_f32_16x16x32_bf16 v[72:75], v[144:147], v[172:175], v[72:75]
    s_add_u32 s30, s30, s13
    s_mul_i32 s30, s30, 384
    v_mfma_f32_16x16x32_bf16 v[72:75], v[152:155], v[164:167], v[72:75]
    s_mov_b32 s32, 1
    s_and_b32 s12, s42, 1
    v_mfma_f32_16x16x32_bf16 v[72:75], v[160:163], v[156:159], v[72:75]
    s_mul_i32 s20, s12, 917504
    s_lshl_b32 s14, s35, 7
    v_mfma_f32_16x16x32_bf16 v[72:75], v[168:171], v[148:151], v[72:75]
    s_add_u32 s20, s20, s14
    s_and_b32 s12, s3, 1
    v_mfma_f32_16x16x32_bf16 v[72:75], v[176:179], v[140:143], v[72:75]
    s_lshl_b32 s12, s12, 15
    s_add_u32 s20, s20, s12
    v_mfma_f32_16x16x32_bf16 v[72:75], v[184:187], v[132:135], v[72:75]
    s_and_b32 s27, s3, 3
    s_lshl_b32 s27, s27, 12
    s_lshl_b32 s22, s44, 17
    s_lshl_b32 s14, s46, 16
    s_add_u32 s22, s22, s14
    s_add_u32 s22, s22, s27
    s_add_u32 s22, s22, 5242880
    s_mul_i32 s24, s44, 458752
    s_lshl_b32 s12, s45, 12
    s_lshl_b32 s13, s3, 9
    s_add_u32 s24, s24, s12
    s_add_u32 s24, s24, s13
    s_add_u32 s24, s24, 8388608
    s_lshl_b32 s25, s44, 11
    s_waitcnt lgkmcnt(0)
    v_mfma_f32_16x16x32_bf16 v[44:47], v[192:195], v[196:199], v[44:47]
    v_mfma_f32_16x16x32_bf16 v[48:51], v[192:195], v[204:207], v[48:51]
    v_mfma_f32_16x16x32_bf16 v[48:51], v[200:203], v[196:199], v[48:51]
    ds_read_b64 v[128:129], v22 offset:3648
    v_mfma_f32_16x16x32_bf16 v[52:55], v[192:195], v[212:215], v[52:55]
    ds_read_b64 v[130:131], v22 offset:3656
    s_add_u32 s25, s25, 163840
    v_mfma_f32_16x16x32_bf16 v[52:55], v[200:203], v[204:207], v[52:55]
    ds_read_b128 v[132:135], v23 offset:64
    s_xor_b32 s41, s45, s46
    v_mfma_f32_16x16x32_bf16 v[52:55], v[208:211], v[196:199], v[52:55]
    ds_read_b64 v[136:137], v22 offset:3136
    s_and_b32 s41, s41, 1
    v_mfma_f32_16x16x32_bf16 v[56:59], v[192:195], v[220:223], v[56:59]
    ds_read_b64 v[138:139], v22 offset:3144
    s_lshl_b32 s26, s44, 1
    v_mfma_f32_16x16x32_bf16 v[56:59], v[200:203], v[212:215], v[56:59]
    ds_read_b128 v[140:143], v23 offset:576
    s_add_u32 s26, s26, s46
    v_mfma_f32_16x16x32_bf16 v[56:59], v[208:211], v[204:207], v[56:59]
    ds_read_b64 v[144:145], v22 offset:2624
    s_lshl_b32 s26, s26, 3
    v_mfma_f32_16x16x32_bf16 v[56:59], v[216:219], v[196:199], v[56:59]
    ds_read_b64 v[146:147], v22 offset:2632
    s_lshr_b32 s12, s3, 2
    v_mfma_f32_16x16x32_bf16 v[60:63], v[192:195], v[228:231], v[60:63]
    ds_read_b128 v[148:151], v23 offset:1088
    s_add_u32 s26, s26, s12
    v_mfma_f32_16x16x32_bf16 v[60:63], v[200:203], v[220:223], v[60:63]
    ds_read_b64 v[152:153], v22 offset:2112
    s_mul_i32 s26, s26, 384
    v_mfma_f32_16x16x32_bf16 v[60:63], v[208:211], v[212:215], v[60:63]
    ds_read_b64 v[154:155], v22 offset:2120
    s_bfe_u32 s12, s3, 0x10001
    v_mfma_f32_16x16x32_bf16 v[60:63], v[216:219], v[204:207], v[60:63]
    ds_read_b128 v[156:159], v23 offset:1600
    s_lshl_b32 s13, s12, 17
    v_mfma_f32_16x16x32_bf16 v[60:63], v[224:227], v[196:199], v[60:63]
    ds_read_b64 v[160:161], v22 offset:1600
    s_add_u32 s20, s20, s13
    v_mfma_f32_16x16x32_bf16 v[64:67], v[192:195], v[236:239], v[64:67]
    ds_read_b64 v[162:163], v22 offset:1608
    s_lshl_b32 s12, s12, 7
    v_mfma_f32_16x16x32_bf16 v[64:67], v[200:203], v[228:231], v[64:67]
    ds_read_b128 v[164:167], v23 offset:2112
    s_add_u32 s26, s26, s12
    v_mfma_f32_16x16x32_bf16 v[64:67], v[208:211], v[220:223], v[64:67]
    ds_read_b64 v[168:169], v22 offset:1088
    s_lshl_b32 s12, s46, 10
    v_mfma_f32_16x16x32_bf16 v[64:67], v[216:219], v[212:215], v[64:67]
    ds_read_b64 v[170:171], v22 offset:1096
    s_add_u32 s13, s12, 159744
    v_mfma_f32_16x16x32_bf16 v[64:67], v[224:227], v[204:207], v[64:67]
    ds_read_b128 v[172:175], v23 offset:2624
    v_add_u32 v124, s13, v19
    v_mfma_f32_16x16x32_bf16 v[64:67], v[232:235], v[196:199], v[64:67]
    ds_read_b64 v[176:177], v22 offset:576
    s_xor_b32 s12, s12, 1024
    v_mfma_f32_16x16x32_bf16 v[68:71], v[192:195], v[244:247], v[68:71]
    ds_read_b64 v[178:179], v22 offset:584
    s_lshl_b32 s13, s41, 9
    v_mfma_f32_16x16x32_bf16 v[68:71], v[200:203], v[236:239], v[68:71]
    ds_read_b128 v[180:183], v23 offset:3136
    s_add_u32 s12, s12, s13
    v_mfma_f32_16x16x32_bf16 v[68:71], v[208:211], v[228:231], v[68:71]
    ds_read_b64 v[184:185], v22 offset:64
    s_add_u32 s13, s12, 159744
    v_mfma_f32_16x16x32_bf16 v[68:71], v[216:219], v[220:223], v[68:71]
    ds_read_b64 v[186:187], v22 offset:72
    v_add_u32 v7, s13, v19
    v_mfma_f32_16x16x32_bf16 v[68:71], v[224:227], v[212:215], v[68:71]
    ds_read_b128 v[188:191], v23 offset:3648
    s_lshl_b32 s12, s41, 15
    v_mfma_f32_16x16x32_bf16 v[68:71], v[232:235], v[204:207], v[68:71]
    s_xor_b32 s12, s12, 65536
    s_xor_b32 s44, s12, s22
    v_mfma_f32_16x16x32_bf16 v[68:71], v[240:243], v[196:199], v[68:71]
    s_xor_b32 s12, s46, 1
    s_lshl_b32 s12, s12, 1
    v_mfma_f32_16x16x32_bf16 v[72:75], v[192:195], v[252:255], v[72:75]
    s_mul_i32 s13, s46, 229376
    s_add_u32 s12, s12, s41
    v_mfma_f32_16x16x32_bf16 v[72:75], v[200:203], v[244:247], v[72:75]
    s_mul_i32 s45, s12, 114688
    s_xor_b32 s12, s12, 1
    v_mfma_f32_16x16x32_bf16 v[72:75], v[208:211], v[236:239], v[72:75]
    s_mul_i32 s46, s12, 114688
    s_add_u32 s45, s45, s24
    v_mfma_f32_16x16x32_bf16 v[72:75], v[216:219], v[228:231], v[72:75]
    s_add_u32 s46, s46, s24
    s_add_u32 s24, s24, s13
    v_mfma_f32_16x16x32_bf16 v[72:75], v[224:227], v[220:223], v[72:75]
    s_lshr_b32 s12, s3, 2
    s_sub_u32 s12, s41, s12
    v_mfma_f32_16x16x32_bf16 v[72:75], v[232:235], v[212:215], v[72:75]
    s_mul_i32 s12, s12, 384
    s_add_u32 s41, s26, s12
    v_mfma_f32_16x16x32_bf16 v[72:75], v[240:243], v[204:207], v[72:75]
    s_and_b32 s29, s47, -2
    s_and_b32 s13, s42, 1
    v_mfma_f32_16x16x32_bf16 v[72:75], v[248:251], v[196:199], v[72:75]
    s_add_u32 s29, s29, s13
    s_lshl_b32 s29, s29, 3
    s_and_b32 s13, s3, 1
    s_lshl_b32 s13, s13, 1
    s_add_u32 s29, s29, s13
    s_mul_i32 s29, s29, 384
    s_bfe_u32 s13, s3, 0x10001
    s_lshl_b32 s13, s13, 7
    s_add_u32 s29, s29, s13
    s_and_b32 s13, s3, 1
    s_mul_i32 s12, s13, 114688
    s_and_b32 s13, s42, 1
    s_mul_i32 s13, s13, 28672
    s_waitcnt lgkmcnt(0)
    v_mfma_f32_16x16x32_bf16 v[44:47], v[128:131], v[132:135], v[44:47]
    v_mfma_f32_16x16x32_bf16 v[48:51], v[128:131], v[140:143], v[48:51]
    v_mfma_f32_16x16x32_bf16 v[48:51], v[136:139], v[132:135], v[48:51]
    ds_read_b64 v[192:193], v22 offset:3584
    v_mfma_f32_16x16x32_bf16 v[52:55], v[128:131], v[148:151], v[52:55]
    ds_read_b64 v[194:195], v22 offset:3592
    s_add_u32 s12, s12, s13
    v_mfma_f32_16x16x32_bf16 v[52:55], v[136:139], v[140:143], v[52:55]
    ds_read_b128 v[196:199], v23 offset:0
    s_bfe_u32 s14, s3, 0x10001
    v_mfma_f32_16x16x32_bf16 v[52:55], v[144:147], v[132:135], v[52:55]
    ds_read_b64 v[200:201], v22 offset:3072
    s_lshl_b32 s14, s14, 10
    v_mfma_f32_16x16x32_bf16 v[56:59], v[128:131], v[156:159], v[56:59]
    ds_read_b64 v[202:203], v22 offset:3080
    s_add_u32 s12, s12, s14
    v_mfma_f32_16x16x32_bf16 v[56:59], v[136:139], v[148:151], v[56:59]
    ds_read_b128 v[204:207], v23 offset:512
    s_add_u32 s12, s12, 8388608
    v_mfma_f32_16x16x32_bf16 v[56:59], v[144:147], v[140:143], v[56:59]
    ds_read_b64 v[208:209], v22 offset:2560
    s_mul_i32 s1, s47, 229376
    v_mfma_f32_16x16x32_bf16 v[56:59], v[152:155], v[132:135], v[56:59]
    ds_read_b64 v[210:211], v22 offset:2568
    s_add_u32 s1, s1, s12
    v_mfma_f32_16x16x32_bf16 v[60:63], v[128:131], v[164:167], v[60:63]
    ds_read_b128 v[212:215], v23 offset:1024
    s_xor_b32 s0, s47, 1
    v_mfma_f32_16x16x32_bf16 v[60:63], v[136:139], v[156:159], v[60:63]
    ds_read_b64 v[216:217], v22 offset:2048
    s_mul_i32 s0, s0, 229376
    v_mfma_f32_16x16x32_bf16 v[60:63], v[144:147], v[148:151], v[60:63]
    ds_read_b64 v[218:219], v22 offset:2056
    s_add_u32 s0, s0, s12
    v_mfma_f32_16x16x32_bf16 v[60:63], v[152:155], v[140:143], v[60:63]
    ds_read_b128 v[220:223], v23 offset:1536
    v_add_u32 v16, 57344, v26
    v_mfma_f32_16x16x32_bf16 v[60:63], v[160:163], v[132:135], v[60:63]
    ds_read_b64 v[224:225], v22 offset:1536
    s_lshl_b32 s23, s47, 3
    v_mfma_f32_16x16x32_bf16 v[64:67], v[128:131], v[172:175], v[64:67]
    ds_read_b64 v[226:227], v22 offset:1544
    s_add_u32 s23, s23, s35
    v_mfma_f32_16x16x32_bf16 v[64:67], v[136:139], v[164:167], v[64:67]
    ds_read_b128 v[228:231], v23 offset:2048
    s_lshl_b32 s23, s23, 2
    v_mfma_f32_16x16x32_bf16 v[64:67], v[144:147], v[156:159], v[64:67]
    ds_read_b64 v[232:233], v22 offset:1024
    s_and_b32 s13, s3, 3
    v_mfma_f32_16x16x32_bf16 v[64:67], v[152:155], v[148:151], v[64:67]
    ds_read_b64 v[234:235], v22 offset:1032
    s_add_u32 s23, s23, s13
    v_mfma_f32_16x16x32_bf16 v[64:67], v[160:163], v[140:143], v[64:67]
    ds_read_b128 v[236:239], v23 offset:2560
    s_lshl_b32 s23, s23, 11
    v_mfma_f32_16x16x32_bf16 v[64:67], v[168:171], v[132:135], v[64:67]
    ds_read_b64 v[240:241], v22 offset:512
    s_xor_b32 s21, s23, 65536
    v_mfma_f32_16x16x32_bf16 v[68:71], v[128:131], v[180:183], v[68:71]
    ds_read_b64 v[242:243], v22 offset:520
    s_add_u32 s23, s23, 18874368
    v_mfma_f32_16x16x32_bf16 v[68:71], v[136:139], v[172:175], v[68:71]
    ds_read_b128 v[244:247], v23 offset:3072
    s_add_u32 s21, s21, 18874368
    v_mfma_f32_16x16x32_bf16 v[68:71], v[144:147], v[164:167], v[68:71]
    ds_read_b64 v[248:249], v22 offset:0
    v_bfe_u32 v2, v1, 2, 3
    v_mfma_f32_16x16x32_bf16 v[68:71], v[152:155], v[156:159], v[68:71]
    ds_read_b64 v[250:251], v22 offset:8
    v_lshrrev_b32 v3, 5, v1
    v_mfma_f32_16x16x32_bf16 v[68:71], v[160:163], v[148:151], v[68:71]
    ds_read_b128 v[252:255], v23 offset:3584
    v_lshlrev_b32 v3, 11, v3
    v_mfma_f32_16x16x32_bf16 v[68:71], v[168:171], v[140:143], v[68:71]
    v_lshl_add_u32 v3, v2, 7, v3
    v_lshrrev_b32 v2, 1, v2
    v_mfma_f32_16x16x32_bf16 v[68:71], v[176:179], v[132:135], v[68:71]
    v_lshl_add_u32 v3, v2, 5, v3
    v_and_b32 v2, 3, v1
    v_mfma_f32_16x16x32_bf16 v[72:75], v[128:131], v[188:191], v[72:75]
    v_lshl_add_u32 v3, v2, 3, v3
    s_bfe_u32 s12, s3, 0x10001
    v_mfma_f32_16x16x32_bf16 v[72:75], v[136:139], v[180:183], v[72:75]
    s_lshl_b32 s12, s12, 12
    v_add_u32 v125, s12, v3
    v_mfma_f32_16x16x32_bf16 v[72:75], v[144:147], v[172:175], v[72:75]
    v_and_b32 v2, 15, v1
    v_lshrrev_b32 v3, 4, v1
    v_mfma_f32_16x16x32_bf16 v[72:75], v[152:155], v[164:167], v[72:75]
    v_xor_b32 v3, v3, v2
    v_lshlrev_b32 v2, 8, v2
    v_mfma_f32_16x16x32_bf16 v[72:75], v[160:163], v[156:159], v[72:75]
    v_lshl_add_u32 v2, v3, 4, v2
    s_and_b32 s12, s3, 3
    v_mfma_f32_16x16x32_bf16 v[72:75], v[168:171], v[148:151], v[72:75]
    s_lshl_b32 s12, s12, 13
    v_add_u32 v126, s12, v2
    v_mfma_f32_16x16x32_bf16 v[72:75], v[176:179], v[140:143], v[72:75]
    v_lshrrev_b32 v2, 3, v1
    s_and_b32 s12, s3, 3
    v_mfma_f32_16x16x32_bf16 v[72:75], v[184:187], v[132:135], v[72:75]
    s_lshl_b32 s12, s12, 4
    v_add_u32 v2, s12, v2
    v_and_b32 v3, 7, v0
    v_lshlrev_b32 v31, 10, v2
    v_lshl_add_u32 v31, v3, 4, v31
    v_lshlrev_b32 v3, 1, v3
    v_and_b32 v127, 15, v2
    v_xor_b32 v3, v3, v127
    v_lshlrev_b32 v3, 4, v3
    v_lshl_add_u32 v127, v2, 8, v3
    s_lshl_b32 s31, s47, 16
    s_lshl_b32 s13, s35, 7
    s_add_u32 s31, s31, s13
    s_waitcnt lgkmcnt(0)
    v_mfma_f32_16x16x32_bf16 v[44:47], v[192:195], v[196:199], v[44:47]
    v_mfma_f32_16x16x32_bf16 v[48:51], v[192:195], v[204:207], v[48:51]
    v_mfma_f32_16x16x32_bf16 v[48:51], v[200:203], v[196:199], v[48:51]
    v_mfma_f32_16x16x32_bf16 v[52:55], v[192:195], v[212:215], v[52:55]
    v_mfma_f32_16x16x32_bf16 v[52:55], v[200:203], v[204:207], v[52:55]
    v_mfma_f32_16x16x32_bf16 v[52:55], v[208:211], v[196:199], v[52:55]
    v_mfma_f32_16x16x32_bf16 v[56:59], v[192:195], v[220:223], v[56:59]
    s_nop 1
    v_cvt_pk_bf16_f32 v128, v44, v45
    v_mfma_f32_16x16x32_bf16 v[56:59], v[200:203], v[212:215], v[56:59]
    v_cvt_pk_bf16_f32 v129, v46, v47
    v_mfma_f32_16x16x32_bf16 v[56:59], v[208:211], v[204:207], v[56:59]
    ds_write_b64 v24, v[128:129] offset:0
    v_mfma_f32_16x16x32_bf16 v[56:59], v[216:219], v[196:199], v[56:59]
    v_cvt_pk_bf16_f32 v130, v48, v49
    v_mfma_f32_16x16x32_bf16 v[60:63], v[192:195], v[228:231], v[60:63]
    v_cvt_pk_bf16_f32 v131, v50, v51
    v_mfma_f32_16x16x32_bf16 v[60:63], v[200:203], v[220:223], v[60:63]
    ds_write_b64 v24, v[130:131] offset:512
    v_mfma_f32_16x16x32_bf16 v[60:63], v[208:211], v[212:215], v[60:63]
    v_cvt_pk_bf16_f32 v132, v52, v53
    v_mfma_f32_16x16x32_bf16 v[60:63], v[216:219], v[204:207], v[60:63]
    v_cvt_pk_bf16_f32 v133, v54, v55
    v_mfma_f32_16x16x32_bf16 v[60:63], v[224:227], v[196:199], v[60:63]
    ds_write_b64 v24, v[132:133] offset:1024
    v_mfma_f32_16x16x32_bf16 v[64:67], v[192:195], v[236:239], v[64:67]
    v_cvt_pk_bf16_f32 v134, v56, v57
    v_mfma_f32_16x16x32_bf16 v[64:67], v[200:203], v[228:231], v[64:67]
    v_cvt_pk_bf16_f32 v135, v58, v59
    v_mfma_f32_16x16x32_bf16 v[64:67], v[208:211], v[220:223], v[64:67]
    ds_write_b64 v24, v[134:135] offset:1536
    v_mfma_f32_16x16x32_bf16 v[64:67], v[216:219], v[212:215], v[64:67]
    v_mfma_f32_16x16x32_bf16 v[64:67], v[224:227], v[204:207], v[64:67]
    v_mfma_f32_16x16x32_bf16 v[64:67], v[232:235], v[196:199], v[64:67]
    v_cvt_pk_bf16_f32 v136, v60, v61
    v_mfma_f32_16x16x32_bf16 v[68:71], v[192:195], v[244:247], v[68:71]
    v_cvt_pk_bf16_f32 v137, v62, v63
    v_mfma_f32_16x16x32_bf16 v[68:71], v[200:203], v[236:239], v[68:71]
    ds_write_b64 v24, v[136:137] offset:2048
    v_mfma_f32_16x16x32_bf16 v[68:71], v[208:211], v[228:231], v[68:71]
    v_mfma_f32_16x16x32_bf16 v[68:71], v[216:219], v[220:223], v[68:71]
    v_mfma_f32_16x16x32_bf16 v[68:71], v[224:227], v[212:215], v[68:71]
    v_mfma_f32_16x16x32_bf16 v[68:71], v[232:235], v[204:207], v[68:71]
    v_cvt_pk_bf16_f32 v138, v64, v65
    v_mfma_f32_16x16x32_bf16 v[68:71], v[240:243], v[196:199], v[68:71]
    v_cvt_pk_bf16_f32 v139, v66, v67
    v_mfma_f32_16x16x32_bf16 v[72:75], v[192:195], v[252:255], v[72:75]
    ds_write_b64 v24, v[138:139] offset:2560
    v_mfma_f32_16x16x32_bf16 v[72:75], v[200:203], v[244:247], v[72:75]
    v_mfma_f32_16x16x32_bf16 v[72:75], v[208:211], v[236:239], v[72:75]
    v_mfma_f32_16x16x32_bf16 v[72:75], v[216:219], v[228:231], v[72:75]
    v_mfma_f32_16x16x32_bf16 v[72:75], v[224:227], v[220:223], v[72:75]
    v_mfma_f32_16x16x32_bf16 v[72:75], v[232:235], v[212:215], v[72:75]
    v_cvt_pk_bf16_f32 v140, v68, v69
    v_mfma_f32_16x16x32_bf16 v[72:75], v[240:243], v[204:207], v[72:75]
    v_cvt_pk_bf16_f32 v141, v70, v71
    v_mfma_f32_16x16x32_bf16 v[72:75], v[248:251], v[196:199], v[72:75]
    ds_write_b64 v24, v[140:141] offset:3072
    s_nop 6
    v_cvt_pk_bf16_f32 v142, v72, v73
    v_cvt_pk_bf16_f32 v143, v74, v75
    ds_write_b64 v24, v[142:143] offset:3584
    s_waitcnt lgkmcnt(0)
CONV_DONE:
    s_lshl_b32 s12, s42, 5
    s_add_u32 s12, s12, s43
    s_lshl_b32 s12, s12, 6
    s_add_u32 s13, s12, 5242880
    s_add_u32 s12, s12, 3145728
    s_barrier
    ds_read_b128 v[60:63], v21
    ds_read_b128 v[64:67], v12 offset:29184
    s_waitcnt lgkmcnt(1)
    v_lshlrev_b32 v44, 16, v60
    v_and_b32 v45, 0xffff0000, v60
    v_lshlrev_b32 v46, 16, v61
    v_and_b32 v47, 0xffff0000, v61
    v_lshlrev_b32 v48, 16, v62
    v_and_b32 v49, 0xffff0000, v62
    v_lshlrev_b32 v50, 16, v63
    v_and_b32 v51, 0xffff0000, v63
    v_fmac_f32 v34, v44, v42
    v_fmac_f32 v35, v45, v42
    v_fmac_f32 v36, v46, v42
    v_fmac_f32 v37, v47, v42
    v_fmac_f32 v38, v48, v42
    v_fmac_f32 v39, v49, v42
    v_fmac_f32 v40, v50, v42
    v_fmac_f32 v41, v51, v42
    s_waitcnt lgkmcnt(0)
    v_lshlrev_b32 v44, 16, v64
    v_and_b32 v45, 0xffff0000, v64
    v_lshlrev_b32 v46, 16, v65
    v_and_b32 v47, 0xffff0000, v65
    v_lshlrev_b32 v48, 16, v66
    v_and_b32 v49, 0xffff0000, v66
    v_lshlrev_b32 v50, 16, v67
    v_and_b32 v51, 0xffff0000, v67
    v_fmac_f32 v34, v44, v42
    v_mul_f32 v44, v34, v43
    v_fmac_f32 v35, v45, v42
    v_mul_f32 v45, v35, v43
    v_fmac_f32 v36, v46, v42
    v_mul_f32 v46, v36, v43
    v_fmac_f32 v37, v47, v42
    v_mul_f32 v47, v37, v43
    v_fmac_f32 v38, v48, v42
    v_mul_f32 v48, v38, v43
    v_fmac_f32 v39, v49, v42
    v_mul_f32 v49, v39, v43
    v_fmac_f32 v40, v50, v42
    v_mul_f32 v50, v40, v43
    v_fmac_f32 v41, v51, v42
    v_mul_f32 v51, v41, v43
    v_cvt_pk_bf16_f32 v52, v44, v45
    v_cvt_pk_bf16_f32 v53, v46, v47
    v_cvt_pk_bf16_f32 v54, v48, v49
    v_cvt_pk_bf16_f32 v55, v50, v51
    buffer_store_dwordx4 v[52:55], v15, s[4:7], s13 offen sc1
    v_cvt_pk_bf16_f32 v56, v34, v35
    v_cvt_pk_bf16_f32 v57, v36, v37
    v_cvt_pk_bf16_f32 v58, v38, v39
    v_cvt_pk_bf16_f32 v59, v40, v41
    buffer_store_dwordx4 v[56:59], v15, s[4:7], s12 offen sc1
    s_barrier
    s_cmp_eq_u32 s34, 7
    s_cbranch_scc1 SPARE
    s_cmp_lt_u32 s3, 4
    s_cbranch_scc1 PRE_S
    v_add_u32 v2, 65536, v25
    ds_read_b64_tr_b16 v[160:161], v2 offset:0
    ds_read_b64_tr_b16 v[162:163], v2 offset:2048
    ds_read_b64_tr_b16 v[164:165], v2 offset:16384
    ds_read_b64_tr_b16 v[166:167], v2 offset:18432
    ds_read_b64_tr_b16 v[168:169], v2 offset:4096
    ds_read_b64_tr_b16 v[170:171], v2 offset:6144
    ds_read_b64_tr_b16 v[172:173], v2 offset:20480
    ds_read_b64_tr_b16 v[174:175], v2 offset:22528
    ds_read_b64_tr_b16 v[176:177], v2 offset:8192
    ds_read_b64_tr_b16 v[178:179], v2 offset:10240
    ds_read_b64_tr_b16 v[180:181], v2 offset:24576
    ds_read_b64_tr_b16 v[182:183], v2 offset:26624
    ds_read_b64_tr_b16 v[184:185], v2 offset:12288
    ds_read_b64_tr_b16 v[186:187], v2 offset:14336
    ds_read_b64_tr_b16 v[188:189], v2 offset:28672
    ds_read_b64_tr_b16 v[190:191], v2 offset:30720
    v_add_u32 v2, 98304, v25
    ds_read_b64_tr_b16 v[192:193], v2 offset:0
    ds_read_b64_tr_b16 v[194:195], v2 offset:2048
    ds_read_b64_tr_b16 v[196:197], v2 offset:16384
    ds_read_b64_tr_b16 v[198:199], v2 offset:18432
    ds_read_b64_tr_b16 v[200:201], v2 offset:4096
    ds_read_b64_tr_b16 v[202:203], v2 offset:6144
    ds_read_b64_tr_b16 v[204:205], v2 offset:20480
    ds_read_b64_tr_b16 v[206:207], v2 offset:22528
    ds_read_b64_tr_b16 v[208:209], v2 offset:8192
    ds_read_b64_tr_b16 v[210:211], v2 offset:10240
    ds_read_b64_tr_b16 v[212:213], v2 offset:24576
    ds_read_b64_tr_b16 v[214:215], v2 offset:26624
    ds_read_b64_tr_b16 v[216:217], v2 offset:12288
    ds_read_b64_tr_b16 v[218:219], v2 offset:14336
    ds_read_b64_tr_b16 v[220:221], v2 offset:28672
    ds_read_b64_tr_b16 v[222:223], v2 offset:30720
    ds_read_b128 v[60:63], v17 offset:0
    ds_read_b128 v[64:67], v17 offset:128
    ds_read_b128 v[68:71], v17 offset:256
    ds_read_b128 v[72:75], v17 offset:384
    ds_read_b128 v[76:79], v17 offset:512
    ds_read_b128 v[80:83], v17 offset:640
    ds_read_b128 v[84:87], v17 offset:768
    ds_read_b128 v[88:91], v17 offset:896
    s_waitcnt lgkmcnt(7)
    v_mfma_f32_16x16x32_bf16 v[96:99], v[128:131], v[60:63], 0
    v_mfma_f32_16x16x32_bf16 v[100:103], v[132:135], v[60:63], 0
    s_waitcnt lgkmcnt(6)
    v_mfma_f32_16x16x32_bf16 v[96:99], v[136:139], v[64:67], v[96:99]
    v_mfma_f32_16x16x32_bf16 v[100:103], v[140:143], v[64:67], v[100:103]
    s_waitcnt lgkmcnt(5)
    v_mfma_f32_16x16x32_bf16 v[96:99], v[144:147], v[68:71], v[96:99]
    v_mfma_f32_16x16x32_bf16 v[100:103], v[148:151], v[68:71], v[100:103]
    s_waitcnt lgkmcnt(4)
    v_mfma_f32_16x16x32_bf16 v[96:99], v[152:155], v[72:75], v[96:99]
    v_mfma_f32_16x16x32_bf16 v[100:103], v[156:159], v[72:75], v[100:103]
    s_waitcnt lgkmcnt(3)
    v_mfma_f32_16x16x32_bf16 v[96:99], v[160:163], v[76:79], v[96:99]
    v_mfma_f32_16x16x32_bf16 v[100:103], v[164:167], v[76:79], v[100:103]
    s_waitcnt lgkmcnt(2)
    v_mfma_f32_16x16x32_bf16 v[96:99], v[168:171], v[80:83], v[96:99]
    v_mfma_f32_16x16x32_bf16 v[100:103], v[172:175], v[80:83], v[100:103]
    s_waitcnt lgkmcnt(1)
    v_mfma_f32_16x16x32_bf16 v[96:99], v[176:179], v[84:87], v[96:99]
    v_mfma_f32_16x16x32_bf16 v[100:103], v[180:183], v[84:87], v[100:103]
    s_waitcnt lgkmcnt(0)
    v_mfma_f32_16x16x32_bf16 v[96:99], v[184:187], v[88:91], v[96:99]
    v_mfma_f32_16x16x32_bf16 v[100:103], v[188:191], v[88:91], v[100:103]
    s_branch PG_6
.p2align 12
PG_6:
    s_waitcnt vmcnt(0)
    s_barrier
    ds_read_b128 v[44:47], v17 offset:1024
    ds_read_b128 v[48:51], v17 offset:1152
    ds_read_b128 v[52:55], v17 offset:1280
    ds_read_b128 v[56:59], v17 offset:1408
    s_waitcnt lgkmcnt(3)
    v_mfma_f32_16x16x32_bf16 v[96:99], v[192:195], v[44:47], v[96:99]
    v_mfma_f32_16x16x32_bf16 v[100:103], v[196:199], v[44:47], v[100:103]
    s_waitcnt lgkmcnt(2)
    v_mfma_f32_16x16x32_bf16 v[96:99], v[200:203], v[48:51], v[96:99]
    v_mfma_f32_16x16x32_bf16 v[100:103], v[204:207], v[48:51], v[100:103]
    s_waitcnt lgkmcnt(1)
    v_mfma_f32_16x16x32_bf16 v[96:99], v[208:211], v[52:55], v[96:99]
    v_mfma_f32_16x16x32_bf16 v[100:103], v[212:215], v[52:55], v[100:103]
    s_waitcnt lgkmcnt(0)
    v_mfma_f32_16x16x32_bf16 v[96:99], v[216:219], v[56:59], v[96:99]
    v_mfma_f32_16x16x32_bf16 v[100:103], v[220:223], v[56:59], v[100:103]
    s_barrier
    v_add_u32 v2, 32768, v25
    ds_read_b64_tr_b16 v[224:225], v2 offset:0
    ds_read_b64_tr_b16 v[226:227], v2 offset:2048
    ds_read_b64_tr_b16 v[228:229], v2 offset:16384
    ds_read_b64_tr_b16 v[230:231], v2 offset:18432
    ds_read_b64_tr_b16 v[232:233], v2 offset:4096
    ds_read_b64_tr_b16 v[234:235], v2 offset:6144
    ds_read_b64_tr_b16 v[236:237], v2 offset:20480
    ds_read_b64_tr_b16 v[238:239], v2 offset:22528
    ds_read_b64_tr_b16 v[240:241], v2 offset:8192
    ds_read_b64_tr_b16 v[242:243], v2 offset:10240
    ds_read_b64_tr_b16 v[244:245], v2 offset:24576
    ds_read_b64_tr_b16 v[246:247], v2 offset:26624
    ds_read_b64_tr_b16 v[248:249], v2 offset:12288
    ds_read_b64_tr_b16 v[250:251], v2 offset:14336
    ds_read_b64_tr_b16 v[252:253], v2 offset:28672
    ds_read_b64_tr_b16 v[254:255], v2 offset:30720
    ds_read_b128 v[44:47], v17 offset:1536
    ds_read_b128 v[48:51], v17 offset:1664
    ds_read_b128 v[52:55], v17 offset:1792
    ds_read_b128 v[56:59], v17 offset:1920
    s_waitcnt lgkmcnt(3)
    v_mfma_f32_16x16x32_bf16 v[96:99], v[224:227], v[44:47], v[96:99]
    v_mfma_f32_16x16x32_bf16 v[100:103], v[228:231], v[44:47], v[100:103]
    s_waitcnt lgkmcnt(2)
    v_mfma_f32_16x16x32_bf16 v[96:99], v[232:235], v[48:51], v[96:99]
    v_mfma_f32_16x16x32_bf16 v[100:103], v[236:239], v[48:51], v[100:103]
    s_waitcnt lgkmcnt(1)
    v_mfma_f32_16x16x32_bf16 v[96:99], v[240:243], v[52:55], v[96:99]
    v_mfma_f32_16x16x32_bf16 v[100:103], v[244:247], v[52:55], v[100:103]
    s_waitcnt lgkmcnt(0)
    v_mfma_f32_16x16x32_bf16 v[96:99], v[248:251], v[56:59], v[96:99]
    v_mfma_f32_16x16x32_bf16 v[100:103], v[252:255], v[56:59], v[100:103]
    s_barrier
    s_mov_b64 s[12:13], 0
    s_mov_b32 s14, 0
    s_mov_b32 s28, 0
    s_atomic_add s12, s[4:5], s30 offset:196608 glc
    s_atomic_add s13, s[4:5], s30 offset:198144 glc
    s_atomic_add s14, s[4:5], s30 offset:199680 glc
    s_atomic_add s28, s[4:5], s30 offset:201216 glc
    v_mov_b32 v2, 0xbfb8aa3b
    s_nop 1
    v_mul_f32_dpp v108, v96, v2 quad_perm:[0,0,0,0] row_mask:0xf bank_mask:0xf
    v_mul_f32_dpp v112, v96, v2 quad_perm:[1,1,1,1] row_mask:0xf bank_mask:0xf
    v_mov_b32_dpp v116, v100 quad_perm:[0,0,0,0] row_mask:0xf bank_mask:0xf
    v_mov_b32_dpp v120, v100 quad_perm:[1,1,1,1] row_mask:0xf bank_mask:0xf
    v_mul_f32_dpp v109, v97, v2 quad_perm:[0,0,0,0] row_mask:0xf bank_mask:0xf
    v_mul_f32_dpp v113, v97, v2 quad_perm:[1,1,1,1] row_mask:0xf bank_mask:0xf
    v_mov_b32_dpp v117, v101 quad_perm:[0,0,0,0] row_mask:0xf bank_mask:0xf
    v_mov_b32_dpp v121, v101 quad_perm:[1,1,1,1] row_mask:0xf bank_mask:0xf
    v_mul_f32_dpp v110, v98, v2 quad_perm:[0,0,0,0] row_mask:0xf bank_mask:0xf
    v_mul_f32_dpp v114, v98, v2 quad_perm:[1,1,1,1] row_mask:0xf bank_mask:0xf
    v_mov_b32_dpp v118, v102 quad_perm:[0,0,0,0] row_mask:0xf bank_mask:0xf
    v_mov_b32_dpp v122, v102 quad_perm:[1,1,1,1] row_mask:0xf bank_mask:0xf
    v_mul_f32_dpp v111, v99, v2 quad_perm:[0,0,0,0] row_mask:0xf bank_mask:0xf
    v_mul_f32_dpp v115, v99, v2 quad_perm:[1,1,1,1] row_mask:0xf bank_mask:0xf
    v_mov_b32_dpp v119, v103 quad_perm:[0,0,0,0] row_mask:0xf bank_mask:0xf
    v_mov_b32_dpp v123, v103 quad_perm:[1,1,1,1] row_mask:0xf bank_mask:0xf
    s_mov_b32 s15, 0
    s_branch POLL2C
POLL2:
    s_mov_b64 s[12:13], 0
    s_mov_b32 s14, 0
    s_mov_b32 s28, 0
    s_atomic_add s12, s[4:5], s30 offset:196608 glc
    s_atomic_add s13, s[4:5], s30 offset:198144 glc
    s_atomic_add s14, s[4:5], s30 offset:199680 glc
    s_atomic_add s28, s[4:5], s30 offset:201216 glc
POLL2C:
    s_add_u32 s15, s15, 1
    s_waitcnt lgkmcnt(0)
    s_min_u32 s12, s12, s13
    s_min_u32 s14, s14, s28
    s_min_u32 s12, s12, s14
    s_cmp_gt_u32 s15, 200000
    s_cbranch_scc1 POLL2X
    s_cmp_lt_u32 s12, 16
    s_cbranch_scc1 POLL2
POLL2X:
    s_branch PRE_J
PRE_S:
    s_and_b32 s13, s3, 1
    s_lshl_b32 s13, s13, 14
    s_bfe_u32 s14, s3, 0x10001
    s_mul_i32 s12, s14, 229376
    s_add_u32 s12, s12, s33
    s_add_u32 s12, s12, 1376384
    s_mul_i32 s14, s14, 8192
    s_add_u32 s13, s13, s14
    s_add_u32 m0, s13, 32768
    s_nop 0
    buffer_load_dwordx4 v27, s[16:19], s12 offen offset:0 lds
    buffer_load_dwordx4 v28, s[16:19], s12 offen offset:1024 lds
    buffer_load_dwordx4 v29, s[16:19], s12 offen offset:2048 lds
    buffer_load_dwordx4 v30, s[16:19], s12 offen offset:3072 lds
    s_add_u32 m0, m0, 4096
    s_add_u32 s12, s12, 114688
    buffer_load_dwordx4 v27, s[16:19], s12 offen offset:0 lds
    buffer_load_dwordx4 v28, s[16:19], s12 offen offset:1024 lds
    buffer_load_dwordx4 v29, s[16:19], s12 offen offset:2048 lds
    buffer_load_dwordx4 v30, s[16:19], s12 offen offset:3072 lds
    s_waitcnt vmcnt(8)
    s_barrier
    s_atomic_add s32, s[4:5], s28 offset:196608
    s_atomic_add s32, s[4:5], s28 offset:221184
    s_atomic_add s32, s[4:5], s28 offset:245760
    s_atomic_add s32, s[4:5], s28 offset:270336
    s_and_b32 s13, s3, 1
    s_lshl_b32 s13, s13, 14
    s_bfe_u32 s14, s3, 0x10001
    s_mul_i32 s12, s14, 229376
    s_add_u32 s12, s12, s33
    s_add_u32 s12, s12, 0
    s_mul_i32 s14, s14, 8192
    s_add_u32 s13, s13, s14
    s_add_u32 m0, s13, 0
    s_nop 0
    buffer_load_dwordx4 v27, s[16:19], s12 offen offset:0 lds
    buffer_load_dwordx4 v28, s[16:19], s12 offen offset:1024 lds
    buffer_load_dwordx4 v29, s[16:19], s12 offen offset:2048 lds
    buffer_load_dwordx4 v30, s[16:19], s12 offen offset:3072 lds
    s_add_u32 m0, m0, 4096
    s_add_u32 s12, s12, 114688
    buffer_load_dwordx4 v27, s[16:19], s12 offen offset:0 lds
    buffer_load_dwordx4 v28, s[16:19], s12 offen offset:1024 lds
    buffer_load_dwordx4 v29, s[16:19], s12 offen offset:2048 lds
    buffer_load_dwordx4 v30, s[16:19], s12 offen offset:3072 lds
    s_waitcnt vmcnt(8)
    s_barrier
    s_and_b32 s13, s3, 1
    s_lshl_b32 s13, s13, 14
    s_bfe_u32 s14, s3, 0x10001
    s_mul_i32 s12, s14, 229376
    s_add_u32 s12, s12, s33
    s_add_u32 s12, s12, 458752
    s_mul_i32 s14, s14, 8192
    s_add_u32 s13, s13, s14
    s_add_u32 m0, s13, 65536
    s_nop 0
    buffer_load_dwordx4 v27, s[16:19], s12 offen offset:0 lds
    buffer_load_dwordx4 v28, s[16:19], s12 offen offset:1024 lds
    buffer_load_dwordx4 v29, s[16:19], s12 offen offset:2048 lds
    buffer_load_dwordx4 v30, s[16:19], s12 offen offset:3072 lds
    s_add_u32 m0, m0, 4096
    s_add_u32 s12, s12, 114688
    buffer_load_dwordx4 v27, s[16:19], s12 offen offset:0 lds
    buffer_load_dwordx4 v28, s[16:19], s12 offen offset:1024 lds
    buffer_load_dwordx4 v29, s[16:19], s12 offen offset:2048 lds
    buffer_load_dwordx4 v30, s[16:19], s12 offen offset:3072 lds
    s_waitcnt vmcnt(8)
    s_barrier
    v_add_u32 v2, 0, v25
    ds_read_b64_tr_b16 v[128:129], v2 offset:0
    ds_read_b64_tr_b16 v[130:131], v2 offset:2048
    ds_read_b64_tr_b16 v[132:133], v2 offset:16384
    ds_read_b64_tr_b16 v[134:135], v2 offset:18432
    ds_read_b64_tr_b16 v[136:137], v2 offset:4096
    ds_read_b64_tr_b16 v[138:139], v2 offset:6144
    ds_read_b64_tr_b16 v[140:141], v2 offset:20480
    ds_read_b64_tr_b16 v[142:143], v2 offset:22528
    ds_read_b64_tr_b16 v[144:145], v2 offset:8192
    ds_read_b64_tr_b16 v[146:147], v2 offset:10240
    ds_read_b64_tr_b16 v[148:149], v2 offset:24576
    ds_read_b64_tr_b16 v[150:151], v2 offset:26624
    ds_read_b64_tr_b16 v[152:153], v2 offset:12288
    ds_read_b64_tr_b16 v[154:155], v2 offset:14336
    ds_read_b64_tr_b16 v[156:157], v2 offset:28672
    ds_read_b64_tr_b16 v[158:159], v2 offset:30720
    s_and_b32 s13, s3, 1
    s_lshl_b32 s13, s13, 14
    s_bfe_u32 s14, s3, 0x10001
    s_mul_i32 s12, s14, 229376
    s_add_u32 s12, s12, s33
    s_add_u32 s12, s12, 917504
    s_mul_i32 s14, s14, 8192
    s_add_u32 s13, s13, s14
    s_add_u32 m0, s13, 98304
    s_nop 0
    buffer_load_dwordx4 v27, s[16:19], s12 offen offset:0 lds
    buffer_load_dwordx4 v28, s[16:19], s12 offen offset:1024 lds
    buffer_load_dwordx4 v29, s[16:19], s12 offen offset:2048 lds
    buffer_load_dwordx4 v30, s[16:19], s12 offen offset:3072 lds
    s_add_u32 m0, m0, 4096
    s_add_u32 s12, s12, 114688
    buffer_load_dwordx4 v27, s[16:19], s12 offen offset:0 lds
    buffer_load_dwordx4 v28, s[16:19], s12 offen offset:1024 lds
    buffer_load_dwordx4 v29, s[16:19], s12 offen offset:2048 lds
    buffer_load_dwordx4 v30, s[16:19], s12 offen offset:3072 lds
    s_and_b32 s13, s3, 1
    s_lshl_b32 s13, s13, 14
    s_bfe_u32 s14, s3, 0x10001
    s_mul_i32 s12, s14, 229376
    s_add_u32 s12, s12, s33
    s_add_u32 s12, s12, 1376256
    s_mul_i32 s14, s14, 8192
    s_add_u32 s13, s13, s14
    s_add_u32 m0, s13, 32768
    s_nop 0
    buffer_load_dwordx4 v27, s[16:19], s12 offen offset:0 lds
    buffer_load_dwordx4 v28, s[16:19], s12 offen offset:1024 lds
    buffer_load_dwordx4 v29, s[16:19], s12 offen offset:2048 lds
    buffer_load_dwordx4 v30, s[16:19], s12 offen offset:3072 lds
    s_add_u32 m0, m0, 4096
    s_add_u32 s12, s12, 114688
    buffer_load_dwordx4 v27, s[16:19], s12 offen offset:0 lds
    buffer_load_dwordx4 v28, s[16:19], s12 offen offset:1024 lds
    buffer_load_dwordx4 v29, s[16:19], s12 offen offset:2048 lds
    buffer_load_dwordx4 v30, s[16:19], s12 offen offset:3072 lds
    s_waitcnt vmcnt(8)
    s_waitcnt lgkmcnt(0)
PRE_J:
    s_barrier
    s_cmp_lt_u32 s3, 4
    s_cbranch_scc1 G1_S
    s_setprio 2
    s_xor_b32 s12, s22, 0
    s_add_u32 m0, s27, 0
    s_nop 0
    buffer_load_dwordx4 v26, s[4:7], s12 offen offset:0 sc1 lds
    buffer_load_dwordx4 v26, s[4:7], s12 offen offset:1024 sc1 lds
    buffer_load_dwordx4 v26, s[4:7], s12 offen offset:2048 sc1 lds
    buffer_load_dwordx4 v26, s[4:7], s12 offen offset:3072 sc1 lds
    s_add_u32 m0, m0, 16384
    s_add_u32 s12, s12, 16384
    buffer_load_dwordx4 v26, s[4:7], s12 offen offset:0 sc1 lds
    buffer_load_dwordx4 v26, s[4:7], s12 offen offset:1024 sc1 lds
    buffer_load_dwordx4 v26, s[4:7], s12 offen offset:2048 sc1 lds
    buffer_load_dwordx4 v26, s[4:7], s12 offen offset:3072 sc1 lds
    s_barrier
    s_waitcnt vmcnt(0)
    s_barrier
    ds_read_b64_tr_b16 v[64:65], v20 offset:0
    ds_read_b64_tr_b16 v[66:67], v20 offset:512
    ds_read_b64_tr_b16 v[68:69], v20 offset:16384
    ds_read_b64_tr_b16 v[70:71], v20 offset:16896
    ds_read_b64_tr_b16 v[72:73], v20 offset:1024
    ds_read_b64_tr_b16 v[74:75], v20 offset:1536
    ds_read_b64_tr_b16 v[76:77], v20 offset:17408
    ds_read_b64_tr_b16 v[78:79], v20 offset:17920
    ds_read_b64_tr_b16 v[80:81], v20 offset:2048
    ds_read_b64_tr_b16 v[82:83], v20 offset:2560
    ds_read_b64_tr_b16 v[84:85], v20 offset:18432
    ds_read_b64_tr_b16 v[86:87], v20 offset:18944
    s_setprio 1
    s_waitcnt lgkmcnt(8)
    v_mfma_f32_16x16x32_bf16 v[32:35], v[128:131], v[64:67], 0
    ds_read_b64_tr_b16 v[88:89], v20 offset:3072
    v_mfma_f32_16x16x32_bf16 v[36:39], v[132:135], v[64:67], 0
    ds_read_b64_tr_b16 v[90:91], v20 offset:3584
    v_mfma_f32_16x16x32_bf16 v[40:43], v[128:131], v[68:71], 0
    ds_read_b64_tr_b16 v[92:93], v20 offset:19456
    v_mfma_f32_16x16x32_bf16 v[44:47], v[132:135], v[68:71], 0
    ds_read_b64_tr_b16 v[94:95], v20 offset:19968
    s_waitcnt lgkmcnt(8)
    v_mfma_f32_16x16x32_bf16 v[32:35], v[136:139], v[72:75], v[32:35]
    ds_read_b64_tr_b16 v[64:65], v20 offset:4096
    v_mfma_f32_16x16x32_bf16 v[36:39], v[140:143], v[72:75], v[36:39]
    ds_read_b64_tr_b16 v[66:67], v20 offset:4608
    v_mfma_f32_16x16x32_bf16 v[40:43], v[136:139], v[76:79], v[40:43]
    ds_read_b64_tr_b16 v[68:69], v20 offset:20480
    v_mfma_f32_16x16x32_bf16 v[44:47], v[140:143], v[76:79], v[44:47]
    ds_read_b64_tr_b16 v[70:71], v20 offset:20992
    s_waitcnt lgkmcnt(8)
    v_mfma_f32_16x16x32_bf16 v[32:35], v[144:147], v[80:83], v[32:35]
    ds_read_b64_tr_b16 v[72:73], v20 offset:5120
    v_mfma_f32_16x16x32_bf16 v[36:39], v[148:151], v[80:83], v[36:39]
    ds_read_b64_tr_b16 v[74:75], v20 offset:5632
    v_mfma_f32_16x16x32_bf16 v[40:43], v[144:147], v[84:87], v[40:43]
    ds_read_b64_tr_b16 v[76:77], v20 offset:21504
    v_mfma_f32_16x16x32_bf16 v[44:47], v[148:151], v[84:87], v[44:47]
    ds_read_b64_tr_b16 v[78:79], v20 offset:22016
    s_waitcnt lgkmcnt(8)
    v_mfma_f32_16x16x32_bf16 v[32:35], v[152:155], v[88:91], v[32:35]
    ds_read_b64_tr_b16 v[80:81], v20 offset:6144
    v_mfma_f32_16x16x32_bf16 v[36:39], v[156:159], v[88:91], v[36:39]
    ds_read_b64_tr_b16 v[82:83], v20 offset:6656
    v_mfma_f32_16x16x32_bf16 v[40:43], v[152:155], v[92:95], v[40:43]
    ds_read_b64_tr_b16 v[84:85], v20 offset:22528
    v_mfma_f32_16x16x32_bf16 v[44:47], v[156:159], v[92:95], v[44:47]
    ds_read_b64_tr_b16 v[86:87], v20 offset:23040
    s_waitcnt lgkmcnt(8)
    v_mfma_f32_16x16x32_bf16 v[32:35], v[160:163], v[64:67], v[32:35]
    ds_read_b64_tr_b16 v[88:89], v20 offset:7168
    v_mfma_f32_16x16x32_bf16 v[36:39], v[164:167], v[64:67], v[36:39]
    ds_read_b64_tr_b16 v[90:91], v20 offset:7680
    v_mfma_f32_16x16x32_bf16 v[40:43], v[160:163], v[68:71], v[40:43]
    ds_read_b64_tr_b16 v[92:93], v20 offset:23552
    v_mfma_f32_16x16x32_bf16 v[44:47], v[164:167], v[68:71], v[44:47]
    ds_read_b64_tr_b16 v[94:95], v20 offset:24064
    s_waitcnt lgkmcnt(8)
    v_mfma_f32_16x16x32_bf16 v[32:35], v[168:171], v[72:75], v[32:35]
    ds_read_b64_tr_b16 v[64:65], v20 offset:8192
    v_mfma_f32_16x16x32_bf16 v[36:39], v[172:175], v[72:75], v[36:39]
    ds_read_b64_tr_b16 v[66:67], v20 offset:8704
    v_mfma_f32_16x16x32_bf16 v[40:43], v[168:171], v[76:79], v[40:43]
    ds_read_b64_tr_b16 v[68:69], v20 offset:24576
    v_mfma_f32_16x16x32_bf16 v[44:47], v[172:175], v[76:79], v[44:47]
    ds_read_b64_tr_b16 v[70:71], v20 offset:25088
    s_waitcnt lgkmcnt(8)
    v_mfma_f32_16x16x32_bf16 v[32:35], v[176:179], v[80:83], v[32:35]
    ds_read_b64_tr_b16 v[72:73], v20 offset:9216
    v_mfma_f32_16x16x32_bf16 v[36:39], v[180:183], v[80:83], v[36:39]
    ds_read_b64_tr_b16 v[74:75], v20 offset:9728
    v_mfma_f32_16x16x32_bf16 v[40:43], v[176:179], v[84:87], v[40:43]
    ds_read_b64_tr_b16 v[76:77], v20 offset:25600
    v_mfma_f32_16x16x32_bf16 v[44:47], v[180:183], v[84:87], v[44:47]
    ds_read_b64_tr_b16 v[78:79], v20 offset:26112
    s_waitcnt lgkmcnt(8)
    v_mfma_f32_16x16x32_bf16 v[32:35], v[184:187], v[88:91], v[32:35]
    ds_read_b64_tr_b16 v[80:81], v20 offset:10240
    v_mfma_f32_16x16x32_bf16 v[36:39], v[188:191], v[88:91], v[36:39]
    ds_read_b64_tr_b16 v[82:83], v20 offset:10752
    v_mfma_f32_16x16x32_bf16 v[40:43], v[184:187], v[92:95], v[40:43]
    ds_read_b64_tr_b16 v[84:85], v20 offset:26624
    v_mfma_f32_16x16x32_bf16 v[44:47], v[188:191], v[92:95], v[44:47]
    ds_read_b64_tr_b16 v[86:87], v20 offset:27136
    s_waitcnt lgkmcnt(8)
    v_mfma_f32_16x16x32_bf16 v[32:35], v[192:195], v[64:67], v[32:35]
    ds_read_b64_tr_b16 v[88:89], v20 offset:11264
    v_mfma_f32_16x16x32_bf16 v[36:39], v[196:199], v[64:67], v[36:39]
    ds_read_b64_tr_b16 v[90:91], v20 offset:11776
    v_mfma_f32_16x16x32_bf16 v[40:43], v[192:195], v[68:71], v[40:43]
    ds_read_b64_tr_b16 v[92:93], v20 offset:27648
    v_mfma_f32_16x16x32_bf16 v[44:47], v[196:199], v[68:71], v[44:47]
    ds_read_b64_tr_b16 v[94:95], v20 offset:28160
    s_waitcnt lgkmcnt(8)
    v_mfma_f32_16x16x32_bf16 v[32:35], v[200:203], v[72:75], v[32:35]
    ds_read_b64_tr_b16 v[64:65], v20 offset:12288
    v_mfma_f32_16x16x32_bf16 v[36:39], v[204:207], v[72:75], v[36:39]
    ds_read_b64_tr_b16 v[66:67], v20 offset:12800
    v_mfma_f32_16x16x32_bf16 v[40:43], v[200:203], v[76:79], v[40:43]
    ds_read_b64_tr_b16 v[68:69], v20 offset:28672
    v_mfma_f32_16x16x32_bf16 v[44:47], v[204:207], v[76:79], v[44:47]
    ds_read_b64_tr_b16 v[70:71], v20 offset:29184
    s_waitcnt lgkmcnt(8)
    v_mfma_f32_16x16x32_bf16 v[32:35], v[208:211], v[80:83], v[32:35]
    ds_read_b64_tr_b16 v[72:73], v20 offset:13312
    v_mfma_f32_16x16x32_bf16 v[36:39], v[212:215], v[80:83], v[36:39]
    ds_read_b64_tr_b16 v[74:75], v20 offset:13824
    v_mfma_f32_16x16x32_bf16 v[40:43], v[208:211], v[84:87], v[40:43]
    ds_read_b64_tr_b16 v[76:77], v20 offset:29696
    v_mfma_f32_16x16x32_bf16 v[44:47], v[212:215], v[84:87], v[44:47]
    ds_read_b64_tr_b16 v[78:79], v20 offset:30208
    s_waitcnt lgkmcnt(8)
    s_mov_b32 m0, 159744
    s_nop 0
    buffer_load_dwordx4 v26, s[4:7], s25 offen sc1 lds
    buffer_load_dwordx4 v26, s[4:7], s25 offen offset:1024 sc1 lds
    v_mfma_f32_16x16x32_bf16 v[32:35], v[216:219], v[88:91], v[32:35]
    ds_read_b64_tr_b16 v[80:81], v20 offset:14336
    v_mfma_f32_16x16x32_bf16 v[36:39], v[220:223], v[88:91], v[36:39]
    ds_read_b64_tr_b16 v[82:83], v20 offset:14848
    v_mfma_f32_16x16x32_bf16 v[40:43], v[216:219], v[92:95], v[40:43]
    ds_read_b64_tr_b16 v[84:85], v20 offset:30720
    v_mfma_f32_16x16x32_bf16 v[44:47], v[220:223], v[92:95], v[44:47]
    ds_read_b64_tr_b16 v[86:87], v20 offset:31232
    s_waitcnt lgkmcnt(8)
    v_mfma_f32_16x16x32_bf16 v[32:35], v[224:227], v[64:67], v[32:35]
    ds_read_b64_tr_b16 v[88:89], v20 offset:15360
    v_mfma_f32_16x16x32_bf16 v[36:39], v[228:231], v[64:67], v[36:39]
    ds_read_b64_tr_b16 v[90:91], v20 offset:15872
    v_mfma_f32_16x16x32_bf16 v[40:43], v[224:227], v[68:71], v[40:43]
    ds_read_b64_tr_b16 v[92:93], v20 offset:31744
    v_mfma_f32_16x16x32_bf16 v[44:47], v[228:231], v[68:71], v[44:47]
    ds_read_b64_tr_b16 v[94:95], v20 offset:32256
    s_waitcnt lgkmcnt(8)
    v_mfma_f32_16x16x32_bf16 v[32:35], v[232:235], v[72:75], v[32:35]
    v_mfma_f32_16x16x32_bf16 v[36:39], v[236:239], v[72:75], v[36:39]
    v_mfma_f32_16x16x32_bf16 v[40:43], v[232:235], v[76:79], v[40:43]
    v_mfma_f32_16x16x32_bf16 v[44:47], v[236:239], v[76:79], v[44:47]
    s_waitcnt lgkmcnt(4)
    v_mfma_f32_16x16x32_bf16 v[32:35], v[240:243], v[80:83], v[32:35]
    v_mfma_f32_16x16x32_bf16 v[36:39], v[244:247], v[80:83], v[36:39]
    v_mfma_f32_16x16x32_bf16 v[40:43], v[240:243], v[84:87], v[40:43]
    v_mfma_f32_16x16x32_bf16 v[44:47], v[244:247], v[84:87], v[44:47]
    s_waitcnt lgkmcnt(0)
    s_setprio 2
    v_mfma_f32_16x16x32_bf16 v[32:35], v[248:251], v[88:91], v[32:35]
    v_mfma_f32_16x16x32_bf16 v[36:39], v[252:255], v[88:91], v[36:39]
    v_mfma_f32_16x16x32_bf16 v[40:43], v[248:251], v[92:95], v[40:43]
    v_mfma_f32_16x16x32_bf16 v[44:47], v[252:255], v[92:95], v[44:47]
    v_add_u32 v2, 159756, v26
    s_mov_b32 s15, 0
    s_waitcnt vmcnt(0)
    s_branch STPC
STP:
    s_mov_b32 m0, 159744
    s_nop 0
    buffer_load_dwordx4 v26, s[4:7], s25 offen sc1 lds
    buffer_load_dwordx4 v26, s[4:7], s25 offen offset:1024 sc1 lds
    s_waitcnt vmcnt(0)
STPC:
    ds_read2st64_b32 v[4:5], v2 offset0:0 offset1:4
    ds_read_b128 v[100:103], v124 offset:0
    ds_read_b128 v[22:25], v124 offset:256
    s_add_u32 s15, s15, 1
    s_waitcnt lgkmcnt(0)
    v_cmp_ne_u32 vcc, s40, v4
    v_cmp_ne_u32_e64 s[12:13], s40, v5
    s_nop 0
    s_or_b64 vcc, vcc, s[12:13]
    s_cmp_gt_u32 s15, 200000
    s_cbranch_scc1 STPX
    s_cbranch_vccnz STP
STPX:
    v_fma_f32 v8, v101, v108, v112
    v_fma_f32 v9, v101, v109, v113
    v_fma_f32 v10, v101, v110, v114
    v_fma_f32 v11, v101, v111, v115
    v_fmac_f32 v8, v102, v32
    v_fmac_f32 v9, v102, v33
    v_fmac_f32 v10, v102, v34
    v_fmac_f32 v11, v102, v35
    v_exp_f32 v8, v8
    s_xor_b32 s12, s44, 0
    s_add_u32 m0, s27, 98304
    s_nop 0
    buffer_load_dwordx4 v26, s[4:7], s12 offen offset:0 sc1 lds
    v_fma_f32 v12, v101, v116, v120
    v_exp_f32 v9, v9
    v_fma_f32 v13, v101, v117, v121
    v_exp_f32 v10, v10
    v_fma_f32 v14, v101, v118, v122
    v_exp_f32 v11, v11
    v_fma_f32 v15, v101, v119, v123
    v_add_f32 v8, 1.0, v8
    buffer_load_dwordx4 v26, s[4:7], s12 offen offset:1024 sc1 lds
    v_add_f32 v9, 1.0, v9
    v_add_f32 v10, 1.0, v10
    v_add_f32 v11, 1.0, v11
    v_rcp_f32 v8, v8
    v_fmac_f32 v12, v100, v36
    v_rcp_f32 v9, v9
    v_fmac_f32 v13, v100, v37
    v_rcp_f32 v10, v10
    v_fmac_f32 v14, v100, v38
    buffer_load_dwordx4 v26, s[4:7], s12 offen offset:2048 sc1 lds
    v_rcp_f32 v11, v11
    v_fmac_f32 v15, v100, v39
    v_mul_f32 v8, v8, v12
    v_mul_f32 v9, v9, v13
    v_mul_f32 v10, v10, v14
    v_mul_f32 v11, v11, v15
    v_cvt_pk_bf16_f32 v96, v8, v9
    v_cvt_pk_bf16_f32 v97, v10, v11
    buffer_load_dwordx4 v26, s[4:7], s12 offen offset:3072 sc1 lds
    v_fma_f32 v8, v23, v108, v112
    v_fma_f32 v9, v23, v109, v113
    v_fma_f32 v10, v23, v110, v114
    v_fma_f32 v11, v23, v111, v115
    v_fmac_f32 v8, v24, v40
    v_fmac_f32 v9, v24, v41
    v_fmac_f32 v10, v24, v42
    v_fmac_f32 v11, v24, v43
    v_exp_f32 v8, v8
    s_add_u32 m0, m0, 16384
    s_add_u32 s12, s12, 16384
    buffer_load_dwordx4 v26, s[4:7], s12 offen offset:0 sc1 lds
    v_fma_f32 v12, v23, v116, v120
    v_exp_f32 v9, v9
    v_fma_f32 v13, v23, v117, v121
    v_exp_f32 v10, v10
    v_fma_f32 v14, v23, v118, v122
    v_exp_f32 v11, v11
    v_fma_f32 v15, v23, v119, v123
    v_add_f32 v8, 1.0, v8
    buffer_load_dwordx4 v26, s[4:7], s12 offen offset:1024 sc1 lds
    v_add_f32 v9, 1.0, v9
    v_add_f32 v10, 1.0, v10
    v_add_f32 v11, 1.0, v11
    v_rcp_f32 v8, v8
    v_fmac_f32 v12, v22, v44
    v_rcp_f32 v9, v9
    v_fmac_f32 v13, v22, v45
    v_rcp_f32 v10, v10
    v_fmac_f32 v14, v22, v46
    buffer_load_dwordx4 v26, s[4:7], s12 offen offset:2048 sc1 lds
    v_rcp_f32 v11, v11
    v_fmac_f32 v15, v22, v47
    v_mul_f32 v8, v8, v12
    v_mul_f32 v9, v9, v13
    v_mul_f32 v10, v10, v14
    v_mul_f32 v11, v11, v15
    v_cvt_pk_bf16_f32 v98, v8, v9
    v_cvt_pk_bf16_f32 v99, v10, v11
    buffer_load_dwordx4 v26, s[4:7], s12 offen offset:3072 sc1 lds
    v_permlane32_swap_b32 v96, v98
    v_permlane32_swap_b32 v97, v99
    buffer_store_dwordx4 v[96:99], v18, s[4:7], s24 offen sc1
    ds_read_b128 v[100:103], v124 offset:512
    ds_read_b128 v[22:25], v124 offset:768
    s_branch PG_10
.p2align 12
PG_10:
    s_barrier
    v_add_u32 v20, 65536, v20
    ds_read_b64_tr_b16 v[64:65], v20 offset:0
    ds_read_b64_tr_b16 v[66:67], v20 offset:512
    ds_read_b64_tr_b16 v[68:69], v20 offset:16384
    ds_read_b64_tr_b16 v[70:71], v20 offset:16896
    ds_read_b64_tr_b16 v[72:73], v20 offset:1024
    ds_read_b64_tr_b16 v[74:75], v20 offset:1536
    ds_read_b64_tr_b16 v[76:77], v20 offset:17408
    ds_read_b64_tr_b16 v[78:79], v20 offset:17920
    ds_read_b64_tr_b16 v[80:81], v20 offset:2048
    ds_read_b64_tr_b16 v[82:83], v20 offset:2560
    ds_read_b64_tr_b16 v[84:85], v20 offset:18432
    ds_read_b64_tr_b16 v[86:87], v20 offset:18944
    s_setprio 1
    s_waitcnt lgkmcnt(8)
    v_mfma_f32_16x16x32_bf16 v[48:51], v[128:131], v[64:67], 0
    ds_read_b64_tr_b16 v[88:89], v20 offset:3072
    v_mfma_f32_16x16x32_bf16 v[52:55], v[132:135], v[64:67], 0
    ds_read_b64_tr_b16 v[90:91], v20 offset:3584
    v_mfma_f32_16x16x32_bf16 v[56:59], v[128:131], v[68:71], 0
    ds_read_b64_tr_b16 v[92:93], v20 offset:19456
    v_mfma_f32_16x16x32_bf16 v[60:63], v[132:135], v[68:71], 0
    ds_read_b64_tr_b16 v[94:95], v20 offset:19968
    s_waitcnt lgkmcnt(8)
    v_mfma_f32_16x16x32_bf16 v[48:51], v[136:139], v[72:75], v[48:51]
    ds_read_b64_tr_b16 v[64:65], v20 offset:4096
    v_mfma_f32_16x16x32_bf16 v[52:55], v[140:143], v[72:75], v[52:55]
    ds_read_b64_tr_b16 v[66:67], v20 offset:4608
    v_mfma_f32_16x16x32_bf16 v[56:59], v[136:139], v[76:79], v[56:59]
    ds_read_b64_tr_b16 v[68:69], v20 offset:20480
    v_mfma_f32_16x16x32_bf16 v[60:63], v[140:143], v[76:79], v[60:63]
    ds_read_b64_tr_b16 v[70:71], v20 offset:20992
    s_waitcnt lgkmcnt(8)
    v_mfma_f32_16x16x32_bf16 v[48:51], v[144:147], v[80:83], v[48:51]
    ds_read_b64_tr_b16 v[72:73], v20 offset:5120
    v_mfma_f32_16x16x32_bf16 v[52:55], v[148:151], v[80:83], v[52:55]
    ds_read_b64_tr_b16 v[74:75], v20 offset:5632
    v_mfma_f32_16x16x32_bf16 v[56:59], v[144:147], v[84:87], v[56:59]
    ds_read_b64_tr_b16 v[76:77], v20 offset:21504
    v_mfma_f32_16x16x32_bf16 v[60:63], v[148:151], v[84:87], v[60:63]
    ds_read_b64_tr_b16 v[78:79], v20 offset:22016
    s_waitcnt lgkmcnt(8)
    v_mfma_f32_16x16x32_bf16 v[48:51], v[152:155], v[88:91], v[48:51]
    ds_read_b64_tr_b16 v[80:81], v20 offset:6144
    v_mfma_f32_16x16x32_bf16 v[52:55], v[156:159], v[88:91], v[52:55]
    ds_read_b64_tr_b16 v[82:83], v20 offset:6656
    v_mfma_f32_16x16x32_bf16 v[56:59], v[152:155], v[92:95], v[56:59]
    ds_read_b64_tr_b16 v[84:85], v20 offset:22528
    v_mfma_f32_16x16x32_bf16 v[60:63], v[156:159], v[92:95], v[60:63]
    ds_read_b64_tr_b16 v[86:87], v20 offset:23040
    s_waitcnt lgkmcnt(8)
    v_mfma_f32_16x16x32_bf16 v[48:51], v[160:163], v[64:67], v[48:51]
    ds_read_b64_tr_b16 v[88:89], v20 offset:7168
    v_mfma_f32_16x16x32_bf16 v[52:55], v[164:167], v[64:67], v[52:55]
    ds_read_b64_tr_b16 v[90:91], v20 offset:7680
    v_mfma_f32_16x16x32_bf16 v[56:59], v[160:163], v[68:71], v[56:59]
    ds_read_b64_tr_b16 v[92:93], v20 offset:23552
    v_mfma_f32_16x16x32_bf16 v[60:63], v[164:167], v[68:71], v[60:63]
    ds_read_b64_tr_b16 v[94:95], v20 offset:24064
    s_waitcnt lgkmcnt(8)
    v_mfma_f32_16x16x32_bf16 v[48:51], v[168:171], v[72:75], v[48:51]
    ds_read_b64_tr_b16 v[64:65], v20 offset:8192
    v_mfma_f32_16x16x32_bf16 v[52:55], v[172:175], v[72:75], v[52:55]
    ds_read_b64_tr_b16 v[66:67], v20 offset:8704
    v_mfma_f32_16x16x32_bf16 v[56:59], v[168:171], v[76:79], v[56:59]
    ds_read_b64_tr_b16 v[68:69], v20 offset:24576
    v_mfma_f32_16x16x32_bf16 v[60:63], v[172:175], v[76:79], v[60:63]
    ds_read_b64_tr_b16 v[70:71], v20 offset:25088
    s_waitcnt lgkmcnt(8)
    v_mfma_f32_16x16x32_bf16 v[48:51], v[176:179], v[80:83], v[48:51]
    ds_read_b64_tr_b16 v[72:73], v20 offset:9216
    v_mfma_f32_16x16x32_bf16 v[52:55], v[180:183], v[80:83], v[52:55]
    ds_read_b64_tr_b16 v[74:75], v20 offset:9728
    v_mfma_f32_16x16x32_bf16 v[56:59], v[176:179], v[84:87], v[56:59]
    ds_read_b64_tr_b16 v[76:77], v20 offset:25600
    v_mfma_f32_16x16x32_bf16 v[60:63], v[180:183], v[84:87], v[60:63]
    ds_read_b64_tr_b16 v[78:79], v20 offset:26112
    s_waitcnt lgkmcnt(8)
    v_mfma_f32_16x16x32_bf16 v[48:51], v[184:187], v[88:91], v[48:51]
    ds_read_b64_tr_b16 v[80:81], v20 offset:10240
    v_mfma_f32_16x16x32_bf16 v[52:55], v[188:191], v[88:91], v[52:55]
    ds_read_b64_tr_b16 v[82:83], v20 offset:10752
    v_mfma_f32_16x16x32_bf16 v[56:59], v[184:187], v[92:95], v[56:59]
    ds_read_b64_tr_b16 v[84:85], v20 offset:26624
    v_mfma_f32_16x16x32_bf16 v[60:63], v[188:191], v[92:95], v[60:63]
    ds_read_b64_tr_b16 v[86:87], v20 offset:27136
    s_waitcnt lgkmcnt(8)
    v_mfma_f32_16x16x32_bf16 v[48:51], v[192:195], v[64:67], v[48:51]
    ds_read_b64_tr_b16 v[88:89], v20 offset:11264
    v_mfma_f32_16x16x32_bf16 v[52:55], v[196:199], v[64:67], v[52:55]
    ds_read_b64_tr_b16 v[90:91], v20 offset:11776
    v_mfma_f32_16x16x32_bf16 v[56:59], v[192:195], v[68:71], v[56:59]
    ds_read_b64_tr_b16 v[92:93], v20 offset:27648
    v_mfma_f32_16x16x32_bf16 v[60:63], v[196:199], v[68:71], v[60:63]
    ds_read_b64_tr_b16 v[94:95], v20 offset:28160
    s_waitcnt lgkmcnt(8)
    v_mfma_f32_16x16x32_bf16 v[48:51], v[200:203], v[72:75], v[48:51]
    ds_read_b64_tr_b16 v[64:65], v20 offset:12288
    v_mfma_f32_16x16x32_bf16 v[52:55], v[204:207], v[72:75], v[52:55]
    ds_read_b64_tr_b16 v[66:67], v20 offset:12800
    v_mfma_f32_16x16x32_bf16 v[56:59], v[200:203], v[76:79], v[56:59]
    ds_read_b64_tr_b16 v[68:69], v20 offset:28672
    v_mfma_f32_16x16x32_bf16 v[60:63], v[204:207], v[76:79], v[60:63]
    ds_read_b64_tr_b16 v[70:71], v20 offset:29184
    s_waitcnt lgkmcnt(8)
    v_mfma_f32_16x16x32_bf16 v[48:51], v[208:211], v[80:83], v[48:51]
    ds_read_b64_tr_b16 v[72:73], v20 offset:13312
    v_mfma_f32_16x16x32_bf16 v[52:55], v[212:215], v[80:83], v[52:55]
    ds_read_b64_tr_b16 v[74:75], v20 offset:13824
    v_mfma_f32_16x16x32_bf16 v[56:59], v[208:211], v[84:87], v[56:59]
    ds_read_b64_tr_b16 v[76:77], v20 offset:29696
    v_mfma_f32_16x16x32_bf16 v[60:63], v[212:215], v[84:87], v[60:63]
    ds_read_b64_tr_b16 v[78:79], v20 offset:30208
    s_waitcnt lgkmcnt(8)
    v_mfma_f32_16x16x32_bf16 v[48:51], v[216:219], v[88:91], v[48:51]
    ds_read_b64_tr_b16 v[80:81], v20 offset:14336
    v_mfma_f32_16x16x32_bf16 v[52:55], v[220:223], v[88:91], v[52:55]
    ds_read_b64_tr_b16 v[82:83], v20 offset:14848
    v_mfma_f32_16x16x32_bf16 v[56:59], v[216:219], v[92:95], v[56:59]
    ds_read_b64_tr_b16 v[84:85], v20 offset:30720
    v_mfma_f32_16x16x32_bf16 v[60:63], v[220:223], v[92:95], v[60:63]
    ds_read_b64_tr_b16 v[86:87], v20 offset:31232
    s_waitcnt lgkmcnt(8)
    v_mfma_f32_16x16x32_bf16 v[48:51], v[224:227], v[64:67], v[48:51]
    ds_read_b64_tr_b16 v[88:89], v20 offset:15360
    v_mfma_f32_16x16x32_bf16 v[52:55], v[228:231], v[64:67], v[52:55]
    ds_read_b64_tr_b16 v[90:91], v20 offset:15872
    v_mfma_f32_16x16x32_bf16 v[56:59], v[224:227], v[68:71], v[56:59]
    ds_read_b64_tr_b16 v[92:93], v20 offset:31744
    v_mfma_f32_16x16x32_bf16 v[60:63], v[228:231], v[68:71], v[60:63]
    ds_read_b64_tr_b16 v[94:95], v20 offset:32256
    s_waitcnt lgkmcnt(8)
    v_mfma_f32_16x16x32_bf16 v[48:51], v[232:235], v[72:75], v[48:51]
    v_mfma_f32_16x16x32_bf16 v[52:55], v[236:239], v[72:75], v[52:55]
    v_mfma_f32_16x16x32_bf16 v[56:59], v[232:235], v[76:79], v[56:59]
    v_mfma_f32_16x16x32_bf16 v[60:63], v[236:239], v[76:79], v[60:63]
    s_waitcnt lgkmcnt(4)
    v_mfma_f32_16x16x32_bf16 v[48:51], v[240:243], v[80:83], v[48:51]
    v_mfma_f32_16x16x32_bf16 v[52:55], v[244:247], v[80:83], v[52:55]
    v_mfma_f32_16x16x32_bf16 v[56:59], v[240:243], v[84:87], v[56:59]
    v_mfma_f32_16x16x32_bf16 v[60:63], v[244:247], v[84:87], v[60:63]
    s_waitcnt lgkmcnt(0)
    s_setprio 2
    s_waitcnt vmcnt(0)
    s_barrier
    v_mfma_f32_16x16x32_bf16 v[48:51], v[248:251], v[88:91], v[48:51]
    v_mfma_f32_16x16x32_bf16 v[52:55], v[252:255], v[88:91], v[52:55]
    v_mfma_f32_16x16x32_bf16 v[56:59], v[248:251], v[92:95], v[56:59]
    v_mfma_f32_16x16x32_bf16 v[60:63], v[252:255], v[92:95], v[60:63]
    s_add_u32 s28, s24, 114688
    v_fma_f32 v8, v101, v108, v112
    v_fma_f32 v9, v101, v109, v113
    v_fma_f32 v10, v101, v110, v114
    v_fma_f32 v11, v101, v111, v115
    v_fmac_f32 v8, v102, v48
    v_fmac_f32 v9, v102, v49
    v_fmac_f32 v10, v102, v50
    v_fmac_f32 v11, v102, v51
    v_exp_f32 v8, v8
    v_fma_f32 v12, v101, v116, v120
    v_exp_f32 v9, v9
    v_fma_f32 v13, v101, v117, v121
    s_lshl_b32 s12, s47, 2
    s_and_b32 s13, s3, 3
    s_add_u32 s12, s12, s13
    s_lshl_b32 s12, s12, 14
    s_lshl_b32 s14, s35, 11
    s_add_u32 s12, s12, s14
    s_add_u32 s12, s12, 3145728
    s_lshl_b32 s13, s13, 11
    s_add_u32 m0, s13, 147456
    s_nop 0
    buffer_load_dwordx4 v26, s[4:7], s12 offen sc1 lds
    v_exp_f32 v10, v10
    v_fma_f32 v14, v101, v118, v122
    v_exp_f32 v11, v11
    v_fma_f32 v15, v101, v119, v123
    v_add_f32 v8, 1.0, v8
    v_add_f32 v9, 1.0, v9
    v_add_f32 v10, 1.0, v10
    v_add_f32 v11, 1.0, v11
    v_rcp_f32 v8, v8
    v_fmac_f32 v12, v100, v52
    v_rcp_f32 v9, v9
    buffer_load_dwordx4 v26, s[4:7], s12 offen offset:1024 sc1 lds
    v_fmac_f32 v13, v100, v53
    v_rcp_f32 v10, v10
    v_fmac_f32 v14, v100, v54
    v_rcp_f32 v11, v11
    v_fmac_f32 v15, v100, v55
    v_mul_f32 v8, v8, v12
    v_mul_f32 v9, v9, v13
    v_mul_f32 v10, v10, v14
    v_mul_f32 v11, v11, v15
    v_cvt_pk_bf16_f32 v96, v8, v9
    v_cvt_pk_bf16_f32 v97, v10, v11
    s_add_u32 m0, s27, 131072
    s_add_u32 s12, s20, 65536
    buffer_load_dwordx4 v104, s[36:39], s12 offen offset:0 lds
    v_fma_f32 v8, v23, v108, v112
    v_fma_f32 v9, v23, v109, v113
    v_fma_f32 v10, v23, v110, v114
    v_fma_f32 v11, v23, v111, v115
    v_fmac_f32 v8, v24, v56
    v_fmac_f32 v9, v24, v57
    v_fmac_f32 v10, v24, v58
    v_fmac_f32 v11, v24, v59
    v_exp_f32 v8, v8
    v_fma_f32 v12, v23, v116, v120
    v_exp_f32 v9, v9
    v_fma_f32 v13, v23, v117, v121
    buffer_load_dwordx4 v105, s[36:39], s12 offen offset:1024 lds
    v_exp_f32 v10, v10
    v_fma_f32 v14, v23, v118, v122
    v_exp_f32 v11, v11
    v_fma_f32 v15, v23, v119, v123
    v_add_f32 v8, 1.0, v8
    v_add_f32 v9, 1.0, v9
    v_add_f32 v10, 1.0, v10
    v_add_f32 v11, 1.0, v11
    v_rcp_f32 v8, v8
    v_fmac_f32 v12, v22, v60
    v_rcp_f32 v9, v9
    buffer_load_dwordx4 v106, s[36:39], s12 offen offset:2048 lds
    v_fmac_f32 v13, v22, v61
    v_rcp_f32 v10, v10
    v_fmac_f32 v14, v22, v62
    v_rcp_f32 v11, v11
    v_fmac_f32 v15, v22, v63
    v_mul_f32 v8, v8, v12
    v_mul_f32 v9, v9, v13
    v_mul_f32 v10, v10, v14
    v_mul_f32 v11, v11, v15
    v_cvt_pk_bf16_f32 v98, v8, v9
    v_cvt_pk_bf16_f32 v99, v10, v11
    buffer_load_dwordx4 v107, s[36:39], s12 offen offset:3072 lds
    v_permlane32_swap_b32 v96, v98
    v_permlane32_swap_b32 v97, v99
    buffer_store_dwordx4 v[96:99], v18, s[4:7], s28 offen sc1
    ds_read_b128 v[100:103], v7 offset:0
    ds_read_b128 v[22:25], v7 offset:256
    v_add_u32 v20, 32768, v20
    ds_read_b64_tr_b16 v[64:65], v20 offset:0
    ds_read_b64_tr_b16 v[66:67], v20 offset:512
    ds_read_b64_tr_b16 v[68:69], v20 offset:16384
    ds_read_b64_tr_b16 v[70:71], v20 offset:16896
    ds_read_b64_tr_b16 v[72:73], v20 offset:1024
    ds_read_b64_tr_b16 v[74:75], v20 offset:1536
    ds_read_b64_tr_b16 v[76:77], v20 offset:17408
    ds_read_b64_tr_b16 v[78:79], v20 offset:17920
    ds_read_b64_tr_b16 v[80:81], v20 offset:2048
    ds_read_b64_tr_b16 v[82:83], v20 offset:2560
    ds_read_b64_tr_b16 v[84:85], v20 offset:18432
    ds_read_b64_tr_b16 v[86:87], v20 offset:18944
    s_barrier
    s_setprio 1
    s_waitcnt lgkmcnt(8)
    v_mfma_f32_16x16x32_bf16 v[32:35], v[128:131], v[64:67], 0
    ds_read_b64_tr_b16 v[88:89], v20 offset:3072
    v_mfma_f32_16x16x32_bf16 v[36:39], v[132:135], v[64:67], 0
    ds_read_b64_tr_b16 v[90:91], v20 offset:3584
    v_mfma_f32_16x16x32_bf16 v[40:43], v[128:131], v[68:71], 0
    ds_read_b64_tr_b16 v[92:93], v20 offset:19456
    v_mfma_f32_16x16x32_bf16 v[44:47], v[132:135], v[68:71], 0
    ds_read_b64_tr_b16 v[94:95], v20 offset:19968
    s_waitcnt lgkmcnt(8)
    v_mfma_f32_16x16x32_bf16 v[32:35], v[136:139], v[72:75], v[32:35]
    ds_read_b64_tr_b16 v[64:65], v20 offset:4096
    v_mfma_f32_16x16x32_bf16 v[36:39], v[140:143], v[72:75], v[36:39]
    ds_read_b64_tr_b16 v[66:67], v20 offset:4608
    v_mfma_f32_16x16x32_bf16 v[40:43], v[136:139], v[76:79], v[40:43]
    ds_read_b64_tr_b16 v[68:69], v20 offset:20480
    v_mfma_f32_16x16x32_bf16 v[44:47], v[140:143], v[76:79], v[44:47]
    ds_read_b64_tr_b16 v[70:71], v20 offset:20992
    s_waitcnt lgkmcnt(8)
    v_mfma_f32_16x16x32_bf16 v[32:35], v[144:147], v[80:83], v[32:35]
    ds_read_b64_tr_b16 v[72:73], v20 offset:5120
    v_mfma_f32_16x16x32_bf16 v[36:39], v[148:151], v[80:83], v[36:39]
    ds_read_b64_tr_b16 v[74:75], v20 offset:5632
    v_mfma_f32_16x16x32_bf16 v[40:43], v[144:147], v[84:87], v[40:43]
    ds_read_b64_tr_b16 v[76:77], v20 offset:21504
    v_mfma_f32_16x16x32_bf16 v[44:47], v[148:151], v[84:87], v[44:47]
    ds_read_b64_tr_b16 v[78:79], v20 offset:22016
    s_waitcnt lgkmcnt(8)
    v_mfma_f32_16x16x32_bf16 v[32:35], v[152:155], v[88:91], v[32:35]
    ds_read_b64_tr_b16 v[80:81], v20 offset:6144
    v_mfma_f32_16x16x32_bf16 v[36:39], v[156:159], v[88:91], v[36:39]
    ds_read_b64_tr_b16 v[82:83], v20 offset:6656
    v_mfma_f32_16x16x32_bf16 v[40:43], v[152:155], v[92:95], v[40:43]
    ds_read_b64_tr_b16 v[84:85], v20 offset:22528
    v_mfma_f32_16x16x32_bf16 v[44:47], v[156:159], v[92:95], v[44:47]
    ds_read_b64_tr_b16 v[86:87], v20 offset:23040
    s_waitcnt lgkmcnt(8)
    v_mfma_f32_16x16x32_bf16 v[32:35], v[160:163], v[64:67], v[32:35]
    ds_read_b64_tr_b16 v[88:89], v20 offset:7168
    v_mfma_f32_16x16x32_bf16 v[36:39], v[164:167], v[64:67], v[36:39]
    ds_read_b64_tr_b16 v[90:91], v20 offset:7680
    v_mfma_f32_16x16x32_bf16 v[40:43], v[160:163], v[68:71], v[40:43]
    ds_read_b64_tr_b16 v[92:93], v20 offset:23552
    v_mfma_f32_16x16x32_bf16 v[44:47], v[164:167], v[68:71], v[44:47]
    ds_read_b64_tr_b16 v[94:95], v20 offset:24064
    s_waitcnt lgkmcnt(8)
    v_mfma_f32_16x16x32_bf16 v[32:35], v[168:171], v[72:75], v[32:35]
    ds_read_b64_tr_b16 v[64:65], v20 offset:8192
    v_mfma_f32_16x16x32_bf16 v[36:39], v[172:175], v[72:75], v[36:39]
    ds_read_b64_tr_b16 v[66:67], v20 offset:8704
    v_mfma_f32_16x16x32_bf16 v[40:43], v[168:171], v[76:79], v[40:43]
    ds_read_b64_tr_b16 v[68:69], v20 offset:24576
    v_mfma_f32_16x16x32_bf16 v[44:47], v[172:175], v[76:79], v[44:47]
    ds_read_b64_tr_b16 v[70:71], v20 offset:25088
    s_waitcnt lgkmcnt(8)
    v_mfma_f32_16x16x32_bf16 v[32:35], v[176:179], v[80:83], v[32:35]
    ds_read_b64_tr_b16 v[72:73], v20 offset:9216
    v_mfma_f32_16x16x32_bf16 v[36:39], v[180:183], v[80:83], v[36:39]
    ds_read_b64_tr_b16 v[74:75], v20 offset:9728
    v_mfma_f32_16x16x32_bf16 v[40:43], v[176:179], v[84:87], v[40:43]
    ds_read_b64_tr_b16 v[76:77], v20 offset:25600
    v_mfma_f32_16x16x32_bf16 v[44:47], v[180:183], v[84:87], v[44:47]
    ds_read_b64_tr_b16 v[78:79], v20 offset:26112
    s_waitcnt lgkmcnt(8)
    v_mfma_f32_16x16x32_bf16 v[32:35], v[184:187], v[88:91], v[32:35]
    ds_read_b64_tr_b16 v[80:81], v20 offset:10240
    v_mfma_f32_16x16x32_bf16 v[36:39], v[188:191], v[88:91], v[36:39]
    ds_read_b64_tr_b16 v[82:83], v20 offset:10752
    v_mfma_f32_16x16x32_bf16 v[40:43], v[184:187], v[92:95], v[40:43]
    ds_read_b64_tr_b16 v[84:85], v20 offset:26624
    v_mfma_f32_16x16x32_bf16 v[44:47], v[188:191], v[92:95], v[44:47]
    ds_read_b64_tr_b16 v[86:87], v20 offset:27136
    s_waitcnt lgkmcnt(8)
    v_mfma_f32_16x16x32_bf16 v[32:35], v[192:195], v[64:67], v[32:35]
    ds_read_b64_tr_b16 v[88:89], v20 offset:11264
    v_mfma_f32_16x16x32_bf16 v[36:39], v[196:199], v[64:67], v[36:39]
    ds_read_b64_tr_b16 v[90:91], v20 offset:11776
    v_mfma_f32_16x16x32_bf16 v[40:43], v[192:195], v[68:71], v[40:43]
    ds_read_b64_tr_b16 v[92:93], v20 offset:27648
    v_mfma_f32_16x16x32_bf16 v[44:47], v[196:199], v[68:71], v[44:47]
    ds_read_b64_tr_b16 v[94:95], v20 offset:28160
    s_waitcnt lgkmcnt(8)
    v_mfma_f32_16x16x32_bf16 v[32:35], v[200:203], v[72:75], v[32:35]
    ds_read_b64_tr_b16 v[64:65], v20 offset:12288
    v_mfma_f32_16x16x32_bf16 v[36:39], v[204:207], v[72:75], v[36:39]
    ds_read_b64_tr_b16 v[66:67], v20 offset:12800
    v_mfma_f32_16x16x32_bf16 v[40:43], v[200:203], v[76:79], v[40:43]
    ds_read_b64_tr_b16 v[68:69], v20 offset:28672
    v_mfma_f32_16x16x32_bf16 v[44:47], v[204:207], v[76:79], v[44:47]
    ds_read_b64_tr_b16 v[70:71], v20 offset:29184
    s_waitcnt lgkmcnt(8)
    v_mfma_f32_16x16x32_bf16 v[32:35], v[208:211], v[80:83], v[32:35]
    ds_read_b64_tr_b16 v[72:73], v20 offset:13312
    v_mfma_f32_16x16x32_bf16 v[36:39], v[212:215], v[80:83], v[36:39]
    ds_read_b64_tr_b16 v[74:75], v20 offset:13824
    v_mfma_f32_16x16x32_bf16 v[40:43], v[208:211], v[84:87], v[40:43]
    ds_read_b64_tr_b16 v[76:77], v20 offset:29696
    v_mfma_f32_16x16x32_bf16 v[44:47], v[212:215], v[84:87], v[44:47]
    ds_read_b64_tr_b16 v[78:79], v20 offset:30208
    s_waitcnt lgkmcnt(8)
    v_mfma_f32_16x16x32_bf16 v[32:35], v[216:219], v[88:91], v[32:35]
    ds_read_b64_tr_b16 v[80:81], v20 offset:14336
    v_mfma_f32_16x16x32_bf16 v[36:39], v[220:223], v[88:91], v[36:39]
    ds_read_b64_tr_b16 v[82:83], v20 offset:14848
    v_mfma_f32_16x16x32_bf16 v[40:43], v[216:219], v[92:95], v[40:43]
    ds_read_b64_tr_b16 v[84:85], v20 offset:30720
    v_mfma_f32_16x16x32_bf16 v[44:47], v[220:223], v[92:95], v[44:47]
    ds_read_b64_tr_b16 v[86:87], v20 offset:31232
    s_waitcnt lgkmcnt(8)
    v_mfma_f32_16x16x32_bf16 v[32:35], v[224:227], v[64:67], v[32:35]
    ds_read_b64_tr_b16 v[88:89], v20 offset:15360
    v_mfma_f32_16x16x32_bf16 v[36:39], v[228:231], v[64:67], v[36:39]
    ds_read_b64_tr_b16 v[90:91], v20 offset:15872
    v_mfma_f32_16x16x32_bf16 v[40:43], v[224:227], v[68:71], v[40:43]
    ds_read_b64_tr_b16 v[92:93], v20 offset:31744
    v_mfma_f32_16x16x32_bf16 v[44:47], v[228:231], v[68:71], v[44:47]
    ds_read_b64_tr_b16 v[94:95], v20 offset:32256
    s_waitcnt lgkmcnt(8)
    v_mfma_f32_16x16x32_bf16 v[32:35], v[232:235], v[72:75], v[32:35]
    v_mfma_f32_16x16x32_bf16 v[36:39], v[236:239], v[72:75], v[36:39]
    v_mfma_f32_16x16x32_bf16 v[40:43], v[232:235], v[76:79], v[40:43]
    v_mfma_f32_16x16x32_bf16 v[44:47], v[236:239], v[76:79], v[44:47]
    s_waitcnt lgkmcnt(4)
    v_mfma_f32_16x16x32_bf16 v[32:35], v[240:243], v[80:83], v[32:35]
    v_mfma_f32_16x16x32_bf16 v[36:39], v[244:247], v[80:83], v[36:39]
    v_mfma_f32_16x16x32_bf16 v[40:43], v[240:243], v[84:87], v[40:43]
    v_mfma_f32_16x16x32_bf16 v[44:47], v[244:247], v[84:87], v[44:47]
    s_waitcnt lgkmcnt(0)
    s_setprio 2
    v_mfma_f32_16x16x32_bf16 v[32:35], v[248:251], v[88:91], v[32:35]
    v_mfma_f32_16x16x32_bf16 v[36:39], v[252:255], v[88:91], v[36:39]
    v_mfma_f32_16x16x32_bf16 v[40:43], v[248:251], v[92:95], v[40:43]
    v_mfma_f32_16x16x32_bf16 v[44:47], v[252:255], v[92:95], v[44:47]
    s_waitcnt vmcnt(0)
    s_atomic_add s32, s[4:5], s26 offset:196736
    s_atomic_add s32, s[4:5], s26 offset:197504
    v_fma_f32 v8, v101, v108, v112
    v_fma_f32 v9, v101, v109, v113
    v_fma_f32 v10, v101, v110, v114
    v_fma_f32 v11, v101, v111, v115
    v_fmac_f32 v8, v102, v32
    v_fmac_f32 v9, v102, v33
    v_fmac_f32 v10, v102, v34
    v_fmac_f32 v11, v102, v35
    v_exp_f32 v8, v8
    s_add_u32 m0, s27, 65536
    s_add_u32 s12, s20, 851968
    s_bfe_u32 s13, s3, 0x10001
    s_mul_i32 s13, s13, -983040
    s_add_u32 s12, s12, s13
    buffer_load_dwordx4 v104, s[36:39], s12 offen offset:0 lds
    v_fma_f32 v12, v101, v116, v120
    v_exp_f32 v9, v9
    v_fma_f32 v13, v101, v117, v121
    v_exp_f32 v10, v10
    v_fma_f32 v14, v101, v118, v122
    v_exp_f32 v11, v11
    v_fma_f32 v15, v101, v119, v123
    v_add_f32 v8, 1.0, v8
    buffer_load_dwordx4 v105, s[36:39], s12 offen offset:1024 lds
    v_add_f32 v9, 1.0, v9
    v_add_f32 v10, 1.0, v10
    v_add_f32 v11, 1.0, v11
    v_rcp_f32 v8, v8
    v_fmac_f32 v12, v100, v36
    v_rcp_f32 v9, v9
    v_fmac_f32 v13, v100, v37
    v_rcp_f32 v10, v10
    v_fmac_f32 v14, v100, v38
    buffer_load_dwordx4 v106, s[36:39], s12 offen offset:2048 lds
    v_rcp_f32 v11, v11
    v_fmac_f32 v15, v100, v39
    v_mul_f32 v8, v8, v12
    v_mul_f32 v9, v9, v13
    v_mul_f32 v10, v10, v14
    v_mul_f32 v11, v11, v15
    v_cvt_pk_bf16_f32 v96, v8, v9
    v_cvt_pk_bf16_f32 v97, v10, v11
    buffer_load_dwordx4 v107, s[36:39], s12 offen offset:3072 lds
    v_fma_f32 v8, v23, v108, v112
    v_fma_f32 v9, v23, v109, v113
    v_fma_f32 v10, v23, v110, v114
    v_fma_f32 v11, v23, v111, v115
    v_fmac_f32 v8, v24, v40
    v_fmac_f32 v9, v24, v41
    v_fmac_f32 v10, v24, v42
    v_fmac_f32 v11, v24, v43
    v_exp_f32 v8, v8
    s_add_u32 m0, s27, 81920
    s_add_u32 s12, s20, 131072
    buffer_load_dwordx4 v104, s[36:39], s12 offen offset:0 lds
    v_fma_f32 v12, v23, v116, v120
    v_exp_f32 v9, v9
    v_fma_f32 v13, v23, v117, v121
    v_exp_f32 v10, v10
    v_fma_f32 v14, v23, v118, v122
    v_exp_f32 v11, v11
    v_fma_f32 v15, v23, v119, v123
    v_add_f32 v8, 1.0, v8
    buffer_load_dwordx4 v105, s[36:39], s12 offen offset:1024 lds
    v_add_f32 v9, 1.0, v9
    v_add_f32 v10, 1.0, v10
    v_add_f32 v11, 1.0, v11
    v_rcp_f32 v8, v8
    v_fmac_f32 v12, v22, v44
    v_rcp_f32 v9, v9
    v_fmac_f32 v13, v22, v45
    v_rcp_f32 v10, v10
    v_fmac_f32 v14, v22, v46
    buffer_load_dwordx4 v106, s[36:39], s12 offen offset:2048 lds
    v_rcp_f32 v11, v11
    v_fmac_f32 v15, v22, v47
    v_mul_f32 v8, v8, v12
    v_mul_f32 v9, v9, v13
    v_mul_f32 v10, v10, v14
    v_mul_f32 v11, v11, v15
    v_cvt_pk_bf16_f32 v98, v8, v9
    v_cvt_pk_bf16_f32 v99, v10, v11
    buffer_load_dwordx4 v107, s[36:39], s12 offen offset:3072 lds
    v_permlane32_swap_b32 v96, v98
    v_permlane32_swap_b32 v97, v99
    buffer_store_dwordx4 v[96:99], v18, s[4:7], s45 offen sc1
    v_xor_b32 v7, 512, v7
    ds_read_b128 v[100:103], v7 offset:0
    ds_read_b128 v[22:25], v7 offset:256
    s_branch PG_12
.p2align 12
PG_12:
    v_add_u32 v20, 4294901760, v20
    ds_read_b64_tr_b16 v[64:65], v20 offset:0
    ds_read_b64_tr_b16 v[66:67], v20 offset:512
    ds_read_b64_tr_b16 v[68:69], v20 offset:16384
    ds_read_b64_tr_b16 v[70:71], v20 offset:16896
    ds_read_b64_tr_b16 v[72:73], v20 offset:1024
    ds_read_b64_tr_b16 v[74:75], v20 offset:1536
    ds_read_b64_tr_b16 v[76:77], v20 offset:17408
    ds_read_b64_tr_b16 v[78:79], v20 offset:17920
    ds_read_b64_tr_b16 v[80:81], v20 offset:2048
    ds_read_b64_tr_b16 v[82:83], v20 offset:2560
    ds_read_b64_tr_b16 v[84:85], v20 offset:18432
    ds_read_b64_tr_b16 v[86:87], v20 offset:18944
    s_barrier
    s_setprio 1
    s_waitcnt lgkmcnt(8)
    v_mfma_f32_16x16x32_bf16 v[48:51], v[128:131], v[64:67], 0
    ds_read_b64_tr_b16 v[88:89], v20 offset:3072
    v_mfma_f32_16x16x32_bf16 v[52:55], v[132:135], v[64:67], 0
    ds_read_b64_tr_b16 v[90:91], v20 offset:3584
    v_mfma_f32_16x16x32_bf16 v[56:59], v[128:131], v[68:71], 0
    ds_read_b64_tr_b16 v[92:93], v20 offset:19456
    v_mfma_f32_16x16x32_bf16 v[60:63], v[132:135], v[68:71], 0
    ds_read_b64_tr_b16 v[94:95], v20 offset:19968
    s_waitcnt lgkmcnt(8)
    v_mfma_f32_16x16x32_bf16 v[48:51], v[136:139], v[72:75], v[48:51]
    ds_read_b64_tr_b16 v[64:65], v20 offset:4096
    v_mfma_f32_16x16x32_bf16 v[52:55], v[140:143], v[72:75], v[52:55]
    ds_read_b64_tr_b16 v[66:67], v20 offset:4608
    v_mfma_f32_16x16x32_bf16 v[56:59], v[136:139], v[76:79], v[56:59]
    ds_read_b64_tr_b16 v[68:69], v20 offset:20480
    v_mfma_f32_16x16x32_bf16 v[60:63], v[140:143], v[76:79], v[60:63]
    ds_read_b64_tr_b16 v[70:71], v20 offset:20992
    s_waitcnt lgkmcnt(8)
    s_mov_b32 s33, 0
    s_atomic_add s33, s[4:5], s29 offset:197120 glc
    v_mfma_f32_16x16x32_bf16 v[48:51], v[144:147], v[80:83], v[48:51]
    ds_read_b64_tr_b16 v[72:73], v20 offset:5120
    v_mfma_f32_16x16x32_bf16 v[52:55], v[148:151], v[80:83], v[52:55]
    ds_read_b64_tr_b16 v[74:75], v20 offset:5632
    v_mfma_f32_16x16x32_bf16 v[56:59], v[144:147], v[84:87], v[56:59]
    ds_read_b64_tr_b16 v[76:77], v20 offset:21504
    v_mfma_f32_16x16x32_bf16 v[60:63], v[148:151], v[84:87], v[60:63]
    ds_read_b64_tr_b16 v[78:79], v20 offset:22016
    s_waitcnt lgkmcnt(8)
    v_mfma_f32_16x16x32_bf16 v[48:51], v[152:155], v[88:91], v[48:51]
    ds_read_b64_tr_b16 v[80:81], v20 offset:6144
    v_mfma_f32_16x16x32_bf16 v[52:55], v[156:159], v[88:91], v[52:55]
    ds_read_b64_tr_b16 v[82:83], v20 offset:6656
    v_mfma_f32_16x16x32_bf16 v[56:59], v[152:155], v[92:95], v[56:59]
    ds_read_b64_tr_b16 v[84:85], v20 offset:22528
    v_mfma_f32_16x16x32_bf16 v[60:63], v[156:159], v[92:95], v[60:63]
    ds_read_b64_tr_b16 v[86:87], v20 offset:23040
    s_waitcnt lgkmcnt(8)
    v_mfma_f32_16x16x32_bf16 v[48:51], v[160:163], v[64:67], v[48:51]
    ds_read_b64_tr_b16 v[88:89], v20 offset:7168
    v_mfma_f32_16x16x32_bf16 v[52:55], v[164:167], v[64:67], v[52:55]
    ds_read_b64_tr_b16 v[90:91], v20 offset:7680
    v_mfma_f32_16x16x32_bf16 v[56:59], v[160:163], v[68:71], v[56:59]
    ds_read_b64_tr_b16 v[92:93], v20 offset:23552
    v_mfma_f32_16x16x32_bf16 v[60:63], v[164:167], v[68:71], v[60:63]
    ds_read_b64_tr_b16 v[94:95], v20 offset:24064
    s_waitcnt lgkmcnt(8)
    v_mfma_f32_16x16x32_bf16 v[48:51], v[168:171], v[72:75], v[48:51]
    ds_read_b64_tr_b16 v[64:65], v20 offset:8192
    v_mfma_f32_16x16x32_bf16 v[52:55], v[172:175], v[72:75], v[52:55]
    ds_read_b64_tr_b16 v[66:67], v20 offset:8704
    v_mfma_f32_16x16x32_bf16 v[56:59], v[168:171], v[76:79], v[56:59]
    ds_read_b64_tr_b16 v[68:69], v20 offset:24576
    v_mfma_f32_16x16x32_bf16 v[60:63], v[172:175], v[76:79], v[60:63]
    ds_read_b64_tr_b16 v[70:71], v20 offset:25088
    s_waitcnt lgkmcnt(8)
    v_mfma_f32_16x16x32_bf16 v[48:51], v[176:179], v[80:83], v[48:51]
    ds_read_b64_tr_b16 v[72:73], v20 offset:9216
    v_mfma_f32_16x16x32_bf16 v[52:55], v[180:183], v[80:83], v[52:55]
    ds_read_b64_tr_b16 v[74:75], v20 offset:9728
    v_mfma_f32_16x16x32_bf16 v[56:59], v[176:179], v[84:87], v[56:59]
    ds_read_b64_tr_b16 v[76:77], v20 offset:25600
    v_mfma_f32_16x16x32_bf16 v[60:63], v[180:183], v[84:87], v[60:63]
    ds_read_b64_tr_b16 v[78:79], v20 offset:26112
    s_waitcnt lgkmcnt(8)
    v_mfma_f32_16x16x32_bf16 v[48:51], v[184:187], v[88:91], v[48:51]
    ds_read_b64_tr_b16 v[80:81], v20 offset:10240
    v_mfma_f32_16x16x32_bf16 v[52:55], v[188:191], v[88:91], v[52:55]
    ds_read_b64_tr_b16 v[82:83], v20 offset:10752
    v_mfma_f32_16x16x32_bf16 v[56:59], v[184:187], v[92:95], v[56:59]
    ds_read_b64_tr_b16 v[84:85], v20 offset:26624
    v_mfma_f32_16x16x32_bf16 v[60:63], v[188:191], v[92:95], v[60:63]
    ds_read_b64_tr_b16 v[86:87], v20 offset:27136
    s_waitcnt lgkmcnt(8)
    v_mfma_f32_16x16x32_bf16 v[48:51], v[192:195], v[64:67], v[48:51]
    ds_read_b64_tr_b16 v[88:89], v20 offset:11264
    v_mfma_f32_16x16x32_bf16 v[52:55], v[196:199], v[64:67], v[52:55]
    ds_read_b64_tr_b16 v[90:91], v20 offset:11776
    v_mfma_f32_16x16x32_bf16 v[56:59], v[192:195], v[68:71], v[56:59]
    ds_read_b64_tr_b16 v[92:93], v20 offset:27648
    v_mfma_f32_16x16x32_bf16 v[60:63], v[196:199], v[68:71], v[60:63]
    ds_read_b64_tr_b16 v[94:95], v20 offset:28160
    s_waitcnt lgkmcnt(8)
    v_mfma_f32_16x16x32_bf16 v[48:51], v[200:203], v[72:75], v[48:51]
    ds_read_b64_tr_b16 v[64:65], v20 offset:12288
    v_mfma_f32_16x16x32_bf16 v[52:55], v[204:207], v[72:75], v[52:55]
    ds_read_b64_tr_b16 v[66:67], v20 offset:12800
    v_mfma_f32_16x16x32_bf16 v[56:59], v[200:203], v[76:79], v[56:59]
    ds_read_b64_tr_b16 v[68:69], v20 offset:28672
    v_mfma_f32_16x16x32_bf16 v[60:63], v[204:207], v[76:79], v[60:63]
    ds_read_b64_tr_b16 v[70:71], v20 offset:29184
    s_waitcnt lgkmcnt(8)
    v_mfma_f32_16x16x32_bf16 v[48:51], v[208:211], v[80:83], v[48:51]
    ds_read_b64_tr_b16 v[72:73], v20 offset:13312
    v_mfma_f32_16x16x32_bf16 v[52:55], v[212:215], v[80:83], v[52:55]
    ds_read_b64_tr_b16 v[74:75], v20 offset:13824
    v_mfma_f32_16x16x32_bf16 v[56:59], v[208:211], v[84:87], v[56:59]
    ds_read_b64_tr_b16 v[76:77], v20 offset:29696
    v_mfma_f32_16x16x32_bf16 v[60:63], v[212:215], v[84:87], v[60:63]
    ds_read_b64_tr_b16 v[78:79], v20 offset:30208
    s_waitcnt lgkmcnt(8)
    v_mfma_f32_16x16x32_bf16 v[48:51], v[216:219], v[88:91], v[48:51]
    ds_read_b64_tr_b16 v[80:81], v20 offset:14336
    v_mfma_f32_16x16x32_bf16 v[52:55], v[220:223], v[88:91], v[52:55]
    ds_read_b64_tr_b16 v[82:83], v20 offset:14848
    v_mfma_f32_16x16x32_bf16 v[56:59], v[216:219], v[92:95], v[56:59]
    ds_read_b64_tr_b16 v[84:85], v20 offset:30720
    v_mfma_f32_16x16x32_bf16 v[60:63], v[220:223], v[92:95], v[60:63]
    ds_read_b64_tr_b16 v[86:87], v20 offset:31232
    s_waitcnt lgkmcnt(8)
    v_mfma_f32_16x16x32_bf16 v[48:51], v[224:227], v[64:67], v[48:51]
    ds_read_b64_tr_b16 v[88:89], v20 offset:15360
    v_mfma_f32_16x16x32_bf16 v[52:55], v[228:231], v[64:67], v[52:55]
    ds_read_b64_tr_b16 v[90:91], v20 offset:15872
    v_mfma_f32_16x16x32_bf16 v[56:59], v[224:227], v[68:71], v[56:59]
    ds_read_b64_tr_b16 v[92:93], v20 offset:31744
    v_mfma_f32_16x16x32_bf16 v[60:63], v[228:231], v[68:71], v[60:63]
    ds_read_b64_tr_b16 v[94:95], v20 offset:32256
    s_waitcnt lgkmcnt(8)
    v_mfma_f32_16x16x32_bf16 v[48:51], v[232:235], v[72:75], v[48:51]
    v_mfma_f32_16x16x32_bf16 v[52:55], v[236:239], v[72:75], v[52:55]
    v_mfma_f32_16x16x32_bf16 v[56:59], v[232:235], v[76:79], v[56:59]
    v_mfma_f32_16x16x32_bf16 v[60:63], v[236:239], v[76:79], v[60:63]
    s_waitcnt lgkmcnt(4)
    v_mfma_f32_16x16x32_bf16 v[48:51], v[240:243], v[80:83], v[48:51]
    v_mfma_f32_16x16x32_bf16 v[52:55], v[244:247], v[80:83], v[52:55]
    v_mfma_f32_16x16x32_bf16 v[56:59], v[240:243], v[84:87], v[56:59]
    v_mfma_f32_16x16x32_bf16 v[60:63], v[244:247], v[84:87], v[60:63]
    s_waitcnt lgkmcnt(0)
    s_setprio 2
    v_mfma_f32_16x16x32_bf16 v[48:51], v[248:251], v[88:91], v[48:51]
    v_mfma_f32_16x16x32_bf16 v[52:55], v[252:255], v[88:91], v[52:55]
    v_mfma_f32_16x16x32_bf16 v[56:59], v[248:251], v[92:95], v[56:59]
    v_mfma_f32_16x16x32_bf16 v[60:63], v[252:255], v[92:95], v[60:63]
    s_mov_b32 s15, 0
    s_branch P3AC
P3A:
    s_mov_b32 s33, 0
    s_atomic_add s33, s[4:5], s29 offset:197120 glc
P3AC:
    s_add_u32 s15, s15, 1
    s_waitcnt lgkmcnt(0)
    s_cmp_gt_u32 s15, 200000
    s_cbranch_scc1 P3AX
    s_cmp_lt_u32 s33, 14
    s_cbranch_scc1 P3A
P3AX:
    s_add_u32 s30, s0, 2048
    buffer_load_dwordx4 v[128:131], v26, s[4:7], s30 offen sc1
    buffer_load_dwordx4 v[132:135], v16, s[4:7], s30 offen sc1
    s_add_u32 s30, s0, 6144
    buffer_load_dwordx4 v[136:139], v26, s[4:7], s30 offen sc1
    buffer_load_dwordx4 v[140:143], v16, s[4:7], s30 offen sc1
    s_add_u32 s30, s0, 10240
    buffer_load_dwordx4 v[144:147], v26, s[4:7], s30 offen sc1
    buffer_load_dwordx4 v[148:151], v16, s[4:7], s30 offen sc1
    s_add_u32 s30, s0, 14336
    buffer_load_dwordx4 v[152:155], v26, s[4:7], s30 offen sc1
    buffer_load_dwordx4 v[156:159], v16, s[4:7], s30 offen sc1
    s_add_u32 s30, s0, 18432
    buffer_load_dwordx4 v[160:163], v26, s[4:7], s30 offen sc1
    buffer_load_dwordx4 v[164:167], v16, s[4:7], s30 offen sc1
    s_branch PG_13
.p2align 12
PG_13:
    s_waitcnt vmcnt(10)
    s_atomic_add s32, s[4:5], s41 offset:198272
    s_mov_b32 s33, 0
    s_atomic_add s33, s[4:5], s29 offset:196736 glc
    v_fma_f32 v8, v101, v108, v112
    v_fma_f32 v9, v101, v109, v113
    v_fma_f32 v10, v101, v110, v114
    v_fma_f32 v11, v101, v111, v115
    v_fmac_f32 v8, v102, v48
    v_fmac_f32 v9, v102, v49
    v_fmac_f32 v10, v102, v50
    v_fmac_f32 v11, v102, v51
    v_exp_f32 v8, v8
    v_fma_f32 v12, v101, v116, v120
    v_exp_f32 v9, v9
    v_fma_f32 v13, v101, v117, v121
    v_exp_f32 v10, v10
    v_fma_f32 v14, v101, v118, v122
    v_exp_f32 v11, v11
    v_fma_f32 v15, v101, v119, v123
    v_add_f32 v8, 1.0, v8
    s_add_u32 s30, s0, 22528
    buffer_load_dwordx4 v[168:171], v26, s[4:7], s30 offen sc1
    v_add_f32 v9, 1.0, v9
    v_add_f32 v10, 1.0, v10
    v_add_f32 v11, 1.0, v11
    v_rcp_f32 v8, v8
    v_fmac_f32 v12, v100, v52
    v_rcp_f32 v9, v9
    v_fmac_f32 v13, v100, v53
    v_rcp_f32 v10, v10
    v_fmac_f32 v14, v100, v54
    v_rcp_f32 v11, v11
    v_fmac_f32 v15, v100, v55
    v_mul_f32 v8, v8, v12
    v_mul_f32 v9, v9, v13
    v_mul_f32 v10, v10, v14
    v_mul_f32 v11, v11, v15
    v_cvt_pk_bf16_f32 v96, v8, v9
    v_cvt_pk_bf16_f32 v97, v10, v11
    buffer_load_dwordx4 v[172:175], v16, s[4:7], s30 offen sc1
    v_fma_f32 v8, v23, v108, v112
    v_fma_f32 v9, v23, v109, v113
    v_fma_f32 v10, v23, v110, v114
    v_fma_f32 v11, v23, v111, v115
    v_fmac_f32 v8, v24, v56
    v_fmac_f32 v9, v24, v57
    v_fmac_f32 v10, v24, v58
    v_fmac_f32 v11, v24, v59
    v_exp_f32 v8, v8
    v_fma_f32 v12, v23, v116, v120
    v_exp_f32 v9, v9
    v_fma_f32 v13, v23, v117, v121
    v_exp_f32 v10, v10
    v_fma_f32 v14, v23, v118, v122
    v_exp_f32 v11, v11
    v_fma_f32 v15, v23, v119, v123
    v_add_f32 v8, 1.0, v8
    s_add_u32 s30, s0, 26624
    buffer_load_dwordx4 v[176:179], v26, s[4:7], s30 offen sc1
    v_add_f32 v9, 1.0, v9
    v_add_f32 v10, 1.0, v10
    v_add_f32 v11, 1.0, v11
    v_rcp_f32 v8, v8
    v_fmac_f32 v12, v22, v60
    v_rcp_f32 v9, v9
    v_fmac_f32 v13, v22, v61
    v_rcp_f32 v10, v10
    v_fmac_f32 v14, v22, v62
    v_rcp_f32 v11, v11
    v_fmac_f32 v15, v22, v63
    v_mul_f32 v8, v8, v12
    v_mul_f32 v9, v9, v13
    v_mul_f32 v10, v10, v14
    v_mul_f32 v11, v11, v15
    v_cvt_pk_bf16_f32 v98, v8, v9
    v_cvt_pk_bf16_f32 v99, v10, v11
    buffer_load_dwordx4 v[180:183], v16, s[4:7], s30 offen sc1
    v_permlane32_swap_b32 v96, v98
    v_permlane32_swap_b32 v97, v99
    buffer_store_dwordx4 v[96:99], v18, s[4:7], s46 offen sc1
    s_mov_b32 s15, 0
    s_branch P3EC
P3E:
    s_mov_b32 s33, 0
    s_atomic_add s33, s[4:5], s29 offset:196736 glc
P3EC:
    s_add_u32 s15, s15, 1
    s_waitcnt lgkmcnt(0)
    s_cmp_gt_u32 s15, 200000
    s_cbranch_scc1 P3EX
    s_cmp_lt_u32 s33, 14
    s_cbranch_scc1 P3E
P3EX:
G2_F:
    s_add_u32 s30, s0, 0
    buffer_load_dwordx4 v[184:187], v26, s[4:7], s30 offen sc1
    buffer_load_dwordx4 v[188:191], v16, s[4:7], s30 offen sc1
    s_add_u32 s30, s0, 4096
    buffer_load_dwordx4 v[192:195], v26, s[4:7], s30 offen sc1
    buffer_load_dwordx4 v[196:199], v16, s[4:7], s30 offen sc1
    v_mov_b32 v4, v125
    v_xor_b32 v5, 32, v125
    v_xor_b32 v6, 64, v125
    v_xor_b32 v7, 96, v125
    v_mov_b32 v12, v126
    v_xor_b32 v13, 64, v126
    v_xor_b32 v14, 128, v126
    v_xor_b32 v15, 192, v126
    v_add_u32 v4, 131072, v4
    v_add_u32 v5, 131072, v5
    v_add_u32 v6, 131072, v6
    v_add_u32 v7, 131072, v7
    ds_read_b64_tr_b16 v[64:65], v4 offset:0
    ds_read_b64_tr_b16 v[66:67], v4 offset:1024
    ds_read_b64_tr_b16 v[68:69], v5 offset:0
    ds_read_b64_tr_b16 v[70:71], v5 offset:1024
    ds_read_b64_tr_b16 v[72:73], v6 offset:0
    ds_read_b64_tr_b16 v[74:75], v6 offset:1024
    ds_read_b64_tr_b16 v[76:77], v7 offset:0
    ds_read_b64_tr_b16 v[78:79], v7 offset:1024
    ds_read_b64_tr_b16 v[80:81], v4 offset:8192
    ds_read_b64_tr_b16 v[82:83], v4 offset:9216
    ds_read_b64_tr_b16 v[84:85], v5 offset:8192
    ds_read_b64_tr_b16 v[86:87], v5 offset:9216
    s_setprio 1
    s_add_u32 s30, s0, 8192
    buffer_load_dwordx4 v[200:203], v26, s[4:7], s30 offen sc1
    buffer_load_dwordx4 v[204:207], v16, s[4:7], s30 offen sc1
    s_waitcnt vmcnt(19) lgkmcnt(8)
    v_mfma_f32_16x16x32_bf16 v[32:35], v[64:67], v[128:131], 0
    ds_read_b64_tr_b16 v[88:89], v6 offset:8192
    v_mfma_f32_16x16x32_bf16 v[48:51], v[64:67], v[132:135], 0
    ds_read_b64_tr_b16 v[90:91], v6 offset:9216
    v_mfma_f32_16x16x32_bf16 v[36:39], v[68:71], v[128:131], 0
    ds_read_b64_tr_b16 v[92:93], v7 offset:8192
    v_mfma_f32_16x16x32_bf16 v[52:55], v[68:71], v[132:135], 0
    ds_read_b64_tr_b16 v[94:95], v7 offset:9216
    s_waitcnt lgkmcnt(8)
    v_mfma_f32_16x16x32_bf16 v[40:43], v[72:75], v[128:131], 0
    v_add_u32 v4, 4294836224, v4
    v_add_u32 v5, 4294836224, v5
    v_add_u32 v6, 4294836224, v6
    v_add_u32 v7, 4294836224, v7
    ds_read_b64_tr_b16 v[64:65], v4 offset:0
    v_mfma_f32_16x16x32_bf16 v[56:59], v[72:75], v[132:135], 0
    ds_read_b64_tr_b16 v[66:67], v4 offset:1024
    v_mfma_f32_16x16x32_bf16 v[44:47], v[76:79], v[128:131], 0
    ds_read_b64_tr_b16 v[68:69], v5 offset:0
    v_mfma_f32_16x16x32_bf16 v[60:63], v[76:79], v[132:135], 0
    ds_read_b64_tr_b16 v[70:71], v5 offset:1024
    s_add_u32 s30, s0, 12288
    buffer_load_dwordx4 v[208:211], v26, s[4:7], s30 offen sc1
    buffer_load_dwordx4 v[212:215], v16, s[4:7], s30 offen sc1
    s_waitcnt vmcnt(19) lgkmcnt(8)
    v_mfma_f32_16x16x32_bf16 v[32:35], v[80:83], v[136:139], v[32:35]
    ds_read_b64_tr_b16 v[72:73], v6 offset:0
    v_mfma_f32_16x16x32_bf16 v[48:51], v[80:83], v[140:143], v[48:51]
    ds_read_b64_tr_b16 v[74:75], v6 offset:1024
    v_mfma_f32_16x16x32_bf16 v[36:39], v[84:87], v[136:139], v[36:39]
    ds_read_b64_tr_b16 v[76:77], v7 offset:0
    v_mfma_f32_16x16x32_bf16 v[52:55], v[84:87], v[140:143], v[52:55]
    ds_read_b64_tr_b16 v[78:79], v7 offset:1024
    s_waitcnt lgkmcnt(8)
    v_mfma_f32_16x16x32_bf16 v[40:43], v[88:91], v[136:139], v[40:43]
    ds_read_b64_tr_b16 v[80:81], v4 offset:8192
    v_mfma_f32_16x16x32_bf16 v[56:59], v[88:91], v[140:143], v[56:59]
    ds_read_b64_tr_b16 v[82:83], v4 offset:9216
    v_mfma_f32_16x16x32_bf16 v[44:47], v[92:95], v[136:139], v[44:47]
    ds_read_b64_tr_b16 v[84:85], v5 offset:8192
    v_mfma_f32_16x16x32_bf16 v[60:63], v[92:95], v[140:143], v[60:63]
    ds_read_b64_tr_b16 v[86:87], v5 offset:9216
    s_add_u32 s30, s0, 16384
    buffer_load_dwordx4 v[216:219], v26, s[4:7], s30 offen sc1
    buffer_load_dwordx4 v[220:223], v16, s[4:7], s30 offen sc1
    s_waitcnt vmcnt(19) lgkmcnt(8)
    v_mfma_f32_16x16x32_bf16 v[32:35], v[64:67], v[144:147], v[32:35]
    ds_read_b64_tr_b16 v[88:89], v6 offset:8192
    v_mfma_f32_16x16x32_bf16 v[48:51], v[64:67], v[148:151], v[48:51]
    ds_read_b64_tr_b16 v[90:91], v6 offset:9216
    v_mfma_f32_16x16x32_bf16 v[36:39], v[68:71], v[144:147], v[36:39]
    ds_read_b64_tr_b16 v[92:93], v7 offset:8192
    v_mfma_f32_16x16x32_bf16 v[52:55], v[68:71], v[148:151], v[52:55]
    ds_read_b64_tr_b16 v[94:95], v7 offset:9216
    s_waitcnt lgkmcnt(8)
    v_mfma_f32_16x16x32_bf16 v[40:43], v[72:75], v[144:147], v[40:43]
    ds_read_b64_tr_b16 v[64:65], v4 offset:16384
    v_mfma_f32_16x16x32_bf16 v[56:59], v[72:75], v[148:151], v[56:59]
    ds_read_b64_tr_b16 v[66:67], v4 offset:17408
    v_mfma_f32_16x16x32_bf16 v[44:47], v[76:79], v[144:147], v[44:47]
    ds_read_b64_tr_b16 v[68:69], v5 offset:16384
    v_mfma_f32_16x16x32_bf16 v[60:63], v[76:79], v[148:151], v[60:63]
    ds_read_b64_tr_b16 v[70:71], v5 offset:17408
    s_add_u32 s30, s0, 20480
    buffer_load_dwordx4 v[224:227], v26, s[4:7], s30 offen sc1
    buffer_load_dwordx4 v[228:231], v16, s[4:7], s30 offen sc1
    s_waitcnt vmcnt(12)
    s_atomic_add s32, s[4:5], s41 offset:199040
    s_waitcnt lgkmcnt(8)
    v_mfma_f32_16x16x32_bf16 v[32:35], v[80:83], v[152:155], v[32:35]
    ds_read_b64_tr_b16 v[72:73], v6 offset:16384
    v_mfma_f32_16x16x32_bf16 v[48:51], v[80:83], v[156:159], v[48:51]
    ds_read_b64_tr_b16 v[74:75], v6 offset:17408
    v_mfma_f32_16x16x32_bf16 v[36:39], v[84:87], v[152:155], v[36:39]
    ds_read_b64_tr_b16 v[76:77], v7 offset:16384
    v_mfma_f32_16x16x32_bf16 v[52:55], v[84:87], v[156:159], v[52:55]
    ds_read_b64_tr_b16 v[78:79], v7 offset:17408
    s_waitcnt lgkmcnt(8)
    v_mfma_f32_16x16x32_bf16 v[40:43], v[88:91], v[152:155], v[40:43]
    ds_read_b64_tr_b16 v[80:81], v4 offset:24576
    v_mfma_f32_16x16x32_bf16 v[56:59], v[88:91], v[156:159], v[56:59]
    ds_read_b64_tr_b16 v[82:83], v4 offset:25600
    v_mfma_f32_16x16x32_bf16 v[44:47], v[92:95], v[152:155], v[44:47]
    ds_read_b64_tr_b16 v[84:85], v5 offset:24576
    v_mfma_f32_16x16x32_bf16 v[60:63], v[92:95], v[156:159], v[60:63]
    ds_read_b64_tr_b16 v[86:87], v5 offset:25600
    s_add_u32 s30, s0, 24576
    buffer_load_dwordx4 v[232:235], v26, s[4:7], s30 offen sc1
    buffer_load_dwordx4 v[236:239], v16, s[4:7], s30 offen sc1
    s_barrier
    s_waitcnt lgkmcnt(8)
    v_mfma_f32_16x16x32_bf16 v[32:35], v[64:67], v[160:163], v[32:35]
    ds_read_b64_tr_b16 v[88:89], v6 offset:24576
    v_mfma_f32_16x16x32_bf16 v[48:51], v[64:67], v[164:167], v[48:51]
    ds_read_b64_tr_b16 v[90:91], v6 offset:25600
    v_mfma_f32_16x16x32_bf16 v[36:39], v[68:71], v[160:163], v[36:39]
    ds_read_b64_tr_b16 v[92:93], v7 offset:24576
    v_mfma_f32_16x16x32_bf16 v[52:55], v[68:71], v[164:167], v[52:55]
    ds_read_b64_tr_b16 v[94:95], v7 offset:25600
    s_waitcnt lgkmcnt(8)
    v_mfma_f32_16x16x32_bf16 v[40:43], v[72:75], v[160:163], v[40:43]
    v_add_u32 v4, 65536, v4
    v_add_u32 v5, 65536, v5
    v_add_u32 v6, 65536, v6
    v_add_u32 v7, 65536, v7
    ds_read_b64_tr_b16 v[64:65], v4 offset:0
    v_mfma_f32_16x16x32_bf16 v[56:59], v[72:75], v[164:167], v[56:59]
    ds_read_b64_tr_b16 v[66:67], v4 offset:1024
    v_mfma_f32_16x16x32_bf16 v[44:47], v[76:79], v[160:163], v[44:47]
    ds_read_b64_tr_b16 v[68:69], v5 offset:0
    v_mfma_f32_16x16x32_bf16 v[60:63], v[76:79], v[164:167], v[60:63]
    ds_read_b64_tr_b16 v[70:71], v5 offset:1024
    s_waitcnt lgkmcnt(8)
    v_mfma_f32_16x16x32_bf16 v[32:35], v[80:83], v[168:171], v[32:35]
    ds_read_b64_tr_b16 v[72:73], v6 offset:0
    v_mfma_f32_16x16x32_bf16 v[48:51], v[80:83], v[172:175], v[48:51]
    ds_read_b64_tr_b16 v[74:75], v6 offset:1024
    v_mfma_f32_16x16x32_bf16 v[36:39], v[84:87], v[168:171], v[36:39]
    ds_read_b64_tr_b16 v[76:77], v7 offset:0
    v_mfma_f32_16x16x32_bf16 v[52:55], v[84:87], v[172:175], v[52:55]
    ds_read_b64_tr_b16 v[78:79], v7 offset:1024
    s_waitcnt lgkmcnt(8)
    v_mfma_f32_16x16x32_bf16 v[40:43], v[88:91], v[168:171], v[40:43]
    ds_read_b64_tr_b16 v[80:81], v4 offset:8192
    v_mfma_f32_16x16x32_bf16 v[56:59], v[88:91], v[172:175], v[56:59]
    ds_read_b64_tr_b16 v[82:83], v4 offset:9216
    v_mfma_f32_16x16x32_bf16 v[44:47], v[92:95], v[168:171], v[44:47]
    ds_read_b64_tr_b16 v[84:85], v5 offset:8192
    v_mfma_f32_16x16x32_bf16 v[60:63], v[92:95], v[172:175], v[60:63]
    ds_read_b64_tr_b16 v[86:87], v5 offset:9216
    s_waitcnt lgkmcnt(8)
    v_mfma_f32_16x16x32_bf16 v[32:35], v[64:67], v[176:179], v[32:35]
    ds_read_b64_tr_b16 v[88:89], v6 offset:8192
    v_mfma_f32_16x16x32_bf16 v[48:51], v[64:67], v[180:183], v[48:51]
    ds_read_b64_tr_b16 v[90:91], v6 offset:9216
    v_mfma_f32_16x16x32_bf16 v[36:39], v[68:71], v[176:179], v[36:39]
    ds_read_b64_tr_b16 v[92:93], v7 offset:8192
    v_mfma_f32_16x16x32_bf16 v[52:55], v[68:71], v[180:183], v[52:55]
    ds_read_b64_tr_b16 v[94:95], v7 offset:9216
    s_waitcnt lgkmcnt(8)
    v_mfma_f32_16x16x32_bf16 v[40:43], v[72:75], v[176:179], v[40:43]
    ds_read_b64_tr_b16 v[64:65], v4 offset:16384
    v_mfma_f32_16x16x32_bf16 v[56:59], v[72:75], v[180:183], v[56:59]
    ds_read_b64_tr_b16 v[66:67], v4 offset:17408
    v_mfma_f32_16x16x32_bf16 v[44:47], v[76:79], v[176:179], v[44:47]
    ds_read_b64_tr_b16 v[68:69], v5 offset:16384
    v_mfma_f32_16x16x32_bf16 v[60:63], v[76:79], v[180:183], v[60:63]
    ds_read_b64_tr_b16 v[70:71], v5 offset:17408
    s_waitcnt vmcnt(12) lgkmcnt(8)
    v_mfma_f32_16x16x32_bf16 v[32:35], v[80:83], v[184:187], v[32:35]
    ds_read_b64_tr_b16 v[72:73], v6 offset:16384
    v_mfma_f32_16x16x32_bf16 v[48:51], v[80:83], v[188:191], v[48:51]
    ds_read_b64_tr_b16 v[74:75], v6 offset:17408
    v_mfma_f32_16x16x32_bf16 v[36:39], v[84:87], v[184:187], v[36:39]
    ds_read_b64_tr_b16 v[76:77], v7 offset:16384
    v_mfma_f32_16x16x32_bf16 v[52:55], v[84:87], v[188:191], v[52:55]
    ds_read_b64_tr_b16 v[78:79], v7 offset:17408
    s_waitcnt lgkmcnt(8)
    v_mfma_f32_16x16x32_bf16 v[40:43], v[88:91], v[184:187], v[40:43]
    ds_read_b64_tr_b16 v[80:81], v4 offset:24576
    v_mfma_f32_16x16x32_bf16 v[56:59], v[88:91], v[188:191], v[56:59]
    ds_read_b64_tr_b16 v[82:83], v4 offset:25600
    v_mfma_f32_16x16x32_bf16 v[44:47], v[92:95], v[184:187], v[44:47]
    ds_read_b64_tr_b16 v[84:85], v5 offset:24576
    v_mfma_f32_16x16x32_bf16 v[60:63], v[92:95], v[188:191], v[60:63]
    ds_read_b64_tr_b16 v[86:87], v5 offset:25600
    s_waitcnt vmcnt(10) lgkmcnt(8)
    v_mfma_f32_16x16x32_bf16 v[32:35], v[64:67], v[192:195], v[32:35]
    ds_read_b64_tr_b16 v[88:89], v6 offset:24576
    v_mfma_f32_16x16x32_bf16 v[48:51], v[64:67], v[196:199], v[48:51]
    ds_read_b64_tr_b16 v[90:91], v6 offset:25600
    v_mfma_f32_16x16x32_bf16 v[36:39], v[68:71], v[192:195], v[36:39]
    ds_read_b64_tr_b16 v[92:93], v7 offset:24576
    v_mfma_f32_16x16x32_bf16 v[52:55], v[68:71], v[196:199], v[52:55]
    ds_read_b64_tr_b16 v[94:95], v7 offset:25600
    s_waitcnt lgkmcnt(8)
    v_mfma_f32_16x16x32_bf16 v[40:43], v[72:75], v[192:195], v[40:43]
    ds_read_b64_tr_b16 v[64:65], v4 offset:32768
    v_mfma_f32_16x16x32_bf16 v[56:59], v[72:75], v[196:199], v[56:59]
    ds_read_b64_tr_b16 v[66:67], v4 offset:33792
    v_mfma_f32_16x16x32_bf16 v[44:47], v[76:79], v[192:195], v[44:47]
    ds_read_b64_tr_b16 v[68:69], v5 offset:32768
    v_mfma_f32_16x16x32_bf16 v[60:63], v[76:79], v[196:199], v[60:63]
    ds_read_b64_tr_b16 v[70:71], v5 offset:33792
    s_waitcnt vmcnt(8) lgkmcnt(8)
    v_mfma_f32_16x16x32_bf16 v[32:35], v[80:83], v[200:203], v[32:35]
    ds_read_b64_tr_b16 v[72:73], v6 offset:32768
    v_mfma_f32_16x16x32_bf16 v[48:51], v[80:83], v[204:207], v[48:51]
    ds_read_b64_tr_b16 v[74:75], v6 offset:33792
    v_mfma_f32_16x16x32_bf16 v[36:39], v[84:87], v[200:203], v[36:39]
    ds_read_b64_tr_b16 v[76:77], v7 offset:32768
    v_mfma_f32_16x16x32_bf16 v[52:55], v[84:87], v[204:207], v[52:55]
    ds_read_b64_tr_b16 v[78:79], v7 offset:33792
    s_waitcnt lgkmcnt(8)
    v_mfma_f32_16x16x32_bf16 v[40:43], v[88:91], v[200:203], v[40:43]
    ds_read_b64_tr_b16 v[80:81], v4 offset:40960
    v_mfma_f32_16x16x32_bf16 v[56:59], v[88:91], v[204:207], v[56:59]
    ds_read_b64_tr_b16 v[82:83], v4 offset:41984
    v_mfma_f32_16x16x32_bf16 v[44:47], v[92:95], v[200:203], v[44:47]
    ds_read_b64_tr_b16 v[84:85], v4 offset:49152
    v_mfma_f32_16x16x32_bf16 v[60:63], v[92:95], v[204:207], v[60:63]
    ds_read_b64_tr_b16 v[86:87], v4 offset:50176
    s_waitcnt vmcnt(6) lgkmcnt(8)
    v_mfma_f32_16x16x32_bf16 v[32:35], v[64:67], v[208:211], v[32:35]
    ds_read_b64_tr_b16 v[88:89], v4 offset:57344
    v_mfma_f32_16x16x32_bf16 v[48:51], v[64:67], v[212:215], v[48:51]
    ds_read_b64_tr_b16 v[90:91], v4 offset:58368
    v_mfma_f32_16x16x32_bf16 v[36:39], v[68:71], v[208:211], v[36:39]
    ds_read_b64_tr_b16 v[92:93], v5 offset:40960
    v_mfma_f32_16x16x32_bf16 v[52:55], v[68:71], v[212:215], v[52:55]
    ds_read_b64_tr_b16 v[94:95], v5 offset:41984
    s_waitcnt lgkmcnt(8)
    v_mfma_f32_16x16x32_bf16 v[40:43], v[72:75], v[208:211], v[40:43]
    ds_read_b64_tr_b16 v[64:65], v5 offset:49152
    v_mfma_f32_16x16x32_bf16 v[56:59], v[72:75], v[212:215], v[56:59]
    ds_read_b64_tr_b16 v[66:67], v5 offset:50176
    v_mfma_f32_16x16x32_bf16 v[44:47], v[76:79], v[208:211], v[44:47]
    ds_read_b64_tr_b16 v[68:69], v5 offset:57344
    v_mfma_f32_16x16x32_bf16 v[60:63], v[76:79], v[212:215], v[60:63]
    ds_read_b64_tr_b16 v[70:71], v5 offset:58368
    s_waitcnt vmcnt(2) lgkmcnt(8)
    v_mfma_f32_16x16x32_bf16 v[32:35], v[80:83], v[216:219], v[32:35]
    ds_read_b64_tr_b16 v[72:73], v6 offset:40960
    v_mfma_f32_16x16x32_bf16 v[48:51], v[80:83], v[220:223], v[48:51]
    ds_read_b64_tr_b16 v[74:75], v6 offset:41984
    v_mfma_f32_16x16x32_bf16 v[32:35], v[84:87], v[224:227], v[32:35]
    ds_read_b64_tr_b16 v[76:77], v6 offset:49152
    v_mfma_f32_16x16x32_bf16 v[48:51], v[84:87], v[228:231], v[48:51]
    ds_read_b64_tr_b16 v[78:79], v6 offset:50176
    s_waitcnt vmcnt(0) lgkmcnt(8)
    v_mfma_f32_16x16x32_bf16 v[32:35], v[88:91], v[232:235], v[32:35]
    ds_read_b64_tr_b16 v[80:81], v6 offset:57344
    v_mfma_f32_16x16x32_bf16 v[48:51], v[88:91], v[236:239], v[48:51]
    ds_read_b64_tr_b16 v[82:83], v6 offset:58368
    v_mfma_f32_16x16x32_bf16 v[36:39], v[92:95], v[216:219], v[36:39]
    ds_read_b64_tr_b16 v[84:85], v7 offset:40960
    v_mfma_f32_16x16x32_bf16 v[52:55], v[92:95], v[220:223], v[52:55]
    ds_read_b64_tr_b16 v[86:87], v7 offset:41984
    s_waitcnt lgkmcnt(8)
    v_mfma_f32_16x16x32_bf16 v[36:39], v[64:67], v[224:227], v[36:39]
    ds_read_b64_tr_b16 v[88:89], v7 offset:49152
    v_mfma_f32_16x16x32_bf16 v[52:55], v[64:67], v[228:231], v[52:55]
    ds_read_b64_tr_b16 v[90:91], v7 offset:50176
    ds_write_b128 v12, v[32:35] offset:32768
    v_mfma_f32_16x16x32_bf16 v[36:39], v[68:71], v[232:235], v[36:39]
    ds_read_b64_tr_b16 v[92:93], v7 offset:57344
    ds_write_b128 v12, v[48:51] offset:36864
    v_mfma_f32_16x16x32_bf16 v[52:55], v[68:71], v[236:239], v[52:55]
    ds_read_b64_tr_b16 v[94:95], v7 offset:58368
    s_waitcnt lgkmcnt(10)
    v_mfma_f32_16x16x32_bf16 v[40:43], v[72:75], v[216:219], v[40:43]
    v_mfma_f32_16x16x32_bf16 v[56:59], v[72:75], v[220:223], v[56:59]
    v_mfma_f32_16x16x32_bf16 v[40:43], v[76:79], v[224:227], v[40:43]
    v_mfma_f32_16x16x32_bf16 v[56:59], v[76:79], v[228:231], v[56:59]
    ds_write_b128 v13, v[36:39] offset:32768
    s_waitcnt lgkmcnt(7)
    v_mfma_f32_16x16x32_bf16 v[40:43], v[80:83], v[232:235], v[40:43]
    ds_write_b128 v13, v[52:55] offset:36864
    v_mfma_f32_16x16x32_bf16 v[56:59], v[80:83], v[236:239], v[56:59]
    v_mfma_f32_16x16x32_bf16 v[44:47], v[84:87], v[216:219], v[44:47]
    v_mfma_f32_16x16x32_bf16 v[60:63], v[84:87], v[220:223], v[60:63]
    s_waitcnt lgkmcnt(2)
    v_mfma_f32_16x16x32_bf16 v[44:47], v[88:91], v[224:227], v[44:47]
    v_mfma_f32_16x16x32_bf16 v[60:63], v[88:91], v[228:231], v[60:63]
    s_nop 0
    ds_write_b128 v14, v[40:43] offset:32768
    v_mfma_f32_16x16x32_bf16 v[44:47], v[92:95], v[232:235], v[44:47]
    ds_write_b128 v14, v[56:59] offset:36864
    v_mfma_f32_16x16x32_bf16 v[60:63], v[92:95], v[236:239], v[60:63]
    s_nop 5
    ds_write_b128 v15, v[44:47] offset:32768
    s_nop 0
    ds_write_b128 v15, v[60:63] offset:36864
    s_setprio 2
    v_xor_b32 v97, 16, v127
    v_xor_b32 v98, 128, v127
    v_xor_b32 v99, 144, v127
    v_mov_b32 v2, 161792
    v_mov_b32 v3, 1
    s_mov_b64 exec, 1
    ds_add_u32 v2, v3 offset:0
    s_mov_b64 exec, -1
    v_mov_b32 v2, 161792
    s_mov_b32 s15, 0
    s_branch PWC
PW:
    s_sleep 1
PWC:
    ds_read_b32 v3, v2 offset:0
    s_add_u32 s15, s15, 1
    s_waitcnt lgkmcnt(0)
    v_cmp_gt_u32 vcc, 4, v3
    s_cmp_gt_u32 s15, 200000
    s_cbranch_scc1 PWX
    s_cbranch_vccnz PW
PWX:
    ds_read_b128 v[128:131], v127 offset:32768
    ds_read_b128 v[132:135], v97 offset:32768
    ds_read_b128 v[136:139], v127 offset:49152
    ds_read_b128 v[140:143], v97 offset:49152
    ds_read_b128 v[144:147], v98 offset:34816
    ds_read_b128 v[148:151], v99 offset:34816
    ds_read_b128 v[152:155], v98 offset:51200
    ds_read_b128 v[156:159], v99 offset:51200
    v_mov_b32 v2, 161792
    v_mov_b32 v3, 1
    s_mov_b64 exec, 1
    ds_add_u32 v2, v3 offset:8
    s_mov_b64 exec, -1
    s_waitcnt lgkmcnt(6)
    v_add_f32 v128, v128, v136
    v_add_f32 v129, v129, v137
    v_add_f32 v130, v130, v138
    v_add_f32 v131, v131, v139
    s_waitcnt lgkmcnt(5)
    v_add_f32 v132, v132, v140
    v_add_f32 v133, v133, v141
    v_add_f32 v134, v134, v142
    v_add_f32 v135, v135, v143
    v_cvt_pk_bf16_f32 v160, v128, v129
    v_cvt_pk_bf16_f32 v161, v130, v131
    v_cvt_pk_bf16_f32 v162, v132, v133
    v_cvt_pk_bf16_f32 v163, v134, v135
    buffer_store_dwordx4 v[160:163], v26, s[4:7], s21 offen offset:0 sc1
    s_waitcnt lgkmcnt(2)
    v_add_f32 v144, v144, v152
    v_add_f32 v145, v145, v153
    v_add_f32 v146, v146, v154
    v_add_f32 v147, v147, v155
    s_waitcnt lgkmcnt(1)
    v_add_f32 v148, v148, v156
    v_add_f32 v149, v149, v157
    v_add_f32 v150, v150, v158
    v_add_f32 v151, v151, v159
    v_cvt_pk_bf16_f32 v164, v144, v145
    v_cvt_pk_bf16_f32 v165, v146, v147
    v_cvt_pk_bf16_f32 v166, v148, v149
    v_cvt_pk_bf16_f32 v167, v150, v151
    buffer_store_dwordx4 v[164:167], v26, s[4:7], s21 offen offset:1024 sc1
    s_and_b32 s12, s3, 3
    s_lshl_b32 s12, s12, 11
    s_add_u32 s12, s12, 147456
    v_and_b32 v3, 7, v0
    s_lshl_b32 s14, s35, 8
    s_add_u32 s14, s14, 157696
    v_lshl_add_u32 v2, v3, 5, s14
    ds_read_b128 v[16:19], v2
    ds_read_b128 v[20:23], v2 offset:16
    v_lshrrev_b32 v2, 3, v1
    v_xor_b32 v3, v3, v2
    v_lshlrev_b32 v3, 4, v3
    v_lshl_add_u32 v3, v2, 7, v3
    v_add_u32 v3, s12, v3
    ds_read_b128 v[176:179], v3
    ds_read_b128 v[180:183], v3 offset:1024
    s_waitcnt lgkmcnt(1)
    v_lshlrev_b32 v184, 16, v176
    v_and_b32 v185, 0xffff0000, v176
    v_lshlrev_b32 v186, 16, v177
    v_and_b32 v187, 0xffff0000, v177
    v_lshlrev_b32 v188, 16, v178
    v_and_b32 v189, 0xffff0000, v178
    v_lshlrev_b32 v190, 16, v179
    v_and_b32 v191, 0xffff0000, v179
    s_waitcnt lgkmcnt(0)
    v_lshlrev_b32 v192, 16, v180
    v_and_b32 v193, 0xffff0000, v180
    v_lshlrev_b32 v194, 16, v181
    v_and_b32 v195, 0xffff0000, v181
    v_lshlrev_b32 v196, 16, v182
    v_and_b32 v197, 0xffff0000, v182
    v_lshlrev_b32 v198, 16, v183
    v_and_b32 v199, 0xffff0000, v183
    v_mov_b32 v2, 161792
    s_mov_b32 s15, 0
    s_branch XWC
XW:
    s_sleep 4
XWC:
    ds_read_b32 v3, v2 offset:4
    s_add_u32 s15, s15, 1
    s_waitcnt lgkmcnt(0)
    v_cmp_gt_u32 vcc, 1, v3
    s_cmp_gt_u32 s15, 200000
    s_cbranch_scc1 XWX
    s_cbranch_vccnz XW
XWX:
    s_waitcnt vmcnt(0)
    buffer_load_dwordx4 v[160:163], v26, s[4:7], s23 offen sc1
    buffer_load_dwordx4 v[164:167], v26, s[4:7], s23 offen offset:1024 sc1
    s_mov_b32 s15, 0
    s_add_u32 s28, s31, 8192
    s_waitcnt vmcnt(0)
    s_branch XBC
XBL:
    s_sleep 2
    buffer_load_dwordx4 v[160:163], v26, s[4:7], s23 offen sc1
    buffer_load_dwordx4 v[164:167], v26, s[4:7], s23 offen offset:1024 sc1
    s_waitcnt vmcnt(0)
XBC:
    v_max3_u32 v2, v160, v161, v162
    v_max3_u32 v3, v163, v164, v165
    v_max3_u32 v2, v2, v166, v167
    v_max_u32 v2, v2, v3
    s_add_u32 s15, s15, 1
    v_cmp_eq_u32 vcc, -1, v2
    s_cmp_gt_u32 s15, 200000
    s_cbranch_scc1 XBLX
    s_cbranch_vccnz XBL
XBLX:
    v_lshlrev_b32 v2, 16, v160
    v_and_b32 v3, 0xffff0000, v160
    v_fmac_f32 v184, v2, v16
    v_fmac_f32 v185, v3, v17
    v_lshlrev_b32 v2, 16, v161
    v_and_b32 v3, 0xffff0000, v161
    v_fmac_f32 v186, v2, v18
    v_fmac_f32 v187, v3, v19
    v_lshlrev_b32 v2, 16, v162
    v_and_b32 v3, 0xffff0000, v162
    v_fmac_f32 v188, v2, v20
    v_fmac_f32 v189, v3, v21
    v_lshlrev_b32 v2, 16, v163
    v_and_b32 v3, 0xffff0000, v163
    v_fmac_f32 v190, v2, v22
    v_fmac_f32 v191, v3, v23
    v_lshlrev_b32 v2, 16, v164
    v_and_b32 v3, 0xffff0000, v164
    v_fmac_f32 v192, v2, v16
    v_fmac_f32 v193, v3, v17
    v_lshlrev_b32 v2, 16, v165
    v_and_b32 v3, 0xffff0000, v165
    v_fmac_f32 v194, v2, v18
    v_fmac_f32 v195, v3, v19
    v_lshlrev_b32 v2, 16, v166
    v_and_b32 v3, 0xffff0000, v166
    v_fmac_f32 v196, v2, v20
    v_fmac_f32 v197, v3, v21
    v_lshlrev_b32 v2, 16, v167
    v_and_b32 v3, 0xffff0000, v167
    v_fmac_f32 v198, v2, v22
    v_fmac_f32 v199, v3, v23
    s_barrier
    ds_read_b128 v[128:131], v127 offset:32768
    ds_read_b128 v[132:135], v97 offset:32768
    ds_read_b128 v[136:139], v127 offset:49152
    ds_read_b128 v[140:143], v97 offset:49152
    ds_read_b128 v[144:147], v98 offset:34816
    ds_read_b128 v[148:151], v99 offset:34816
    ds_read_b128 v[152:155], v98 offset:51200
    ds_read_b128 v[156:159], v99 offset:51200
    s_waitcnt lgkmcnt(5)
    v_add_f32 v128, v128, v136
    v_fmac_f32 v184, v128, v16
    v_add_f32 v129, v129, v137
    v_fmac_f32 v185, v129, v17
    v_add_f32 v130, v130, v138
    v_fmac_f32 v186, v130, v18
    v_add_f32 v131, v131, v139
    v_fmac_f32 v187, v131, v19
    s_waitcnt lgkmcnt(4)
    v_add_f32 v132, v132, v140
    v_fmac_f32 v188, v132, v20
    v_add_f32 v133, v133, v141
    v_fmac_f32 v189, v133, v21
    v_add_f32 v134, v134, v142
    v_fmac_f32 v190, v134, v22
    v_add_f32 v135, v135, v143
    v_fmac_f32 v191, v135, v23
    v_cvt_pk_bf16_f32 v160, v184, v185
    v_cvt_pk_bf16_f32 v161, v186, v187
    v_cvt_pk_bf16_f32 v162, v188, v189
    v_cvt_pk_bf16_f32 v163, v190, v191
    buffer_store_dwordx4 v[160:163], v31, s[8:11], s31 offen sc1
    s_waitcnt lgkmcnt(1)
    v_add_f32 v144, v144, v152
    v_fmac_f32 v192, v144, v16
    v_add_f32 v145, v145, v153
    v_fmac_f32 v193, v145, v17
    v_add_f32 v146, v146, v154
    v_fmac_f32 v194, v146, v18
    v_add_f32 v147, v147, v155
    v_fmac_f32 v195, v147, v19
    s_waitcnt lgkmcnt(0)
    v_add_f32 v148, v148, v156
    v_fmac_f32 v196, v148, v20
    v_add_f32 v149, v149, v157
    v_fmac_f32 v197, v149, v21
    v_add_f32 v150, v150, v158
    v_fmac_f32 v198, v150, v22
    v_add_f32 v151, v151, v159
    v_fmac_f32 v199, v151, v23
    v_cvt_pk_bf16_f32 v164, v192, v193
    v_cvt_pk_bf16_f32 v165, v194, v195
    v_cvt_pk_bf16_f32 v166, v196, v197
    v_cvt_pk_bf16_f32 v167, v198, v199
    buffer_store_dwordx4 v[164:167], v31, s[8:11], s28 offen sc1
    s_branch FIN
.p2align 12
G1_S:
    s_setprio 2
    v_add_u32 v2, 65536, v25
    ds_read_b64_tr_b16 v[160:161], v2 offset:0
    ds_read_b64_tr_b16 v[162:163], v2 offset:2048
    ds_read_b64_tr_b16 v[164:165], v2 offset:16384
    ds_read_b64_tr_b16 v[166:167], v2 offset:18432
    ds_read_b64_tr_b16 v[168:169], v2 offset:4096
    ds_read_b64_tr_b16 v[170:171], v2 offset:6144
    ds_read_b64_tr_b16 v[172:173], v2 offset:20480
    ds_read_b64_tr_b16 v[174:175], v2 offset:22528
    ds_read_b64_tr_b16 v[176:177], v2 offset:8192
    ds_read_b64_tr_b16 v[178:179], v2 offset:10240
    ds_read_b64_tr_b16 v[180:181], v2 offset:24576
    ds_read_b64_tr_b16 v[182:183], v2 offset:26624
    ds_read_b64_tr_b16 v[184:185], v2 offset:12288
    ds_read_b64_tr_b16 v[186:187], v2 offset:14336
    ds_read_b64_tr_b16 v[188:189], v2 offset:28672
    ds_read_b64_tr_b16 v[190:191], v2 offset:30720
    v_add_u32 v2, 98304, v25
    ds_read_b64_tr_b16 v[192:193], v2 offset:0
    ds_read_b64_tr_b16 v[194:195], v2 offset:2048
    ds_read_b64_tr_b16 v[196:197], v2 offset:16384
    ds_read_b64_tr_b16 v[198:199], v2 offset:18432
    ds_read_b64_tr_b16 v[200:201], v2 offset:4096
    ds_read_b64_tr_b16 v[202:203], v2 offset:6144
    ds_read_b64_tr_b16 v[204:205], v2 offset:20480
    ds_read_b64_tr_b16 v[206:207], v2 offset:22528
    ds_read_b64_tr_b16 v[208:209], v2 offset:8192
    ds_read_b64_tr_b16 v[210:211], v2 offset:10240
    ds_read_b64_tr_b16 v[212:213], v2 offset:24576
    ds_read_b64_tr_b16 v[214:215], v2 offset:26624
    ds_read_b64_tr_b16 v[216:217], v2 offset:12288
    ds_read_b64_tr_b16 v[218:219], v2 offset:14336
    ds_read_b64_tr_b16 v[220:221], v2 offset:28672
    ds_read_b64_tr_b16 v[222:223], v2 offset:30720
    ds_read_b128 v[44:47], v17 offset:0
    ds_read_b128 v[48:51], v17 offset:128
    ds_read_b128 v[52:55], v17 offset:256
    ds_read_b128 v[56:59], v17 offset:384
    ds_read_b128 v[60:63], v17 offset:512
    ds_read_b128 v[64:67], v17 offset:640
    ds_read_b128 v[68:71], v17 offset:768
    ds_read_b128 v[72:75], v17 offset:896
    s_waitcnt lgkmcnt(7)
    v_mfma_f32_16x16x32_bf16 v[96:99], v[128:131], v[44:47], 0
    v_mfma_f32_16x16x32_bf16 v[100:103], v[132:135], v[44:47], 0
    s_waitcnt lgkmcnt(6)
    v_mfma_f32_16x16x32_bf16 v[96:99], v[136:139], v[48:51], v[96:99]
    v_mfma_f32_16x16x32_bf16 v[100:103], v[140:143], v[48:51], v[100:103]
    s_waitcnt lgkmcnt(5)
    v_mfma_f32_16x16x32_bf16 v[96:99], v[144:147], v[52:55], v[96:99]
    v_mfma_f32_16x16x32_bf16 v[100:103], v[148:151], v[52:55], v[100:103]
    s_waitcnt lgkmcnt(4)
    v_mfma_f32_16x16x32_bf16 v[96:99], v[152:155], v[56:59], v[96:99]
    v_mfma_f32_16x16x32_bf16 v[100:103], v[156:159], v[56:59], v[100:103]
    s_waitcnt lgkmcnt(3)
    v_mfma_f32_16x16x32_bf16 v[96:99], v[160:163], v[60:63], v[96:99]
    v_mfma_f32_16x16x32_bf16 v[100:103], v[164:167], v[60:63], v[100:103]
    s_waitcnt lgkmcnt(2)
    v_mfma_f32_16x16x32_bf16 v[96:99], v[168:171], v[64:67], v[96:99]
    v_mfma_f32_16x16x32_bf16 v[100:103], v[172:175], v[64:67], v[100:103]
    s_waitcnt lgkmcnt(1)
    v_mfma_f32_16x16x32_bf16 v[96:99], v[176:179], v[68:71], v[96:99]
    v_mfma_f32_16x16x32_bf16 v[100:103], v[180:183], v[68:71], v[100:103]
    s_waitcnt lgkmcnt(0)
    v_mfma_f32_16x16x32_bf16 v[96:99], v[184:187], v[72:75], v[96:99]
    v_mfma_f32_16x16x32_bf16 v[100:103], v[188:191], v[72:75], v[100:103]
    s_waitcnt vmcnt(0) lgkmcnt(0)
    s_barrier
    v_add_u32 v2, 32768, v25
    ds_read_b64_tr_b16 v[224:225], v2 offset:0
    ds_read_b64_tr_b16 v[226:227], v2 offset:2048
    ds_read_b64_tr_b16 v[228:229], v2 offset:16384
    ds_read_b64_tr_b16 v[230:231], v2 offset:18432
    ds_read_b64_tr_b16 v[232:233], v2 offset:4096
    ds_read_b64_tr_b16 v[234:235], v2 offset:6144
    ds_read_b64_tr_b16 v[236:237], v2 offset:20480
    ds_read_b64_tr_b16 v[238:239], v2 offset:22528
    ds_read_b64_tr_b16 v[240:241], v2 offset:8192
    ds_read_b64_tr_b16 v[242:243], v2 offset:10240
    ds_read_b64_tr_b16 v[244:245], v2 offset:24576
    ds_read_b64_tr_b16 v[246:247], v2 offset:26624
    ds_read_b64_tr_b16 v[248:249], v2 offset:12288
    ds_read_b64_tr_b16 v[250:251], v2 offset:14336
    ds_read_b64_tr_b16 v[252:253], v2 offset:28672
    ds_read_b64_tr_b16 v[254:255], v2 offset:30720
    ds_read_b128 v[44:47], v17 offset:1024
    ds_read_b128 v[48:51], v17 offset:1152
    ds_read_b128 v[52:55], v17 offset:1280
    ds_read_b128 v[56:59], v17 offset:1408
    ds_read_b128 v[60:63], v17 offset:1536
    ds_read_b128 v[64:67], v17 offset:1664
    ds_read_b128 v[68:71], v17 offset:1792
    ds_read_b128 v[72:75], v17 offset:1920
    s_waitcnt lgkmcnt(7)
    v_mfma_f32_16x16x32_bf16 v[96:99], v[192:195], v[44:47], v[96:99]
    v_mfma_f32_16x16x32_bf16 v[100:103], v[196:199], v[44:47], v[100:103]
    s_waitcnt lgkmcnt(6)
    v_mfma_f32_16x16x32_bf16 v[96:99], v[200:203], v[48:51], v[96:99]
    v_mfma_f32_16x16x32_bf16 v[100:103], v[204:207], v[48:51], v[100:103]
    s_waitcnt lgkmcnt(5)
    v_mfma_f32_16x16x32_bf16 v[96:99], v[208:211], v[52:55], v[96:99]
    v_mfma_f32_16x16x32_bf16 v[100:103], v[212:215], v[52:55], v[100:103]
    s_waitcnt lgkmcnt(4)
    v_mfma_f32_16x16x32_bf16 v[96:99], v[216:219], v[56:59], v[96:99]
    v_mfma_f32_16x16x32_bf16 v[100:103], v[220:223], v[56:59], v[100:103]
    s_waitcnt lgkmcnt(3)
    v_mfma_f32_16x16x32_bf16 v[96:99], v[224:227], v[60:63], v[96:99]
    v_mfma_f32_16x16x32_bf16 v[100:103], v[228:231], v[60:63], v[100:103]
    s_waitcnt lgkmcnt(2)
    v_mfma_f32_16x16x32_bf16 v[96:99], v[232:235], v[64:67], v[96:99]
    v_mfma_f32_16x16x32_bf16 v[100:103], v[236:239], v[64:67], v[100:103]
    s_waitcnt lgkmcnt(1)
    v_mfma_f32_16x16x32_bf16 v[96:99], v[240:243], v[68:71], v[96:99]
    v_mfma_f32_16x16x32_bf16 v[100:103], v[244:247], v[68:71], v[100:103]
    s_waitcnt lgkmcnt(0)
    v_mfma_f32_16x16x32_bf16 v[96:99], v[248:251], v[72:75], v[96:99]
    v_mfma_f32_16x16x32_bf16 v[100:103], v[252:255], v[72:75], v[100:103]
    s_barrier
    s_xor_b32 s12, s22, 32768
    s_add_u32 m0, s27, 65536
    s_nop 0
    buffer_load_dwordx4 v26, s[4:7], s12 offen offset:0 sc1 lds
    buffer_load_dwordx4 v26, s[4:7], s12 offen offset:1024 sc1 lds
    buffer_load_dwordx4 v26, s[4:7], s12 offen offset:2048 sc1 lds
    buffer_load_dwordx4 v26, s[4:7], s12 offen offset:3072 sc1 lds
    s_add_u32 m0, m0, 16384
    s_add_u32 s12, s12, 16384
    buffer_load_dwordx4 v26, s[4:7], s12 offen offset:0 sc1 lds
    buffer_load_dwordx4 v26, s[4:7], s12 offen offset:1024 sc1 lds
    buffer_load_dwordx4 v26, s[4:7], s12 offen offset:2048 sc1 lds
    buffer_load_dwordx4 v26, s[4:7], s12 offen offset:3072 sc1 lds
    s_or_b32 s12, s2, s3
    s_cmp_lg_u32 s12, 0
    s_cselect_b32 s12, 33554432, 0
    v_mov_b32 v4, s40
    v_mov_b32 v3, 0
    buffer_store_dword v4, v3, s[4:7], s12 offen sc1
    ds_read_b64_tr_b16 v[64:65], v20 offset:0
    ds_read_b64_tr_b16 v[66:67], v20 offset:512
    ds_read_b64_tr_b16 v[68:69], v20 offset:16384
    ds_read_b64_tr_b16 v[70:71], v20 offset:16896
    ds_read_b64_tr_b16 v[72:73], v20 offset:1024
    ds_read_b64_tr_b16 v[74:75], v20 offset:1536
    ds_read_b64_tr_b16 v[76:77], v20 offset:17408
    ds_read_b64_tr_b16 v[78:79], v20 offset:17920
    ds_read_b64_tr_b16 v[80:81], v20 offset:2048
    ds_read_b64_tr_b16 v[82:83], v20 offset:2560
    ds_read_b64_tr_b16 v[84:85], v20 offset:18432
    ds_read_b64_tr_b16 v[86:87], v20 offset:18944
    v_mov_b32 v2, 0xbfb8aa3b
    s_nop 1
    v_mul_f32_dpp v108, v96, v2 quad_perm:[0,0,0,0] row_mask:0xf bank_mask:0xf
    v_mul_f32_dpp v112, v96, v2 quad_perm:[1,1,1,1] row_mask:0xf bank_mask:0xf
    v_mov_b32_dpp v116, v100 quad_perm:[0,0,0,0] row_mask:0xf bank_mask:0xf
    v_mov_b32_dpp v120, v100 quad_perm:[1,1,1,1] row_mask:0xf bank_mask:0xf
    v_mul_f32_dpp v109, v97, v2 quad_perm:[0,0,0,0] row_mask:0xf bank_mask:0xf
    v_mul_f32_dpp v113, v97, v2 quad_perm:[1,1,1,1] row_mask:0xf bank_mask:0xf
    v_mov_b32_dpp v117, v101 quad_perm:[0,0,0,0] row_mask:0xf bank_mask:0xf
    v_mov_b32_dpp v121, v101 quad_perm:[1,1,1,1] row_mask:0xf bank_mask:0xf
    v_mul_f32_dpp v110, v98, v2 quad_perm:[0,0,0,0] row_mask:0xf bank_mask:0xf
    v_mul_f32_dpp v114, v98, v2 quad_perm:[1,1,1,1] row_mask:0xf bank_mask:0xf
    v_mov_b32_dpp v118, v102 quad_perm:[0,0,0,0] row_mask:0xf bank_mask:0xf
    v_mov_b32_dpp v122, v102 quad_perm:[1,1,1,1] row_mask:0xf bank_mask:0xf
    v_mul_f32_dpp v111, v99, v2 quad_perm:[0,0,0,0] row_mask:0xf bank_mask:0xf
    v_mul_f32_dpp v115, v99, v2 quad_perm:[1,1,1,1] row_mask:0xf bank_mask:0xf
    v_mov_b32_dpp v119, v103 quad_perm:[0,0,0,0] row_mask:0xf bank_mask:0xf
    v_mov_b32_dpp v123, v103 quad_perm:[1,1,1,1] row_mask:0xf bank_mask:0xf
    s_setprio 0
    s_waitcnt lgkmcnt(8)
    v_mfma_f32_16x16x32_bf16 v[32:35], v[128:131], v[64:67], 0
    ds_read_b64_tr_b16 v[88:89], v20 offset:3072
    v_mfma_f32_16x16x32_bf16 v[36:39], v[132:135], v[64:67], 0
    ds_read_b64_tr_b16 v[90:91], v20 offset:3584
    v_mfma_f32_16x16x32_bf16 v[40:43], v[128:131], v[68:71], 0
    ds_read_b64_tr_b16 v[92:93], v20 offset:19456
    v_mfma_f32_16x16x32_bf16 v[44:47], v[132:135], v[68:71], 0
    ds_read_b64_tr_b16 v[94:95], v20 offset:19968
    s_waitcnt lgkmcnt(8)
    v_mfma_f32_16x16x32_bf16 v[32:35], v[136:139], v[72:75], v[32:35]
    ds_read_b64_tr_b16 v[64:65], v20 offset:4096
    v_mfma_f32_16x16x32_bf16 v[36:39], v[140:143], v[72:75], v[36:39]
    ds_read_b64_tr_b16 v[66:67], v20 offset:4608
    v_mfma_f32_16x16x32_bf16 v[40:43], v[136:139], v[76:79], v[40:43]
    ds_read_b64_tr_b16 v[68:69], v20 offset:20480
    v_mfma_f32_16x16x32_bf16 v[44:47], v[140:143], v[76:79], v[44:47]
    ds_read_b64_tr_b16 v[70:71], v20 offset:20992
    s_waitcnt lgkmcnt(8)
    v_mfma_f32_16x16x32_bf16 v[32:35], v[144:147], v[80:83], v[32:35]
    ds_read_b64_tr_b16 v[72:73], v20 offset:5120
    v_mfma_f32_16x16x32_bf16 v[36:39], v[148:151], v[80:83], v[36:39]
    ds_read_b64_tr_b16 v[74:75], v20 offset:5632
    v_mfma_f32_16x16x32_bf16 v[40:43], v[144:147], v[84:87], v[40:43]
    ds_read_b64_tr_b16 v[76:77], v20 offset:21504
    v_mfma_f32_16x16x32_bf16 v[44:47], v[148:151], v[84:87], v[44:47]
    ds_read_b64_tr_b16 v[78:79], v20 offset:22016
    s_waitcnt lgkmcnt(8)
    v_mfma_f32_16x16x32_bf16 v[32:35], v[152:155], v[88:91], v[32:35]
    ds_read_b64_tr_b16 v[80:81], v20 offset:6144
    v_mfma_f32_16x16x32_bf16 v[36:39], v[156:159], v[88:91], v[36:39]
    ds_read_b64_tr_b16 v[82:83], v20 offset:6656
    v_mfma_f32_16x16x32_bf16 v[40:43], v[152:155], v[92:95], v[40:43]
    ds_read_b64_tr_b16 v[84:85], v20 offset:22528
    v_mfma_f32_16x16x32_bf16 v[44:47], v[156:159], v[92:95], v[44:47]
    ds_read_b64_tr_b16 v[86:87], v20 offset:23040
    s_waitcnt lgkmcnt(8)
    v_mfma_f32_16x16x32_bf16 v[32:35], v[160:163], v[64:67], v[32:35]
    ds_read_b64_tr_b16 v[88:89], v20 offset:7168
    v_mfma_f32_16x16x32_bf16 v[36:39], v[164:167], v[64:67], v[36:39]
    ds_read_b64_tr_b16 v[90:91], v20 offset:7680
    v_mfma_f32_16x16x32_bf16 v[40:43], v[160:163], v[68:71], v[40:43]
    ds_read_b64_tr_b16 v[92:93], v20 offset:23552
    v_mfma_f32_16x16x32_bf16 v[44:47], v[164:167], v[68:71], v[44:47]
    ds_read_b64_tr_b16 v[94:95], v20 offset:24064
    s_waitcnt lgkmcnt(8)
    v_mfma_f32_16x16x32_bf16 v[32:35], v[168:171], v[72:75], v[32:35]
    ds_read_b64_tr_b16 v[64:65], v20 offset:8192
    v_mfma_f32_16x16x32_bf16 v[36:39], v[172:175], v[72:75], v[36:39]
    ds_read_b64_tr_b16 v[66:67], v20 offset:8704
    v_mfma_f32_16x16x32_bf16 v[40:43], v[168:171], v[76:79], v[40:43]
    ds_read_b64_tr_b16 v[68:69], v20 offset:24576
    v_mfma_f32_16x16x32_bf16 v[44:47], v[172:175], v[76:79], v[44:47]
    ds_read_b64_tr_b16 v[70:71], v20 offset:25088
    s_waitcnt lgkmcnt(8)
    v_mfma_f32_16x16x32_bf16 v[32:35], v[176:179], v[80:83], v[32:35]
    ds_read_b64_tr_b16 v[72:73], v20 offset:9216
    v_mfma_f32_16x16x32_bf16 v[36:39], v[180:183], v[80:83], v[36:39]
    ds_read_b64_tr_b16 v[74:75], v20 offset:9728
    v_mfma_f32_16x16x32_bf16 v[40:43], v[176:179], v[84:87], v[40:43]
    ds_read_b64_tr_b16 v[76:77], v20 offset:25600
    v_mfma_f32_16x16x32_bf16 v[44:47], v[180:183], v[84:87], v[44:47]
    ds_read_b64_tr_b16 v[78:79], v20 offset:26112
    s_waitcnt lgkmcnt(8)
    v_mfma_f32_16x16x32_bf16 v[32:35], v[184:187], v[88:91], v[32:35]
    ds_read_b64_tr_b16 v[80:81], v20 offset:10240
    v_mfma_f32_16x16x32_bf16 v[36:39], v[188:191], v[88:91], v[36:39]
    ds_read_b64_tr_b16 v[82:83], v20 offset:10752
    v_mfma_f32_16x16x32_bf16 v[40:43], v[184:187], v[92:95], v[40:43]
    ds_read_b64_tr_b16 v[84:85], v20 offset:26624
    v_mfma_f32_16x16x32_bf16 v[44:47], v[188:191], v[92:95], v[44:47]
    ds_read_b64_tr_b16 v[86:87], v20 offset:27136
    s_waitcnt lgkmcnt(8)
    v_mfma_f32_16x16x32_bf16 v[32:35], v[192:195], v[64:67], v[32:35]
    ds_read_b64_tr_b16 v[88:89], v20 offset:11264
    v_mfma_f32_16x16x32_bf16 v[36:39], v[196:199], v[64:67], v[36:39]
    ds_read_b64_tr_b16 v[90:91], v20 offset:11776
    v_mfma_f32_16x16x32_bf16 v[40:43], v[192:195], v[68:71], v[40:43]
    ds_read_b64_tr_b16 v[92:93], v20 offset:27648
    v_mfma_f32_16x16x32_bf16 v[44:47], v[196:199], v[68:71], v[44:47]
    ds_read_b64_tr_b16 v[94:95], v20 offset:28160
    s_waitcnt lgkmcnt(8)
    v_mfma_f32_16x16x32_bf16 v[32:35], v[200:203], v[72:75], v[32:35]
    ds_read_b64_tr_b16 v[64:65], v20 offset:12288
    v_mfma_f32_16x16x32_bf16 v[36:39], v[204:207], v[72:75], v[36:39]
    ds_read_b64_tr_b16 v[66:67], v20 offset:12800
    v_mfma_f32_16x16x32_bf16 v[40:43], v[200:203], v[76:79], v[40:43]
    ds_read_b64_tr_b16 v[68:69], v20 offset:28672
    v_mfma_f32_16x16x32_bf16 v[44:47], v[204:207], v[76:79], v[44:47]
    ds_read_b64_tr_b16 v[70:71], v20 offset:29184
    s_waitcnt lgkmcnt(8)
    v_mfma_f32_16x16x32_bf16 v[32:35], v[208:211], v[80:83], v[32:35]
    ds_read_b64_tr_b16 v[72:73], v20 offset:13312
    v_mfma_f32_16x16x32_bf16 v[36:39], v[212:215], v[80:83], v[36:39]
    ds_read_b64_tr_b16 v[74:75], v20 offset:13824
    v_mfma_f32_16x16x32_bf16 v[40:43], v[208:211], v[84:87], v[40:43]
    ds_read_b64_tr_b16 v[76:77], v20 offset:29696
    v_mfma_f32_16x16x32_bf16 v[44:47], v[212:215], v[84:87], v[44:47]
    ds_read_b64_tr_b16 v[78:79], v20 offset:30208
    s_waitcnt lgkmcnt(8)
    v_mfma_f32_16x16x32_bf16 v[32:35], v[216:219], v[88:91], v[32:35]
    ds_read_b64_tr_b16 v[80:81], v20 offset:14336
    v_mfma_f32_16x16x32_bf16 v[36:39], v[220:223], v[88:91], v[36:39]
    ds_read_b64_tr_b16 v[82:83], v20 offset:14848
    v_mfma_f32_16x16x32_bf16 v[40:43], v[216:219], v[92:95], v[40:43]
    ds_read_b64_tr_b16 v[84:85], v20 offset:30720
    v_mfma_f32_16x16x32_bf16 v[44:47], v[220:223], v[92:95], v[44:47]
    ds_read_b64_tr_b16 v[86:87], v20 offset:31232
    s_waitcnt lgkmcnt(8)
    v_mfma_f32_16x16x32_bf16 v[32:35], v[224:227], v[64:67], v[32:35]
    ds_read_b64_tr_b16 v[88:89], v20 offset:15360
    v_mfma_f32_16x16x32_bf16 v[36:39], v[228:231], v[64:67], v[36:39]
    ds_read_b64_tr_b16 v[90:91], v20 offset:15872
    v_mfma_f32_16x16x32_bf16 v[40:43], v[224:227], v[68:71], v[40:43]
    ds_read_b64_tr_b16 v[92:93], v20 offset:31744
    v_mfma_f32_16x16x32_bf16 v[44:47], v[228:231], v[68:71], v[44:47]
    ds_read_b64_tr_b16 v[94:95], v20 offset:32256
    s_waitcnt lgkmcnt(8)
    v_mfma_f32_16x16x32_bf16 v[32:35], v[232:235], v[72:75], v[32:35]
    v_mfma_f32_16x16x32_bf16 v[36:39], v[236:239], v[72:75], v[36:39]
    v_mfma_f32_16x16x32_bf16 v[40:43], v[232:235], v[76:79], v[40:43]
    v_mfma_f32_16x16x32_bf16 v[44:47], v[236:239], v[76:79], v[44:47]
    s_waitcnt lgkmcnt(4)
    v_mfma_f32_16x16x32_bf16 v[32:35], v[240:243], v[80:83], v[32:35]
    v_mfma_f32_16x16x32_bf16 v[36:39], v[244:247], v[80:83], v[36:39]
    v_mfma_f32_16x16x32_bf16 v[40:43], v[240:243], v[84:87], v[40:43]
    v_mfma_f32_16x16x32_bf16 v[44:47], v[244:247], v[84:87], v[44:47]
    s_waitcnt lgkmcnt(0)
    s_setprio 2
    s_waitcnt vmcnt(1)
    s_barrier
    ds_read_b128 v[100:103], v124 offset:0
    ds_read_b128 v[22:25], v124 offset:256
    v_mfma_f32_16x16x32_bf16 v[32:35], v[248:251], v[88:91], v[32:35]
    v_mfma_f32_16x16x32_bf16 v[36:39], v[252:255], v[88:91], v[36:39]
    v_mfma_f32_16x16x32_bf16 v[40:43], v[248:251], v[92:95], v[40:43]
    v_mfma_f32_16x16x32_bf16 v[44:47], v[252:255], v[92:95], v[44:47]
    s_waitcnt lgkmcnt(1)
    v_fma_f32 v8, v101, v108, v112
    v_fma_f32 v9, v101, v109, v113
    v_fma_f32 v10, v101, v110, v114
    v_fma_f32 v11, v101, v111, v115
    v_fmac_f32 v8, v102, v32
    v_fmac_f32 v9, v102, v33
    v_fmac_f32 v10, v102, v34
    v_fmac_f32 v11, v102, v35
    v_exp_f32 v8, v8
    s_xor_b32 s12, s44, 32768
    s_add_u32 m0, s27, 32768
    s_nop 0
    buffer_load_dwordx4 v26, s[4:7], s12 offen offset:0 sc1 lds
    v_fma_f32 v12, v101, v116, v120
    v_exp_f32 v9, v9
    v_fma_f32 v13, v101, v117, v121
    v_exp_f32 v10, v10
    v_fma_f32 v14, v101, v118, v122
    v_exp_f32 v11, v11
    v_fma_f32 v15, v101, v119, v123
    v_add_f32 v8, 1.0, v8
    buffer_load_dwordx4 v26, s[4:7], s12 offen offset:1024 sc1 lds
    v_add_f32 v9, 1.0, v9
    v_add_f32 v10, 1.0, v10
    v_add_f32 v11, 1.0, v11
    v_rcp_f32 v8, v8
    v_fmac_f32 v12, v100, v36
    v_rcp_f32 v9, v9
    v_fmac_f32 v13, v100, v37
    v_rcp_f32 v10, v10
    v_fmac_f32 v14, v100, v38
    buffer_load_dwordx4 v26, s[4:7], s12 offen offset:2048 sc1 lds
    v_rcp_f32 v11, v11
    v_fmac_f32 v15, v100, v39
    v_mul_f32 v8, v8, v12
    v_mul_f32 v9, v9, v13
    v_mul_f32 v10, v10, v14
    v_mul_f32 v11, v11, v15
    v_cvt_pk_bf16_f32 v96, v8, v9
    v_cvt_pk_bf16_f32 v97, v10, v11
    buffer_load_dwordx4 v26, s[4:7], s12 offen offset:3072 sc1 lds
    s_waitcnt lgkmcnt(0)
    v_fma_f32 v8, v23, v108, v112
    v_fma_f32 v9, v23, v109, v113
    v_fma_f32 v10, v23, v110, v114
    v_fma_f32 v11, v23, v111, v115
    v_fmac_f32 v8, v24, v40
    v_fmac_f32 v9, v24, v41
    v_fmac_f32 v10, v24, v42
    v_fmac_f32 v11, v24, v43
    v_exp_f32 v8, v8
    s_add_u32 m0, m0, 16384
    s_add_u32 s12, s12, 16384
    buffer_load_dwordx4 v26, s[4:7], s12 offen offset:0 sc1 lds
    v_fma_f32 v12, v23, v116, v120
    v_exp_f32 v9, v9
    v_fma_f32 v13, v23, v117, v121
    v_exp_f32 v10, v10
    v_fma_f32 v14, v23, v118, v122
    v_exp_f32 v11, v11
    v_fma_f32 v15, v23, v119, v123
    v_add_f32 v8, 1.0, v8
    buffer_load_dwordx4 v26, s[4:7], s12 offen offset:1024 sc1 lds
    v_add_f32 v9, 1.0, v9
    v_add_f32 v10, 1.0, v10
    v_add_f32 v11, 1.0, v11
    v_rcp_f32 v8, v8
    v_fmac_f32 v12, v22, v44
    v_rcp_f32 v9, v9
    v_fmac_f32 v13, v22, v45
    v_rcp_f32 v10, v10
    v_fmac_f32 v14, v22, v46
    buffer_load_dwordx4 v26, s[4:7], s12 offen offset:2048 sc1 lds
    v_rcp_f32 v11, v11
    v_fmac_f32 v15, v22, v47
    v_mul_f32 v8, v8, v12
    v_mul_f32 v9, v9, v13
    v_mul_f32 v10, v10, v14
    v_mul_f32 v11, v11, v15
    v_cvt_pk_bf16_f32 v98, v8, v9
    v_cvt_pk_bf16_f32 v99, v10, v11
    buffer_load_dwordx4 v26, s[4:7], s12 offen offset:3072 sc1 lds
    v_permlane32_swap_b32 v96, v98
    v_permlane32_swap_b32 v97, v99
    buffer_store_dwordx4 v[96:99], v18, s[4:7], s24 offen sc1
    ds_read_b128 v[100:103], v124 offset:512
    ds_read_b128 v[22:25], v124 offset:768
    s_branch PG_17
.p2align 12
PG_17:
    v_add_u32 v20, 65536, v20
    ds_read_b64_tr_b16 v[64:65], v20 offset:0
    ds_read_b64_tr_b16 v[66:67], v20 offset:512
    ds_read_b64_tr_b16 v[68:69], v20 offset:16384
    ds_read_b64_tr_b16 v[70:71], v20 offset:16896
    ds_read_b64_tr_b16 v[72:73], v20 offset:1024
    ds_read_b64_tr_b16 v[74:75], v20 offset:1536
    ds_read_b64_tr_b16 v[76:77], v20 offset:17408
    ds_read_b64_tr_b16 v[78:79], v20 offset:17920
    ds_read_b64_tr_b16 v[80:81], v20 offset:2048
    ds_read_b64_tr_b16 v[82:83], v20 offset:2560
    ds_read_b64_tr_b16 v[84:85], v20 offset:18432
    ds_read_b64_tr_b16 v[86:87], v20 offset:18944
    s_barrier
    s_setprio 0
    s_waitcnt lgkmcnt(8)
    v_mfma_f32_16x16x32_bf16 v[48:51], v[128:131], v[64:67], 0
    ds_read_b64_tr_b16 v[88:89], v20 offset:3072
    v_mfma_f32_16x16x32_bf16 v[52:55], v[132:135], v[64:67], 0
    ds_read_b64_tr_b16 v[90:91], v20 offset:3584
    v_mfma_f32_16x16x32_bf16 v[56:59], v[128:131], v[68:71], 0
    ds_read_b64_tr_b16 v[92:93], v20 offset:19456
    v_mfma_f32_16x16x32_bf16 v[60:63], v[132:135], v[68:71], 0
    ds_read_b64_tr_b16 v[94:95], v20 offset:19968
    s_waitcnt lgkmcnt(8)
    v_mfma_f32_16x16x32_bf16 v[48:51], v[136:139], v[72:75], v[48:51]
    ds_read_b64_tr_b16 v[64:65], v20 offset:4096
    v_mfma_f32_16x16x32_bf16 v[52:55], v[140:143], v[72:75], v[52:55]
    ds_read_b64_tr_b16 v[66:67], v20 offset:4608
    v_mfma_f32_16x16x32_bf16 v[56:59], v[136:139], v[76:79], v[56:59]
    ds_read_b64_tr_b16 v[68:69], v20 offset:20480
    v_mfma_f32_16x16x32_bf16 v[60:63], v[140:143], v[76:79], v[60:63]
    ds_read_b64_tr_b16 v[70:71], v20 offset:20992
    s_waitcnt lgkmcnt(8)
    v_mfma_f32_16x16x32_bf16 v[48:51], v[144:147], v[80:83], v[48:51]
    ds_read_b64_tr_b16 v[72:73], v20 offset:5120
    v_mfma_f32_16x16x32_bf16 v[52:55], v[148:151], v[80:83], v[52:55]
    ds_read_b64_tr_b16 v[74:75], v20 offset:5632
    v_mfma_f32_16x16x32_bf16 v[56:59], v[144:147], v[84:87], v[56:59]
    ds_read_b64_tr_b16 v[76:77], v20 offset:21504
    v_mfma_f32_16x16x32_bf16 v[60:63], v[148:151], v[84:87], v[60:63]
    ds_read_b64_tr_b16 v[78:79], v20 offset:22016
    s_waitcnt lgkmcnt(8)
    v_mfma_f32_16x16x32_bf16 v[48:51], v[152:155], v[88:91], v[48:51]
    ds_read_b64_tr_b16 v[80:81], v20 offset:6144
    v_mfma_f32_16x16x32_bf16 v[52:55], v[156:159], v[88:91], v[52:55]
    ds_read_b64_tr_b16 v[82:83], v20 offset:6656
    v_mfma_f32_16x16x32_bf16 v[56:59], v[152:155], v[92:95], v[56:59]
    ds_read_b64_tr_b16 v[84:85], v20 offset:22528
    v_mfma_f32_16x16x32_bf16 v[60:63], v[156:159], v[92:95], v[60:63]
    ds_read_b64_tr_b16 v[86:87], v20 offset:23040
    s_waitcnt lgkmcnt(8)
    v_mfma_f32_16x16x32_bf16 v[48:51], v[160:163], v[64:67], v[48:51]
    ds_read_b64_tr_b16 v[88:89], v20 offset:7168
    v_mfma_f32_16x16x32_bf16 v[52:55], v[164:167], v[64:67], v[52:55]
    ds_read_b64_tr_b16 v[90:91], v20 offset:7680
    v_mfma_f32_16x16x32_bf16 v[56:59], v[160:163], v[68:71], v[56:59]
    ds_read_b64_tr_b16 v[92:93], v20 offset:23552
    v_mfma_f32_16x16x32_bf16 v[60:63], v[164:167], v[68:71], v[60:63]
    ds_read_b64_tr_b16 v[94:95], v20 offset:24064
    s_waitcnt lgkmcnt(8)
    v_mfma_f32_16x16x32_bf16 v[48:51], v[168:171], v[72:75], v[48:51]
    ds_read_b64_tr_b16 v[64:65], v20 offset:8192
    v_mfma_f32_16x16x32_bf16 v[52:55], v[172:175], v[72:75], v[52:55]
    ds_read_b64_tr_b16 v[66:67], v20 offset:8704
    v_mfma_f32_16x16x32_bf16 v[56:59], v[168:171], v[76:79], v[56:59]
    ds_read_b64_tr_b16 v[68:69], v20 offset:24576
    v_mfma_f32_16x16x32_bf16 v[60:63], v[172:175], v[76:79], v[60:63]
    ds_read_b64_tr_b16 v[70:71], v20 offset:25088
    s_waitcnt lgkmcnt(8)
    v_mfma_f32_16x16x32_bf16 v[48:51], v[176:179], v[80:83], v[48:51]
    ds_read_b64_tr_b16 v[72:73], v20 offset:9216
    v_mfma_f32_16x16x32_bf16 v[52:55], v[180:183], v[80:83], v[52:55]
    ds_read_b64_tr_b16 v[74:75], v20 offset:9728
    v_mfma_f32_16x16x32_bf16 v[56:59], v[176:179], v[84:87], v[56:59]
    ds_read_b64_tr_b16 v[76:77], v20 offset:25600
    v_mfma_f32_16x16x32_bf16 v[60:63], v[180:183], v[84:87], v[60:63]
    ds_read_b64_tr_b16 v[78:79], v20 offset:26112
    s_waitcnt lgkmcnt(8)
    v_mfma_f32_16x16x32_bf16 v[48:51], v[184:187], v[88:91], v[48:51]
    ds_read_b64_tr_b16 v[80:81], v20 offset:10240
    v_mfma_f32_16x16x32_bf16 v[52:55], v[188:191], v[88:91], v[52:55]
    ds_read_b64_tr_b16 v[82:83], v20 offset:10752
    v_mfma_f32_16x16x32_bf16 v[56:59], v[184:187], v[92:95], v[56:59]
    ds_read_b64_tr_b16 v[84:85], v20 offset:26624
    v_mfma_f32_16x16x32_bf16 v[60:63], v[188:191], v[92:95], v[60:63]
    ds_read_b64_tr_b16 v[86:87], v20 offset:27136
    s_waitcnt lgkmcnt(8)
    v_mfma_f32_16x16x32_bf16 v[48:51], v[192:195], v[64:67], v[48:51]
    ds_read_b64_tr_b16 v[88:89], v20 offset:11264
    v_mfma_f32_16x16x32_bf16 v[52:55], v[196:199], v[64:67], v[52:55]
    ds_read_b64_tr_b16 v[90:91], v20 offset:11776
    v_mfma_f32_16x16x32_bf16 v[56:59], v[192:195], v[68:71], v[56:59]
    ds_read_b64_tr_b16 v[92:93], v20 offset:27648
    v_mfma_f32_16x16x32_bf16 v[60:63], v[196:199], v[68:71], v[60:63]
    ds_read_b64_tr_b16 v[94:95], v20 offset:28160
    s_waitcnt lgkmcnt(8)
    v_mfma_f32_16x16x32_bf16 v[48:51], v[200:203], v[72:75], v[48:51]
    ds_read_b64_tr_b16 v[64:65], v20 offset:12288
    v_mfma_f32_16x16x32_bf16 v[52:55], v[204:207], v[72:75], v[52:55]
    ds_read_b64_tr_b16 v[66:67], v20 offset:12800
    v_mfma_f32_16x16x32_bf16 v[56:59], v[200:203], v[76:79], v[56:59]
    ds_read_b64_tr_b16 v[68:69], v20 offset:28672
    v_mfma_f32_16x16x32_bf16 v[60:63], v[204:207], v[76:79], v[60:63]
    ds_read_b64_tr_b16 v[70:71], v20 offset:29184
    s_waitcnt lgkmcnt(8)
    v_mfma_f32_16x16x32_bf16 v[48:51], v[208:211], v[80:83], v[48:51]
    ds_read_b64_tr_b16 v[72:73], v20 offset:13312
    v_mfma_f32_16x16x32_bf16 v[52:55], v[212:215], v[80:83], v[52:55]
    ds_read_b64_tr_b16 v[74:75], v20 offset:13824
    v_mfma_f32_16x16x32_bf16 v[56:59], v[208:211], v[84:87], v[56:59]
    ds_read_b64_tr_b16 v[76:77], v20 offset:29696
    v_mfma_f32_16x16x32_bf16 v[60:63], v[212:215], v[84:87], v[60:63]
    ds_read_b64_tr_b16 v[78:79], v20 offset:30208
    s_waitcnt lgkmcnt(8)
    v_mfma_f32_16x16x32_bf16 v[48:51], v[216:219], v[88:91], v[48:51]
    ds_read_b64_tr_b16 v[80:81], v20 offset:14336
    v_mfma_f32_16x16x32_bf16 v[52:55], v[220:223], v[88:91], v[52:55]
    ds_read_b64_tr_b16 v[82:83], v20 offset:14848
    v_mfma_f32_16x16x32_bf16 v[56:59], v[216:219], v[92:95], v[56:59]
    ds_read_b64_tr_b16 v[84:85], v20 offset:30720
    v_mfma_f32_16x16x32_bf16 v[60:63], v[220:223], v[92:95], v[60:63]
    ds_read_b64_tr_b16 v[86:87], v20 offset:31232
    s_waitcnt lgkmcnt(8)
    v_mfma_f32_16x16x32_bf16 v[48:51], v[224:227], v[64:67], v[48:51]
    ds_read_b64_tr_b16 v[88:89], v20 offset:15360
    v_mfma_f32_16x16x32_bf16 v[52:55], v[228:231], v[64:67], v[52:55]
    ds_read_b64_tr_b16 v[90:91], v20 offset:15872
    v_mfma_f32_16x16x32_bf16 v[56:59], v[224:227], v[68:71], v[56:59]
    ds_read_b64_tr_b16 v[92:93], v20 offset:31744
    v_mfma_f32_16x16x32_bf16 v[60:63], v[228:231], v[68:71], v[60:63]
    ds_read_b64_tr_b16 v[94:95], v20 offset:32256
    s_waitcnt lgkmcnt(8)
    v_mfma_f32_16x16x32_bf16 v[48:51], v[232:235], v[72:75], v[48:51]
    v_mfma_f32_16x16x32_bf16 v[52:55], v[236:239], v[72:75], v[52:55]
    v_mfma_f32_16x16x32_bf16 v[56:59], v[232:235], v[76:79], v[56:59]
    v_mfma_f32_16x16x32_bf16 v[60:63], v[236:239], v[76:79], v[60:63]
    s_waitcnt lgkmcnt(4)
    v_mfma_f32_16x16x32_bf16 v[48:51], v[240:243], v[80:83], v[48:51]
    v_mfma_f32_16x16x32_bf16 v[52:55], v[244:247], v[80:83], v[52:55]
    v_mfma_f32_16x16x32_bf16 v[56:59], v[240:243], v[84:87], v[56:59]
    v_mfma_f32_16x16x32_bf16 v[60:63], v[244:247], v[84:87], v[60:63]
    s_waitcnt lgkmcnt(0)
    s_setprio 2
    s_waitcnt vmcnt(0)
    s_barrier
    v_mfma_f32_16x16x32_bf16 v[48:51], v[248:251], v[88:91], v[48:51]
    v_mfma_f32_16x16x32_bf16 v[52:55], v[252:255], v[88:91], v[52:55]
    v_mfma_f32_16x16x32_bf16 v[56:59], v[248:251], v[92:95], v[56:59]
    v_mfma_f32_16x16x32_bf16 v[60:63], v[252:255], v[92:95], v[60:63]
    s_add_u32 s28, s24, 114688
    v_fma_f32 v8, v101, v108, v112
    v_fma_f32 v9, v101, v109, v113
    v_fma_f32 v10, v101, v110, v114
    v_fma_f32 v11, v101, v111, v115
    v_fmac_f32 v8, v102, v48
    v_fmac_f32 v9, v102, v49
    v_fmac_f32 v10, v102, v50
    v_fmac_f32 v11, v102, v51
    v_exp_f32 v8, v8
    s_add_u32 m0, s27, 0
    s_add_u32 s12, s20, 327680
    buffer_load_dwordx4 v104, s[36:39], s12 offen offset:0 lds
    v_fma_f32 v12, v101, v116, v120
    v_exp_f32 v9, v9
    v_fma_f32 v13, v101, v117, v121
    v_exp_f32 v10, v10
    v_fma_f32 v14, v101, v118, v122
    v_exp_f32 v11, v11
    v_fma_f32 v15, v101, v119, v123
    v_add_f32 v8, 1.0, v8
    buffer_load_dwordx4 v105, s[36:39], s12 offen offset:1024 lds
    v_add_f32 v9, 1.0, v9
    v_add_f32 v10, 1.0, v10
    v_add_f32 v11, 1.0, v11
    v_rcp_f32 v8, v8
    v_fmac_f32 v12, v100, v52
    v_rcp_f32 v9, v9
    v_fmac_f32 v13, v100, v53
    v_rcp_f32 v10, v10
    v_fmac_f32 v14, v100, v54
    buffer_load_dwordx4 v106, s[36:39], s12 offen offset:2048 lds
    v_rcp_f32 v11, v11
    v_fmac_f32 v15, v100, v55
    v_mul_f32 v8, v8, v12
    v_mul_f32 v9, v9, v13
    v_mul_f32 v10, v10, v14
    v_mul_f32 v11, v11, v15
    v_cvt_pk_bf16_f32 v96, v8, v9
    v_cvt_pk_bf16_f32 v97, v10, v11
    buffer_load_dwordx4 v107, s[36:39], s12 offen offset:3072 lds
    v_fma_f32 v8, v23, v108, v112
    v_fma_f32 v9, v23, v109, v113
    v_fma_f32 v10, v23, v110, v114
    v_fma_f32 v11, v23, v111, v115
    v_fmac_f32 v8, v24, v56
    v_fmac_f32 v9, v24, v57
    v_fmac_f32 v10, v24, v58
    v_fmac_f32 v11, v24, v59
    v_exp_f32 v8, v8
    s_add_u32 m0, s27, 16384
    s_add_u32 s12, s20, 589824
    buffer_load_dwordx4 v104, s[36:39], s12 offen offset:0 lds
    v_fma_f32 v12, v23, v116, v120
    v_exp_f32 v9, v9
    v_fma_f32 v13, v23, v117, v121
    v_exp_f32 v10, v10
    v_fma_f32 v14, v23, v118, v122
    v_exp_f32 v11, v11
    v_fma_f32 v15, v23, v119, v123
    v_add_f32 v8, 1.0, v8
    buffer_load_dwordx4 v105, s[36:39], s12 offen offset:1024 lds
    v_add_f32 v9, 1.0, v9
    v_add_f32 v10, 1.0, v10
    v_add_f32 v11, 1.0, v11
    v_rcp_f32 v8, v8
    v_fmac_f32 v12, v22, v60
    v_rcp_f32 v9, v9
    v_fmac_f32 v13, v22, v61
    v_rcp_f32 v10, v10
    v_fmac_f32 v14, v22, v62
    buffer_load_dwordx4 v106, s[36:39], s12 offen offset:2048 lds
    v_rcp_f32 v11, v11
    v_fmac_f32 v15, v22, v63
    v_mul_f32 v8, v8, v12
    v_mul_f32 v9, v9, v13
    v_mul_f32 v10, v10, v14
    v_mul_f32 v11, v11, v15
    v_cvt_pk_bf16_f32 v98, v8, v9
    v_cvt_pk_bf16_f32 v99, v10, v11
    buffer_load_dwordx4 v107, s[36:39], s12 offen offset:3072 lds
    v_permlane32_swap_b32 v96, v98
    v_permlane32_swap_b32 v97, v99
    buffer_store_dwordx4 v[96:99], v18, s[4:7], s28 offen sc1
    ds_read_b128 v[100:103], v7 offset:0
    ds_read_b128 v[22:25], v7 offset:256
    v_add_u32 v20, 32768, v20
    ds_read_b64_tr_b16 v[64:65], v20 offset:0
    ds_read_b64_tr_b16 v[66:67], v20 offset:512
    ds_read_b64_tr_b16 v[68:69], v20 offset:16384
    ds_read_b64_tr_b16 v[70:71], v20 offset:16896
    ds_read_b64_tr_b16 v[72:73], v20 offset:1024
    ds_read_b64_tr_b16 v[74:75], v20 offset:1536
    ds_read_b64_tr_b16 v[76:77], v20 offset:17408
    ds_read_b64_tr_b16 v[78:79], v20 offset:17920
    ds_read_b64_tr_b16 v[80:81], v20 offset:2048
    ds_read_b64_tr_b16 v[82:83], v20 offset:2560
    ds_read_b64_tr_b16 v[84:85], v20 offset:18432
    ds_read_b64_tr_b16 v[86:87], v20 offset:18944
    s_setprio 0
    s_waitcnt lgkmcnt(8)
    v_mfma_f32_16x16x32_bf16 v[32:35], v[128:131], v[64:67], 0
    ds_read_b64_tr_b16 v[88:89], v20 offset:3072
    v_mfma_f32_16x16x32_bf16 v[36:39], v[132:135], v[64:67], 0
    ds_read_b64_tr_b16 v[90:91], v20 offset:3584
    v_mfma_f32_16x16x32_bf16 v[40:43], v[128:131], v[68:71], 0
    ds_read_b64_tr_b16 v[92:93], v20 offset:19456
    v_mfma_f32_16x16x32_bf16 v[44:47], v[132:135], v[68:71], 0
    ds_read_b64_tr_b16 v[94:95], v20 offset:19968
    s_waitcnt lgkmcnt(8)
    v_mfma_f32_16x16x32_bf16 v[32:35], v[136:139], v[72:75], v[32:35]
    ds_read_b64_tr_b16 v[64:65], v20 offset:4096
    v_mfma_f32_16x16x32_bf16 v[36:39], v[140:143], v[72:75], v[36:39]
    ds_read_b64_tr_b16 v[66:67], v20 offset:4608
    v_mfma_f32_16x16x32_bf16 v[40:43], v[136:139], v[76:79], v[40:43]
    ds_read_b64_tr_b16 v[68:69], v20 offset:20480
    v_mfma_f32_16x16x32_bf16 v[44:47], v[140:143], v[76:79], v[44:47]
    ds_read_b64_tr_b16 v[70:71], v20 offset:20992
    s_waitcnt lgkmcnt(8)
    v_mfma_f32_16x16x32_bf16 v[32:35], v[144:147], v[80:83], v[32:35]
    ds_read_b64_tr_b16 v[72:73], v20 offset:5120
    v_mfma_f32_16x16x32_bf16 v[36:39], v[148:151], v[80:83], v[36:39]
    ds_read_b64_tr_b16 v[74:75], v20 offset:5632
    v_mfma_f32_16x16x32_bf16 v[40:43], v[144:147], v[84:87], v[40:43]
    ds_read_b64_tr_b16 v[76:77], v20 offset:21504
    v_mfma_f32_16x16x32_bf16 v[44:47], v[148:151], v[84:87], v[44:47]
    ds_read_b64_tr_b16 v[78:79], v20 offset:22016
    s_waitcnt lgkmcnt(8)
    v_mfma_f32_16x16x32_bf16 v[32:35], v[152:155], v[88:91], v[32:35]
    ds_read_b64_tr_b16 v[80:81], v20 offset:6144
    v_mfma_f32_16x16x32_bf16 v[36:39], v[156:159], v[88:91], v[36:39]
    ds_read_b64_tr_b16 v[82:83], v20 offset:6656
    v_mfma_f32_16x16x32_bf16 v[40:43], v[152:155], v[92:95], v[40:43]
    ds_read_b64_tr_b16 v[84:85], v20 offset:22528
    v_mfma_f32_16x16x32_bf16 v[44:47], v[156:159], v[92:95], v[44:47]
    ds_read_b64_tr_b16 v[86:87], v20 offset:23040
    s_waitcnt lgkmcnt(8)
    v_mfma_f32_16x16x32_bf16 v[32:35], v[160:163], v[64:67], v[32:35]
    ds_read_b64_tr_b16 v[88:89], v20 offset:7168
    v_mfma_f32_16x16x32_bf16 v[36:39], v[164:167], v[64:67], v[36:39]
    ds_read_b64_tr_b16 v[90:91], v20 offset:7680
    v_mfma_f32_16x16x32_bf16 v[40:43], v[160:163], v[68:71], v[40:43]
    ds_read_b64_tr_b16 v[92:93], v20 offset:23552
    v_mfma_f32_16x16x32_bf16 v[44:47], v[164:167], v[68:71], v[44:47]
    ds_read_b64_tr_b16 v[94:95], v20 offset:24064
    s_waitcnt lgkmcnt(8)
    v_mfma_f32_16x16x32_bf16 v[32:35], v[168:171], v[72:75], v[32:35]
    ds_read_b64_tr_b16 v[64:65], v20 offset:8192
    v_mfma_f32_16x16x32_bf16 v[36:39], v[172:175], v[72:75], v[36:39]
    ds_read_b64_tr_b16 v[66:67], v20 offset:8704
    v_mfma_f32_16x16x32_bf16 v[40:43], v[168:171], v[76:79], v[40:43]
    ds_read_b64_tr_b16 v[68:69], v20 offset:24576
    v_mfma_f32_16x16x32_bf16 v[44:47], v[172:175], v[76:79], v[44:47]
    ds_read_b64_tr_b16 v[70:71], v20 offset:25088
    s_waitcnt lgkmcnt(8)
    v_mfma_f32_16x16x32_bf16 v[32:35], v[176:179], v[80:83], v[32:35]
    ds_read_b64_tr_b16 v[72:73], v20 offset:9216
    v_mfma_f32_16x16x32_bf16 v[36:39], v[180:183], v[80:83], v[36:39]
    ds_read_b64_tr_b16 v[74:75], v20 offset:9728
    v_mfma_f32_16x16x32_bf16 v[40:43], v[176:179], v[84:87], v[40:43]
    ds_read_b64_tr_b16 v[76:77], v20 offset:25600
    v_mfma_f32_16x16x32_bf16 v[44:47], v[180:183], v[84:87], v[44:47]
    ds_read_b64_tr_b16 v[78:79], v20 offset:26112
    s_waitcnt lgkmcnt(8)
    v_mfma_f32_16x16x32_bf16 v[32:35], v[184:187], v[88:91], v[32:35]
    ds_read_b64_tr_b16 v[80:81], v20 offset:10240
    v_mfma_f32_16x16x32_bf16 v[36:39], v[188:191], v[88:91], v[36:39]
    ds_read_b64_tr_b16 v[82:83], v20 offset:10752
    v_mfma_f32_16x16x32_bf16 v[40:43], v[184:187], v[92:95], v[40:43]
    ds_read_b64_tr_b16 v[84:85], v20 offset:26624
    v_mfma_f32_16x16x32_bf16 v[44:47], v[188:191], v[92:95], v[44:47]
    ds_read_b64_tr_b16 v[86:87], v20 offset:27136
    s_waitcnt lgkmcnt(8)
    v_mfma_f32_16x16x32_bf16 v[32:35], v[192:195], v[64:67], v[32:35]
    ds_read_b64_tr_b16 v[88:89], v20 offset:11264
    v_mfma_f32_16x16x32_bf16 v[36:39], v[196:199], v[64:67], v[36:39]
    ds_read_b64_tr_b16 v[90:91], v20 offset:11776
    v_mfma_f32_16x16x32_bf16 v[40:43], v[192:195], v[68:71], v[40:43]
    ds_read_b64_tr_b16 v[92:93], v20 offset:27648
    v_mfma_f32_16x16x32_bf16 v[44:47], v[196:199], v[68:71], v[44:47]
    ds_read_b64_tr_b16 v[94:95], v20 offset:28160
    s_waitcnt lgkmcnt(8)
    v_mfma_f32_16x16x32_bf16 v[32:35], v[200:203], v[72:75], v[32:35]
    ds_read_b64_tr_b16 v[64:65], v20 offset:12288
    v_mfma_f32_16x16x32_bf16 v[36:39], v[204:207], v[72:75], v[36:39]
    ds_read_b64_tr_b16 v[66:67], v20 offset:12800
    v_mfma_f32_16x16x32_bf16 v[40:43], v[200:203], v[76:79], v[40:43]
    ds_read_b64_tr_b16 v[68:69], v20 offset:28672
    v_mfma_f32_16x16x32_bf16 v[44:47], v[204:207], v[76:79], v[44:47]
    ds_read_b64_tr_b16 v[70:71], v20 offset:29184
    s_waitcnt lgkmcnt(8)
    v_mfma_f32_16x16x32_bf16 v[32:35], v[208:211], v[80:83], v[32:35]
    ds_read_b64_tr_b16 v[72:73], v20 offset:13312
    v_mfma_f32_16x16x32_bf16 v[36:39], v[212:215], v[80:83], v[36:39]
    ds_read_b64_tr_b16 v[74:75], v20 offset:13824
    v_mfma_f32_16x16x32_bf16 v[40:43], v[208:211], v[84:87], v[40:43]
    ds_read_b64_tr_b16 v[76:77], v20 offset:29696
    v_mfma_f32_16x16x32_bf16 v[44:47], v[212:215], v[84:87], v[44:47]
    ds_read_b64_tr_b16 v[78:79], v20 offset:30208
    s_waitcnt lgkmcnt(8)
    v_mfma_f32_16x16x32_bf16 v[32:35], v[216:219], v[88:91], v[32:35]
    ds_read_b64_tr_b16 v[80:81], v20 offset:14336
    v_mfma_f32_16x16x32_bf16 v[36:39], v[220:223], v[88:91], v[36:39]
    ds_read_b64_tr_b16 v[82:83], v20 offset:14848
    v_mfma_f32_16x16x32_bf16 v[40:43], v[216:219], v[92:95], v[40:43]
    ds_read_b64_tr_b16 v[84:85], v20 offset:30720
    v_mfma_f32_16x16x32_bf16 v[44:47], v[220:223], v[92:95], v[44:47]
    ds_read_b64_tr_b16 v[86:87], v20 offset:31232
    s_waitcnt lgkmcnt(8)
    v_mfma_f32_16x16x32_bf16 v[32:35], v[224:227], v[64:67], v[32:35]
    ds_read_b64_tr_b16 v[88:89], v20 offset:15360
    v_mfma_f32_16x16x32_bf16 v[36:39], v[228:231], v[64:67], v[36:39]
    ds_read_b64_tr_b16 v[90:91], v20 offset:15872
    v_mfma_f32_16x16x32_bf16 v[40:43], v[224:227], v[68:71], v[40:43]
    ds_read_b64_tr_b16 v[92:93], v20 offset:31744
    v_mfma_f32_16x16x32_bf16 v[44:47], v[228:231], v[68:71], v[44:47]
    ds_read_b64_tr_b16 v[94:95], v20 offset:32256
    s_waitcnt lgkmcnt(8)
    v_mfma_f32_16x16x32_bf16 v[32:35], v[232:235], v[72:75], v[32:35]
    v_mfma_f32_16x16x32_bf16 v[36:39], v[236:239], v[72:75], v[36:39]
    v_mfma_f32_16x16x32_bf16 v[40:43], v[232:235], v[76:79], v[40:43]
    v_mfma_f32_16x16x32_bf16 v[44:47], v[236:239], v[76:79], v[44:47]
    s_waitcnt lgkmcnt(4)
    v_mfma_f32_16x16x32_bf16 v[32:35], v[240:243], v[80:83], v[32:35]
    v_mfma_f32_16x16x32_bf16 v[36:39], v[244:247], v[80:83], v[36:39]
    v_mfma_f32_16x16x32_bf16 v[40:43], v[240:243], v[84:87], v[40:43]
    v_mfma_f32_16x16x32_bf16 v[44:47], v[244:247], v[84:87], v[44:47]
    s_waitcnt lgkmcnt(0)
    s_setprio 2
    s_waitcnt vmcnt(1)
    s_barrier
    v_mfma_f32_16x16x32_bf16 v[32:35], v[248:251], v[88:91], v[32:35]
    v_mfma_f32_16x16x32_bf16 v[36:39], v[252:255], v[88:91], v[36:39]
    v_mfma_f32_16x16x32_bf16 v[40:43], v[248:251], v[92:95], v[40:43]
    v_mfma_f32_16x16x32_bf16 v[44:47], v[252:255], v[92:95], v[44:47]
    s_waitcnt vmcnt(0)
    s_atomic_add s32, s[4:5], s26 offset:196736
    s_atomic_add s32, s[4:5], s26 offset:197504
    v_fma_f32 v8, v101, v108, v112
    v_fma_f32 v9, v101, v109, v113
    v_fma_f32 v10, v101, v110, v114
    v_fma_f32 v11, v101, v111, v115
    v_fmac_f32 v8, v102, v32
    v_fmac_f32 v9, v102, v33
    v_fmac_f32 v10, v102, v34
    v_fmac_f32 v11, v102, v35
    v_exp_f32 v8, v8
    s_add_u32 m0, s27, 98304
    s_add_u32 s12, s20, 393216
    buffer_load_dwordx4 v104, s[36:39], s12 offen offset:0 lds
    v_fma_f32 v12, v101, v116, v120
    v_exp_f32 v9, v9
    v_fma_f32 v13, v101, v117, v121
    v_exp_f32 v10, v10
    v_fma_f32 v14, v101, v118, v122
    v_exp_f32 v11, v11
    v_fma_f32 v15, v101, v119, v123
    v_add_f32 v8, 1.0, v8
    buffer_load_dwordx4 v105, s[36:39], s12 offen offset:1024 lds
    v_add_f32 v9, 1.0, v9
    v_add_f32 v10, 1.0, v10
    v_add_f32 v11, 1.0, v11
    v_rcp_f32 v8, v8
    v_fmac_f32 v12, v100, v36
    v_rcp_f32 v9, v9
    v_fmac_f32 v13, v100, v37
    v_rcp_f32 v10, v10
    v_fmac_f32 v14, v100, v38
    buffer_load_dwordx4 v106, s[36:39], s12 offen offset:2048 lds
    v_rcp_f32 v11, v11
    v_fmac_f32 v15, v100, v39
    v_mul_f32 v8, v8, v12
    v_mul_f32 v9, v9, v13
    v_mul_f32 v10, v10, v14
    v_mul_f32 v11, v11, v15
    v_cvt_pk_bf16_f32 v96, v8, v9
    v_cvt_pk_bf16_f32 v97, v10, v11
    buffer_load_dwordx4 v107, s[36:39], s12 offen offset:3072 lds
    v_fma_f32 v8, v23, v108, v112
    v_fma_f32 v9, v23, v109, v113
    v_fma_f32 v10, v23, v110, v114
    v_fma_f32 v11, v23, v111, v115
    v_fmac_f32 v8, v24, v40
    v_fmac_f32 v9, v24, v41
    v_fmac_f32 v10, v24, v42
    v_fmac_f32 v11, v24, v43
    v_exp_f32 v8, v8
    s_add_u32 m0, s27, 114688
    s_add_u32 s12, s20, 655360
    buffer_load_dwordx4 v104, s[36:39], s12 offen offset:0 lds
    v_fma_f32 v12, v23, v116, v120
    v_exp_f32 v9, v9
    v_fma_f32 v13, v23, v117, v121
    v_exp_f32 v10, v10
    v_fma_f32 v14, v23, v118, v122
    v_exp_f32 v11, v11
    v_fma_f32 v15, v23, v119, v123
    v_add_f32 v8, 1.0, v8
    buffer_load_dwordx4 v105, s[36:39], s12 offen offset:1024 lds
    v_add_f32 v9, 1.0, v9
    v_add_f32 v10, 1.0, v10
    v_add_f32 v11, 1.0, v11
    v_rcp_f32 v8, v8
    v_fmac_f32 v12, v22, v44
    v_rcp_f32 v9, v9
    v_fmac_f32 v13, v22, v45
    v_rcp_f32 v10, v10
    v_fmac_f32 v14, v22, v46
    buffer_load_dwordx4 v106, s[36:39], s12 offen offset:2048 lds
    v_rcp_f32 v11, v11
    v_fmac_f32 v15, v22, v47
    v_mul_f32 v8, v8, v12
    v_mul_f32 v9, v9, v13
    v_mul_f32 v10, v10, v14
    v_mul_f32 v11, v11, v15
    v_cvt_pk_bf16_f32 v98, v8, v9
    v_cvt_pk_bf16_f32 v99, v10, v11
    buffer_load_dwordx4 v107, s[36:39], s12 offen offset:3072 lds
    v_permlane32_swap_b32 v96, v98
    v_permlane32_swap_b32 v97, v99
    buffer_store_dwordx4 v[96:99], v18, s[4:7], s45 offen sc1
    v_xor_b32 v7, 512, v7
    ds_read_b128 v[100:103], v7 offset:0
    ds_read_b128 v[22:25], v7 offset:256
    s_branch PG_19
.p2align 12
PG_19:
    v_add_u32 v20, 4294901760, v20
    ds_read_b64_tr_b16 v[64:65], v20 offset:0
    ds_read_b64_tr_b16 v[66:67], v20 offset:512
    ds_read_b64_tr_b16 v[68:69], v20 offset:16384
    ds_read_b64_tr_b16 v[70:71], v20 offset:16896
    ds_read_b64_tr_b16 v[72:73], v20 offset:1024
    ds_read_b64_tr_b16 v[74:75], v20 offset:1536
    ds_read_b64_tr_b16 v[76:77], v20 offset:17408
    ds_read_b64_tr_b16 v[78:79], v20 offset:17920
    ds_read_b64_tr_b16 v[80:81], v20 offset:2048
    ds_read_b64_tr_b16 v[82:83], v20 offset:2560
    ds_read_b64_tr_b16 v[84:85], v20 offset:18432
    ds_read_b64_tr_b16 v[86:87], v20 offset:18944
    s_setprio 0
    s_waitcnt lgkmcnt(8)
    v_mfma_f32_16x16x32_bf16 v[48:51], v[128:131], v[64:67], 0
    ds_read_b64_tr_b16 v[88:89], v20 offset:3072
    v_mfma_f32_16x16x32_bf16 v[52:55], v[132:135], v[64:67], 0
    ds_read_b64_tr_b16 v[90:91], v20 offset:3584
    v_mfma_f32_16x16x32_bf16 v[56:59], v[128:131], v[68:71], 0
    ds_read_b64_tr_b16 v[92:93], v20 offset:19456
    v_mfma_f32_16x16x32_bf16 v[60:63], v[132:135], v[68:71], 0
    ds_read_b64_tr_b16 v[94:95], v20 offset:19968
    s_waitcnt lgkmcnt(8)
    v_mfma_f32_16x16x32_bf16 v[48:51], v[136:139], v[72:75], v[48:51]
    ds_read_b64_tr_b16 v[64:65], v20 offset:4096
    v_mfma_f32_16x16x32_bf16 v[52:55], v[140:143], v[72:75], v[52:55]
    ds_read_b64_tr_b16 v[66:67], v20 offset:4608
    v_mfma_f32_16x16x32_bf16 v[56:59], v[136:139], v[76:79], v[56:59]
    ds_read_b64_tr_b16 v[68:69], v20 offset:20480
    v_mfma_f32_16x16x32_bf16 v[60:63], v[140:143], v[76:79], v[60:63]
    ds_read_b64_tr_b16 v[70:71], v20 offset:20992
    s_waitcnt lgkmcnt(8)
    v_mfma_f32_16x16x32_bf16 v[48:51], v[144:147], v[80:83], v[48:51]
    ds_read_b64_tr_b16 v[72:73], v20 offset:5120
    v_mfma_f32_16x16x32_bf16 v[52:55], v[148:151], v[80:83], v[52:55]
    ds_read_b64_tr_b16 v[74:75], v20 offset:5632
    v_mfma_f32_16x16x32_bf16 v[56:59], v[144:147], v[84:87], v[56:59]
    ds_read_b64_tr_b16 v[76:77], v20 offset:21504
    v_mfma_f32_16x16x32_bf16 v[60:63], v[148:151], v[84:87], v[60:63]
    ds_read_b64_tr_b16 v[78:79], v20 offset:22016
    s_waitcnt lgkmcnt(8)
    v_mfma_f32_16x16x32_bf16 v[48:51], v[152:155], v[88:91], v[48:51]
    ds_read_b64_tr_b16 v[80:81], v20 offset:6144
    v_mfma_f32_16x16x32_bf16 v[52:55], v[156:159], v[88:91], v[52:55]
    ds_read_b64_tr_b16 v[82:83], v20 offset:6656
    v_mfma_f32_16x16x32_bf16 v[56:59], v[152:155], v[92:95], v[56:59]
    ds_read_b64_tr_b16 v[84:85], v20 offset:22528
    v_mfma_f32_16x16x32_bf16 v[60:63], v[156:159], v[92:95], v[60:63]
    ds_read_b64_tr_b16 v[86:87], v20 offset:23040
    s_waitcnt lgkmcnt(8)
    v_mfma_f32_16x16x32_bf16 v[48:51], v[160:163], v[64:67], v[48:51]
    ds_read_b64_tr_b16 v[88:89], v20 offset:7168
    v_mfma_f32_16x16x32_bf16 v[52:55], v[164:167], v[64:67], v[52:55]
    ds_read_b64_tr_b16 v[90:91], v20 offset:7680
    v_mfma_f32_16x16x32_bf16 v[56:59], v[160:163], v[68:71], v[56:59]
    ds_read_b64_tr_b16 v[92:93], v20 offset:23552
    v_mfma_f32_16x16x32_bf16 v[60:63], v[164:167], v[68:71], v[60:63]
    ds_read_b64_tr_b16 v[94:95], v20 offset:24064
    s_waitcnt lgkmcnt(8)
    v_mfma_f32_16x16x32_bf16 v[48:51], v[168:171], v[72:75], v[48:51]
    ds_read_b64_tr_b16 v[64:65], v20 offset:8192
    v_mfma_f32_16x16x32_bf16 v[52:55], v[172:175], v[72:75], v[52:55]
    ds_read_b64_tr_b16 v[66:67], v20 offset:8704
    v_mfma_f32_16x16x32_bf16 v[56:59], v[168:171], v[76:79], v[56:59]
    ds_read_b64_tr_b16 v[68:69], v20 offset:24576
    v_mfma_f32_16x16x32_bf16 v[60:63], v[172:175], v[76:79], v[60:63]
    ds_read_b64_tr_b16 v[70:71], v20 offset:25088
    s_waitcnt lgkmcnt(8)
    v_mfma_f32_16x16x32_bf16 v[48:51], v[176:179], v[80:83], v[48:51]
    ds_read_b64_tr_b16 v[72:73], v20 offset:9216
    v_mfma_f32_16x16x32_bf16 v[52:55], v[180:183], v[80:83], v[52:55]
    ds_read_b64_tr_b16 v[74:75], v20 offset:9728
    v_mfma_f32_16x16x32_bf16 v[56:59], v[176:179], v[84:87], v[56:59]
    ds_read_b64_tr_b16 v[76:77], v20 offset:25600
    v_mfma_f32_16x16x32_bf16 v[60:63], v[180:183], v[84:87], v[60:63]
    ds_read_b64_tr_b16 v[78:79], v20 offset:26112
    s_waitcnt lgkmcnt(8)
    v_mfma_f32_16x16x32_bf16 v[48:51], v[184:187], v[88:91], v[48:51]
    ds_read_b64_tr_b16 v[80:81], v20 offset:10240
    v_mfma_f32_16x16x32_bf16 v[52:55], v[188:191], v[88:91], v[52:55]
    ds_read_b64_tr_b16 v[82:83], v20 offset:10752
    v_mfma_f32_16x16x32_bf16 v[56:59], v[184:187], v[92:95], v[56:59]
    ds_read_b64_tr_b16 v[84:85], v20 offset:26624
    v_mfma_f32_16x16x32_bf16 v[60:63], v[188:191], v[92:95], v[60:63]
    ds_read_b64_tr_b16 v[86:87], v20 offset:27136
    s_waitcnt lgkmcnt(8)
    v_mfma_f32_16x16x32_bf16 v[48:51], v[192:195], v[64:67], v[48:51]
    ds_read_b64_tr_b16 v[88:89], v20 offset:11264
    v_mfma_f32_16x16x32_bf16 v[52:55], v[196:199], v[64:67], v[52:55]
    ds_read_b64_tr_b16 v[90:91], v20 offset:11776
    v_mfma_f32_16x16x32_bf16 v[56:59], v[192:195], v[68:71], v[56:59]
    ds_read_b64_tr_b16 v[92:93], v20 offset:27648
    v_mfma_f32_16x16x32_bf16 v[60:63], v[196:199], v[68:71], v[60:63]
    ds_read_b64_tr_b16 v[94:95], v20 offset:28160
    s_waitcnt lgkmcnt(8)
    v_mfma_f32_16x16x32_bf16 v[48:51], v[200:203], v[72:75], v[48:51]
    ds_read_b64_tr_b16 v[64:65], v20 offset:12288
    v_mfma_f32_16x16x32_bf16 v[52:55], v[204:207], v[72:75], v[52:55]
    ds_read_b64_tr_b16 v[66:67], v20 offset:12800
    v_mfma_f32_16x16x32_bf16 v[56:59], v[200:203], v[76:79], v[56:59]
    ds_read_b64_tr_b16 v[68:69], v20 offset:28672
    v_mfma_f32_16x16x32_bf16 v[60:63], v[204:207], v[76:79], v[60:63]
    ds_read_b64_tr_b16 v[70:71], v20 offset:29184
    s_waitcnt lgkmcnt(8)
    v_mfma_f32_16x16x32_bf16 v[48:51], v[208:211], v[80:83], v[48:51]
    ds_read_b64_tr_b16 v[72:73], v20 offset:13312
    v_mfma_f32_16x16x32_bf16 v[52:55], v[212:215], v[80:83], v[52:55]
    ds_read_b64_tr_b16 v[74:75], v20 offset:13824
    v_mfma_f32_16x16x32_bf16 v[56:59], v[208:211], v[84:87], v[56:59]
    ds_read_b64_tr_b16 v[76:77], v20 offset:29696
    v_mfma_f32_16x16x32_bf16 v[60:63], v[212:215], v[84:87], v[60:63]
    ds_read_b64_tr_b16 v[78:79], v20 offset:30208
    s_waitcnt lgkmcnt(8)
    v_mfma_f32_16x16x32_bf16 v[48:51], v[216:219], v[88:91], v[48:51]
    ds_read_b64_tr_b16 v[80:81], v20 offset:14336
    v_mfma_f32_16x16x32_bf16 v[52:55], v[220:223], v[88:91], v[52:55]
    ds_read_b64_tr_b16 v[82:83], v20 offset:14848
    v_mfma_f32_16x16x32_bf16 v[56:59], v[216:219], v[92:95], v[56:59]
    ds_read_b64_tr_b16 v[84:85], v20 offset:30720
    v_mfma_f32_16x16x32_bf16 v[60:63], v[220:223], v[92:95], v[60:63]
    ds_read_b64_tr_b16 v[86:87], v20 offset:31232
    s_waitcnt lgkmcnt(8)
    v_mfma_f32_16x16x32_bf16 v[48:51], v[224:227], v[64:67], v[48:51]
    ds_read_b64_tr_b16 v[88:89], v20 offset:15360
    v_mfma_f32_16x16x32_bf16 v[52:55], v[228:231], v[64:67], v[52:55]
    ds_read_b64_tr_b16 v[90:91], v20 offset:15872
    v_mfma_f32_16x16x32_bf16 v[56:59], v[224:227], v[68:71], v[56:59]
    ds_read_b64_tr_b16 v[92:93], v20 offset:31744
    v_mfma_f32_16x16x32_bf16 v[60:63], v[228:231], v[68:71], v[60:63]
    ds_read_b64_tr_b16 v[94:95], v20 offset:32256
    s_waitcnt lgkmcnt(8)
    v_mfma_f32_16x16x32_bf16 v[48:51], v[232:235], v[72:75], v[48:51]
    v_mfma_f32_16x16x32_bf16 v[52:55], v[236:239], v[72:75], v[52:55]
    v_mfma_f32_16x16x32_bf16 v[56:59], v[232:235], v[76:79], v[56:59]
    v_mfma_f32_16x16x32_bf16 v[60:63], v[236:239], v[76:79], v[60:63]
    s_waitcnt lgkmcnt(4)
    v_mfma_f32_16x16x32_bf16 v[48:51], v[240:243], v[80:83], v[48:51]
    v_mfma_f32_16x16x32_bf16 v[52:55], v[244:247], v[80:83], v[52:55]
    v_mfma_f32_16x16x32_bf16 v[56:59], v[240:243], v[84:87], v[56:59]
    v_mfma_f32_16x16x32_bf16 v[60:63], v[244:247], v[84:87], v[60:63]
    s_waitcnt lgkmcnt(0)
    s_setprio 2
    v_mfma_f32_16x16x32_bf16 v[48:51], v[248:251], v[88:91], v[48:51]
    v_mfma_f32_16x16x32_bf16 v[52:55], v[252:255], v[88:91], v[52:55]
    v_mfma_f32_16x16x32_bf16 v[56:59], v[248:251], v[92:95], v[56:59]
    v_mfma_f32_16x16x32_bf16 v[60:63], v[252:255], v[92:95], v[60:63]
    s_waitcnt vmcnt(0)
    s_atomic_add s32, s[4:5], s41 offset:198272
    v_fma_f32 v8, v101, v108, v112
    v_fma_f32 v9, v101, v109, v113
    v_fma_f32 v10, v101, v110, v114
    v_fma_f32 v11, v101, v111, v115
    v_fmac_f32 v8, v102, v48
    v_fmac_f32 v9, v102, v49
    v_fmac_f32 v10, v102, v50
    v_fmac_f32 v11, v102, v51
    v_exp_f32 v8, v8
    v_fma_f32 v12, v101, v116, v120
    v_exp_f32 v9, v9
    v_fma_f32 v13, v101, v117, v121
    v_exp_f32 v10, v10
    v_fma_f32 v14, v101, v118, v122
    v_exp_f32 v11, v11
    v_fma_f32 v15, v101, v119, v123
    v_add_f32 v8, 1.0, v8
    v_add_f32 v9, 1.0, v9
    v_add_f32 v10, 1.0, v10
    v_add_f32 v11, 1.0, v11
    v_rcp_f32 v8, v8
    v_fmac_f32 v12, v100, v52
    v_rcp_f32 v9, v9
    v_fmac_f32 v13, v100, v53
    v_rcp_f32 v10, v10
    v_fmac_f32 v14, v100, v54
    v_rcp_f32 v11, v11
    v_fmac_f32 v15, v100, v55
    v_mul_f32 v8, v8, v12
    v_mul_f32 v9, v9, v13
    v_mul_f32 v10, v10, v14
    v_mul_f32 v11, v11, v15
    v_cvt_pk_bf16_f32 v96, v8, v9
    v_cvt_pk_bf16_f32 v97, v10, v11
    v_fma_f32 v8, v23, v108, v112
    v_fma_f32 v9, v23, v109, v113
    v_fma_f32 v10, v23, v110, v114
    v_fma_f32 v11, v23, v111, v115
    v_fmac_f32 v8, v24, v56
    v_fmac_f32 v9, v24, v57
    v_fmac_f32 v10, v24, v58
    v_fmac_f32 v11, v24, v59
    v_exp_f32 v8, v8
    v_fma_f32 v12, v23, v116, v120
    v_exp_f32 v9, v9
    v_fma_f32 v13, v23, v117, v121
    v_exp_f32 v10, v10
    v_fma_f32 v14, v23, v118, v122
    v_exp_f32 v11, v11
    v_fma_f32 v15, v23, v119, v123
    v_add_f32 v8, 1.0, v8
    v_add_f32 v9, 1.0, v9
    v_add_f32 v10, 1.0, v10
    v_add_f32 v11, 1.0, v11
    v_rcp_f32 v8, v8
    v_fmac_f32 v12, v22, v60
    v_rcp_f32 v9, v9
    v_fmac_f32 v13, v22, v61
    v_rcp_f32 v10, v10
    v_fmac_f32 v14, v22, v62
    v_rcp_f32 v11, v11
    v_fmac_f32 v15, v22, v63
    v_mul_f32 v8, v8, v12
    v_mul_f32 v9, v9, v13
    v_mul_f32 v10, v10, v14
    v_mul_f32 v11, v11, v15
    v_cvt_pk_bf16_f32 v98, v8, v9
    v_cvt_pk_bf16_f32 v99, v10, v11
    s_nop 0
    v_permlane32_swap_b32 v96, v98
    v_permlane32_swap_b32 v97, v99
    buffer_store_dwordx4 v[96:99], v18, s[4:7], s46 offen sc1
    s_branch G2_S
SPARE:
    s_lshl_b32 s12, s42, 2
    s_and_b32 s13, s43, 3
    s_add_u32 s12, s12, s13
    s_lshl_b32 s25, s12, 10
    s_add_u32 s25, s25, 163840
    s_lshl_b32 s12, s12, 16
    s_lshl_b32 s13, s3, 11
    s_add_u32 s12, s12, s13
    s_add_u32 s12, s12, 3145728
    s_lshl_b32 s14, s3, 13
    s_mov_b32 m0, s14
    v_add_u32 v2, s14, v20
    s_and_b32 s30, s2, 15
    s_lshl_b32 s30, s30, 3
    s_add_u32 s30, s30, s3
    s_mul_i32 s30, s30, 768
    s_lshl_b32 s13, s3, 9
    s_add_u32 s13, s13, 65536
    v_and_b32 v4, 15, v1
    v_lshl_add_u32 v4, v4, 3, s13
    v_add_u32 v5, 65536, v20
    v_and_b32 v3, 3, v1
    v_cmp_eq_u32_e64 s[16:17], 1, v3
    v_cmp_eq_u32_e64 s[18:19], 3, v3
    v_cmp_gt_u32 vcc, 2, v3
    v_mov_b32 v8, 0x3f803f80
    v_mov_b32 v9, 0x3f803f80
    v_mov_b32 v10, 0x3f803f80
    v_mov_b32 v11, 0x3f803f80
    s_waitcnt vmcnt(0)
    s_barrier
    s_cmp_ge_u32 s3, 4
    s_cbranch_scc1 SP_A
    s_atomic_add s32, s[4:5], s28 offset:196608
    s_atomic_add s32, s[4:5], s28 offset:221184
    s_atomic_add s32, s[4:5], s28 offset:245760
    s_atomic_add s32, s[4:5], s28 offset:270336
SP_A:
    s_mov_b32 s15, 0
SP_P:
    s_mov_b64 s[44:45], 0
    s_atomic_add s44, s[4:5], s30 offset:196608 glc
    s_atomic_add s45, s[4:5], s30 offset:196992 glc
    s_add_u32 s15, s15, 1
    s_waitcnt lgkmcnt(0)
    s_min_u32 s44, s44, s45
    s_cmp_gt_u32 s15, 200000
    s_cbranch_scc1 SP_X
    s_cmp_lt_u32 s44, 16
    s_cbranch_scc1 SP_P
SP_X:
    s_mov_b32 s32, 0
    buffer_load_dwordx4 v26, s[4:7], s12 offen sc1 lds
    buffer_load_dwordx4 v26, s[4:7], s12 offen offset:1024 sc1 lds
    s_add_u32 m0, m0, 2048
    s_add_u32 s12, s12, 16384
    buffer_load_dwordx4 v26, s[4:7], s12 offen sc1 lds
    buffer_load_dwordx4 v26, s[4:7], s12 offen offset:1024 sc1 lds
    s_add_u32 m0, m0, 2048
    s_add_u32 s12, s12, 16384
    buffer_load_dwordx4 v26, s[4:7], s12 offen sc1 lds
    buffer_load_dwordx4 v26, s[4:7], s12 offen offset:1024 sc1 lds
    s_add_u32 m0, m0, 2048
    s_add_u32 s12, s12, 16384
    buffer_load_dwordx4 v26, s[4:7], s12 offen sc1 lds
    buffer_load_dwordx4 v26, s[4:7], s12 offen offset:1024 sc1 lds
    s_waitcnt vmcnt(6)
    ds_read_b64_tr_b16 v[128:129], v2 offset:0
    ds_read_b64_tr_b16 v[130:131], v2 offset:512
    ds_read_b64_tr_b16 v[132:133], v2 offset:1024
    ds_read_b64_tr_b16 v[134:135], v2 offset:1536
    s_waitcnt vmcnt(4)
    ds_read_b64_tr_b16 v[136:137], v2 offset:2048
    ds_read_b64_tr_b16 v[138:139], v2 offset:2560
    ds_read_b64_tr_b16 v[140:141], v2 offset:3072
    ds_read_b64_tr_b16 v[142:143], v2 offset:3584
    s_waitcnt vmcnt(2)
    ds_read_b64_tr_b16 v[144:145], v2 offset:4096
    ds_read_b64_tr_b16 v[146:147], v2 offset:4608
    ds_read_b64_tr_b16 v[148:149], v2 offset:5120
    ds_read_b64_tr_b16 v[150:151], v2 offset:5632
    s_waitcnt vmcnt(0)
    ds_read_b64_tr_b16 v[152:153], v2 offset:6144
    ds_read_b64_tr_b16 v[154:155], v2 offset:6656
    ds_read_b64_tr_b16 v[156:157], v2 offset:7168
    ds_read_b64_tr_b16 v[158:159], v2 offset:7680
    s_waitcnt lgkmcnt(14)
    v_mfma_f32_16x16x32_bf16 v[32:35], v[128:131], v[128:131], 0
    v_mfma_f32_16x16x32_bf16 v[36:39], v[8:11], v[128:131], 0
    s_waitcnt lgkmcnt(12)
    v_mfma_f32_16x16x32_bf16 v[32:35], v[132:135], v[132:135], v[32:35]
    v_mfma_f32_16x16x32_bf16 v[36:39], v[8:11], v[132:135], v[36:39]
    s_waitcnt lgkmcnt(10)
    v_mfma_f32_16x16x32_bf16 v[40:43], v[136:139], v[136:139], 0
    v_mfma_f32_16x16x32_bf16 v[44:47], v[8:11], v[136:139], 0
    s_waitcnt lgkmcnt(8)
    v_mfma_f32_16x16x32_bf16 v[40:43], v[140:143], v[140:143], v[40:43]
    v_mfma_f32_16x16x32_bf16 v[44:47], v[8:11], v[140:143], v[44:47]
    s_waitcnt lgkmcnt(6)
    v_mfma_f32_16x16x32_bf16 v[48:51], v[144:147], v[144:147], 0
    v_mfma_f32_16x16x32_bf16 v[52:55], v[8:11], v[144:147], 0
    s_waitcnt lgkmcnt(4)
    v_mfma_f32_16x16x32_bf16 v[48:51], v[148:151], v[148:151], v[48:51]
    v_mfma_f32_16x16x32_bf16 v[52:55], v[8:11], v[148:151], v[52:55]
    s_waitcnt lgkmcnt(2)
    v_mfma_f32_16x16x32_bf16 v[56:59], v[152:155], v[152:155], 0
    v_mfma_f32_16x16x32_bf16 v[60:63], v[8:11], v[152:155], 0
    s_waitcnt lgkmcnt(0)
    v_mfma_f32_16x16x32_bf16 v[56:59], v[156:159], v[156:159], v[56:59]
    v_mfma_f32_16x16x32_bf16 v[60:63], v[8:11], v[156:159], v[60:63]
    v_cndmask_b32_e64 v32, v32, v33, s[16:17]
    v_cndmask_b32_e64 v34, v34, v35, s[18:19]
    v_cndmask_b32 v37, v34, v32, vcc
    v_cndmask_b32_e64 v40, v40, v41, s[16:17]
    v_cndmask_b32_e64 v42, v42, v43, s[18:19]
    v_cndmask_b32 v45, v42, v40, vcc
    v_cndmask_b32_e64 v48, v48, v49, s[16:17]
    v_cndmask_b32_e64 v50, v50, v51, s[18:19]
    v_cndmask_b32 v53, v50, v48, vcc
    v_cndmask_b32_e64 v56, v56, v57, s[16:17]
    v_cndmask_b32_e64 v58, v58, v59, s[18:19]
    v_cndmask_b32 v61, v58, v56, vcc
    s_mov_b32 exec_lo, 0x00f0000f
    s_mov_b32 exec_hi, 0xf0000f00
    ds_write_b64 v4, v[36:37] offset:0
    ds_write_b64 v4, v[44:45] offset:128
    ds_write_b64 v4, v[52:53] offset:256
    ds_write_b64 v4, v[60:61] offset:384
    s_mov_b64 exec, -1
    s_waitcnt lgkmcnt(0)
    s_barrier
    s_cmp_lg_u32 s3, 0
    s_cbranch_scc1 SPARE_J
    ds_read_b64 v[32:33], v5 offset:0
    ds_read_b64 v[34:35], v5 offset:512
    ds_read_b64 v[36:37], v5 offset:1024
    ds_read_b64 v[38:39], v5 offset:1536
    ds_read_b64 v[40:41], v5 offset:2048
    ds_read_b64 v[42:43], v5 offset:2560
    ds_read_b64 v[44:45], v5 offset:3072
    ds_read_b64 v[46:47], v5 offset:3584
    s_waitcnt lgkmcnt(3)
    v_add_f32 v32, v32, v40
    v_add_f32 v33, v33, v41
    s_waitcnt lgkmcnt(2)
    v_add_f32 v34, v34, v42
    v_add_f32 v35, v35, v43
    s_waitcnt lgkmcnt(1)
    v_add_f32 v36, v36, v44
    v_add_f32 v37, v37, v45
    s_waitcnt lgkmcnt(0)
    v_add_f32 v38, v38, v46
    v_add_f32 v39, v39, v47
    v_add_f32 v32, v32, v36
    v_add_f32 v33, v33, v37
    v_add_f32 v34, v34, v38
    v_add_f32 v35, v35, v39
    v_add_f32 v32, v32, v34
    v_add_f32 v33, v33, v35
    v_mul_f32 v32, 0x3b000000, v32
    v_mul_f32 v33, 0x3b000000, v33
    v_fma_f32 v33, -v32, v32, v33
    v_max_f32 v33, 0, v33
    v_cvt_pk_bf16_f32 v33, v33, v33
    v_lshlrev_b32 v33, 16, v33
    v_add_f32 v33, 0x3727c5ac, v33
    v_cvt_pk_bf16_f32 v33, v33, v33
    v_lshlrev_b32 v33, 16, v33
    v_sqrt_f32 v33, v33
    s_nop 0
    v_cvt_pk_bf16_f32 v4, v32, v33
    v_lshlrev_b32 v5, 16, v4
    v_and_b32 v4, 0xffff0000, v4
    v_rcp_f32 v4, v4
    v_mov_b32 v7, s40
    v_mul_f32_e64 v5, -v5, v4
    v_mul_f32 v6, 0xbfb8aa3b, v4
    buffer_store_dwordx4 v[4:7], v26, s[4:7], s25 offen sc1
SPARE_J:
    s_barrier
    s_cmp_lt_u32 s3, 4
    s_cbranch_scc1 SPARE_W
    s_and_b32 s12, s43, 3
    s_lshl_b32 s12, s12, 2
    s_and_b32 s13, s3, 3
    s_add_u32 s12, s12, s13
    s_lshl_b32 s12, s12, 12
    s_and_b32 s13, s42, 1
    s_mul_i32 s13, s13, 917504
    s_add_u32 s13, s12, s13
    s_add_u32 s12, s13, 589824
    buffer_load_dwordx4 v[128:131], v26, s[36:39], s12 offen offset:0
    buffer_load_dwordx4 v[132:135], v26, s[36:39], s12 offen offset:1024
    buffer_load_dwordx4 v[136:139], v26, s[36:39], s12 offen offset:2048
    buffer_load_dwordx4 v[140:143], v26, s[36:39], s12 offen offset:3072
    s_add_u32 s12, s13, 720896
    buffer_load_dwordx4 v[144:147], v26, s[36:39], s12 offen offset:0
    buffer_load_dwordx4 v[148:151], v26, s[36:39], s12 offen offset:1024
    buffer_load_dwordx4 v[152:155], v26, s[36:39], s12 offen offset:2048
    buffer_load_dwordx4 v[156:159], v26, s[36:39], s12 offen offset:3072
    s_add_u32 s12, s13, 851968
    buffer_load_dwordx4 v[160:163], v26, s[36:39], s12 offen offset:0
    buffer_load_dwordx4 v[164:167], v26, s[36:39], s12 offen offset:1024
    buffer_load_dwordx4 v[168:171], v26, s[36:39], s12 offen offset:2048
    buffer_load_dwordx4 v[172:175], v26, s[36:39], s12 offen offset:3072
    s_add_u32 s12, s13, 0
    buffer_load_dwordx4 v[176:179], v26, s[36:39], s12 offen offset:0
    buffer_load_dwordx4 v[180:183], v26, s[36:39], s12 offen offset:1024
    buffer_load_dwordx4 v[184:187], v26, s[36:39], s12 offen offset:2048
    buffer_load_dwordx4 v[188:191], v26, s[36:39], s12 offen offset:3072
    s_add_u32 s12, s13, 131072
    buffer_load_dwordx4 v[128:131], v26, s[36:39], s12 offen offset:0
    buffer_load_dwordx4 v[132:135], v26, s[36:39], s12 offen offset:1024
    buffer_load_dwordx4 v[136:139], v26, s[36:39], s12 offen offset:2048
    buffer_load_dwordx4 v[140:143], v26, s[36:39], s12 offen offset:3072
    s_add_u32 s12, s13, 262144
    buffer_load_dwordx4 v[144:147], v26, s[36:39], s12 offen offset:0
    buffer_load_dwordx4 v[148:151], v26, s[36:39], s12 offen offset:1024
    buffer_load_dwordx4 v[152:155], v26, s[36:39], s12 offen offset:2048
    buffer_load_dwordx4 v[156:159], v26, s[36:39], s12 offen offset:3072
    s_add_u32 s12, s13, 393216
    buffer_load_dwordx4 v[160:163], v26, s[36:39], s12 offen offset:0
    buffer_load_dwordx4 v[164:167], v26, s[36:39], s12 offen offset:1024
    buffer_load_dwordx4 v[168:171], v26, s[36:39], s12 offen offset:2048
    buffer_load_dwordx4 v[172:175], v26, s[36:39], s12 offen offset:3072
    s_add_u32 s12, s13, 524288
    buffer_load_dwordx4 v[176:179], v26, s[36:39], s12 offen offset:0
    buffer_load_dwordx4 v[180:183], v26, s[36:39], s12 offen offset:1024
    buffer_load_dwordx4 v[184:187], v26, s[36:39], s12 offen offset:2048
    buffer_load_dwordx4 v[188:191], v26, s[36:39], s12 offen offset:3072
    s_add_u32 s12, s13, 655360
    buffer_load_dwordx4 v[128:131], v26, s[36:39], s12 offen offset:0
    buffer_load_dwordx4 v[132:135], v26, s[36:39], s12 offen offset:1024
    buffer_load_dwordx4 v[136:139], v26, s[36:39], s12 offen offset:2048
    buffer_load_dwordx4 v[140:143], v26, s[36:39], s12 offen offset:3072
    s_add_u32 s12, s13, 786432
    buffer_load_dwordx4 v[144:147], v26, s[36:39], s12 offen offset:0
    buffer_load_dwordx4 v[148:151], v26, s[36:39], s12 offen offset:1024
    buffer_load_dwordx4 v[152:155], v26, s[36:39], s12 offen offset:2048
    buffer_load_dwordx4 v[156:159], v26, s[36:39], s12 offen offset:3072
SPARE_W:
    s_barrier
    s_cmp_lt_u32 s3, 4
    s_cbranch_scc1 SPARE_S
    s_add_u32 m0, s27, 131072
    s_add_u32 s12, s20, 65536
    buffer_load_dwordx4 v104, s[36:39], s12 offen offset:0 lds
    buffer_load_dwordx4 v105, s[36:39], s12 offen offset:1024 lds
    buffer_load_dwordx4 v106, s[36:39], s12 offen offset:2048 lds
    buffer_load_dwordx4 v107, s[36:39], s12 offen offset:3072 lds
    s_add_u32 m0, s27, 0
    s_add_u32 s12, s20, 327680
    buffer_load_dwordx4 v104, s[36:39], s12 offen offset:0 lds
    buffer_load_dwordx4 v105, s[36:39], s12 offen offset:1024 lds
    buffer_load_dwordx4 v106, s[36:39], s12 offen offset:2048 lds
    buffer_load_dwordx4 v107, s[36:39], s12 offen offset:3072 lds
    s_add_u32 m0, s27, 16384
    s_add_u32 s12, s20, 589824
    buffer_load_dwordx4 v104, s[36:39], s12 offen offset:0 lds
    buffer_load_dwordx4 v105, s[36:39], s12 offen offset:1024 lds
    buffer_load_dwordx4 v106, s[36:39], s12 offen offset:2048 lds
    buffer_load_dwordx4 v107, s[36:39], s12 offen offset:3072 lds
    s_lshl_b32 s12, s47, 2
    s_and_b32 s13, s3, 3
    s_add_u32 s12, s12, s13
    s_lshl_b32 s12, s12, 14
    s_lshl_b32 s14, s35, 11
    s_add_u32 s12, s12, s14
    s_add_u32 s12, s12, 3145728
    s_lshl_b32 s13, s13, 11
    s_add_u32 m0, s13, 147456
    s_nop 0
    buffer_load_dwordx4 v26, s[4:7], s12 offen sc1 lds
    buffer_load_dwordx4 v26, s[4:7], s12 offen offset:1024 sc1 lds
    s_waitcnt vmcnt(0) lgkmcnt(0)
    s_barrier
    s_mov_b32 s33, 0
    s_atomic_add s33, s[4:5], s29 offset:197120 glc
    s_mov_b32 s15, 0
    s_branch P3SC
P3S:
    s_sleep 8
    s_mov_b32 s33, 0
    s_atomic_add s33, s[4:5], s29 offset:197120 glc
P3SC:
    s_add_u32 s15, s15, 1
    s_waitcnt lgkmcnt(0)
    s_cmp_gt_u32 s15, 200000
    s_cbranch_scc1 P3SX
    s_cmp_lt_u32 s33, 14
    s_cbranch_scc1 P3S
P3SX:
    s_add_u32 s30, s0, 2048
    buffer_load_dwordx4 v[128:131], v26, s[4:7], s30 offen sc1
    buffer_load_dwordx4 v[132:135], v16, s[4:7], s30 offen sc1
    s_add_u32 s30, s0, 6144
    buffer_load_dwordx4 v[136:139], v26, s[4:7], s30 offen sc1
    buffer_load_dwordx4 v[140:143], v16, s[4:7], s30 offen sc1
    s_add_u32 s30, s0, 10240
    buffer_load_dwordx4 v[144:147], v26, s[4:7], s30 offen sc1
    buffer_load_dwordx4 v[148:151], v16, s[4:7], s30 offen sc1
    s_add_u32 s30, s0, 14336
    buffer_load_dwordx4 v[152:155], v26, s[4:7], s30 offen sc1
    buffer_load_dwordx4 v[156:159], v16, s[4:7], s30 offen sc1
    s_add_u32 s30, s0, 18432
    buffer_load_dwordx4 v[160:163], v26, s[4:7], s30 offen sc1
    buffer_load_dwordx4 v[164:167], v16, s[4:7], s30 offen sc1
    s_add_u32 s30, s0, 22528
    buffer_load_dwordx4 v[168:171], v26, s[4:7], s30 offen sc1
    buffer_load_dwordx4 v[172:175], v16, s[4:7], s30 offen sc1
    s_add_u32 s30, s0, 26624
    buffer_load_dwordx4 v[176:179], v26, s[4:7], s30 offen sc1
    buffer_load_dwordx4 v[180:183], v16, s[4:7], s30 offen sc1
    s_mov_b32 s33, 0
    s_atomic_add s33, s[4:5], s29 offset:196736 glc
    s_mov_b32 s15, 0
    s_branch P3RC
P3R:
    s_sleep 2
    s_mov_b32 s33, 0
    s_atomic_add s33, s[4:5], s29 offset:196736 glc
P3RC:
    s_add_u32 s15, s15, 1
    s_waitcnt lgkmcnt(0)
    s_cmp_gt_u32 s15, 200000
    s_cbranch_scc1 P3RX
    s_cmp_lt_u32 s33, 14
    s_cbranch_scc1 P3R
P3RX:
    s_waitcnt vmcnt(0)
    s_branch G2_F
SPARE_S:
    s_add_u32 m0, s27, 65536
    s_add_u32 s12, s20, 851968
    s_bfe_u32 s13, s3, 0x10001
    s_mul_i32 s13, s13, -983040
    s_add_u32 s12, s12, s13
    buffer_load_dwordx4 v104, s[36:39], s12 offen offset:0 lds
    buffer_load_dwordx4 v105, s[36:39], s12 offen offset:1024 lds
    buffer_load_dwordx4 v106, s[36:39], s12 offen offset:2048 lds
    buffer_load_dwordx4 v107, s[36:39], s12 offen offset:3072 lds
    s_add_u32 m0, s27, 81920
    s_add_u32 s12, s20, 131072
    buffer_load_dwordx4 v104, s[36:39], s12 offen offset:0 lds
    buffer_load_dwordx4 v105, s[36:39], s12 offen offset:1024 lds
    buffer_load_dwordx4 v106, s[36:39], s12 offen offset:2048 lds
    buffer_load_dwordx4 v107, s[36:39], s12 offen offset:3072 lds
    s_add_u32 m0, s27, 98304
    s_add_u32 s12, s20, 393216
    buffer_load_dwordx4 v104, s[36:39], s12 offen offset:0 lds
    buffer_load_dwordx4 v105, s[36:39], s12 offen offset:1024 lds
    buffer_load_dwordx4 v106, s[36:39], s12 offen offset:2048 lds
    buffer_load_dwordx4 v107, s[36:39], s12 offen offset:3072 lds
    s_add_u32 m0, s27, 114688
    s_add_u32 s12, s20, 655360
    buffer_load_dwordx4 v104, s[36:39], s12 offen offset:0 lds
    buffer_load_dwordx4 v105, s[36:39], s12 offen offset:1024 lds
    buffer_load_dwordx4 v106, s[36:39], s12 offen offset:2048 lds
    buffer_load_dwordx4 v107, s[36:39], s12 offen offset:3072 lds
    s_waitcnt vmcnt(0) lgkmcnt(0)
    s_barrier
    s_branch PG_21
.p2align 12
PG_21:
G2_S:
    s_lshl_b32 s12, s3, 11
    s_add_u32 s12, s12, 147456
    v_lshl_add_u32 v2, v1, 3, s12
    ds_read_b64_tr_b16 v[64:65], v2 offset:0
    ds_read_b64_tr_b16 v[66:67], v2 offset:512
    ds_read_b64_tr_b16 v[68:69], v2 offset:1024
    ds_read_b64_tr_b16 v[70:71], v2 offset:1536
    v_and_b32 v3, 7, v0
    v_and_b32 v4, 15, v1
    v_lshrrev_b32 v5, 5, v1
    v_xor_b32 v5, v5, v3
    v_lshlrev_b32 v5, 4, v5
    v_lshl_add_u32 v5, v4, 7, v5
    v_bfe_u32 v4, v1, 4, 1
    v_lshl_add_u32 v5, v4, 3, v5
    v_add_u32 v4, s12, v5
    v_xor_b32 v5, 32, v4
    v_xor_b32 v6, 64, v4
    v_xor_b32 v7, 96, v4
    s_waitcnt lgkmcnt(0)
    ds_write_b64 v4, v[64:65]
    ds_write_b64 v5, v[66:67]
    ds_write_b64 v6, v[68:69]
    ds_write_b64 v7, v[70:71]
    s_waitcnt lgkmcnt(0)
    v_mov_b32 v4, v125
    v_xor_b32 v5, 32, v125
    v_xor_b32 v6, 64, v125
    v_xor_b32 v7, 96, v125
    v_mov_b32 v12, v126
    v_xor_b32 v13, 64, v126
    v_xor_b32 v14, 128, v126
    v_xor_b32 v15, 192, v126
    s_bitcmp1_b32 s3, 0
    s_cbranch_scc1 LATE1
    s_waitcnt vmcnt(0)
    s_atomic_add s32, s[4:5], s41 offset:199040
    s_mov_b32 s33, 0
    s_atomic_add s33, s[4:5], s29 offset:198272 glc
    s_barrier
    s_mov_b32 s15, 0
    s_branch P3M0C
P3M0:
    s_mov_b32 s33, 0
    s_atomic_add s33, s[4:5], s29 offset:198272 glc
P3M0C:
    s_add_u32 s15, s15, 1
    s_waitcnt lgkmcnt(0)
    s_cmp_gt_u32 s15, 200000
    s_cbranch_scc1 P3M0X
    s_cmp_lt_u32 s33, 16
    s_cbranch_scc1 P3M0
P3M0X:
    s_add_u32 s30, s1, 2048
    buffer_load_dwordx4 v[128:131], v26, s[4:7], s30 offen sc1
    buffer_load_dwordx4 v[132:135], v16, s[4:7], s30 offen sc1
    s_add_u32 s30, s1, 10240
    buffer_load_dwordx4 v[136:139], v26, s[4:7], s30 offen sc1
    buffer_load_dwordx4 v[140:143], v16, s[4:7], s30 offen sc1
    s_add_u32 s30, s1, 18432
    buffer_load_dwordx4 v[144:147], v26, s[4:7], s30 offen sc1
    buffer_load_dwordx4 v[148:151], v16, s[4:7], s30 offen sc1
    s_add_u32 s30, s1, 26624
    buffer_load_dwordx4 v[152:155], v26, s[4:7], s30 offen sc1
    buffer_load_dwordx4 v[156:159], v16, s[4:7], s30 offen sc1
    s_add_u32 s30, s1, 0
    buffer_load_dwordx4 v[160:163], v26, s[4:7], s30 offen sc1
    buffer_load_dwordx4 v[164:167], v16, s[4:7], s30 offen sc1
    s_add_u32 s30, s1, 8192
    buffer_load_dwordx4 v[168:171], v26, s[4:7], s30 offen sc1
    buffer_load_dwordx4 v[172:175], v16, s[4:7], s30 offen sc1
    s_mov_b32 s33, 0
    s_atomic_add s33, s[4:5], s29 offset:199424 glc
    s_add_u32 s30, s1, 16384
    buffer_load_dwordx4 v[176:179], v26, s[4:7], s30 offen sc1
    buffer_load_dwordx4 v[180:183], v16, s[4:7], s30 offen sc1
    s_add_u32 s30, s1, 24576
    buffer_load_dwordx4 v[184:187], v26, s[4:7], s30 offen sc1
    buffer_load_dwordx4 v[188:191], v16, s[4:7], s30 offen sc1
    v_add_u32 v4, 131072, v4
    v_add_u32 v5, 131072, v5
    v_add_u32 v6, 131072, v6
    v_add_u32 v7, 131072, v7
    ds_read_b64_tr_b16 v[64:65], v4 offset:0
    ds_read_b64_tr_b16 v[66:67], v4 offset:1024
    ds_read_b64_tr_b16 v[68:69], v5 offset:0
    ds_read_b64_tr_b16 v[70:71], v5 offset:1024
    ds_read_b64_tr_b16 v[72:73], v6 offset:0
    ds_read_b64_tr_b16 v[74:75], v6 offset:1024
    ds_read_b64_tr_b16 v[76:77], v7 offset:0
    ds_read_b64_tr_b16 v[78:79], v7 offset:1024
    v_add_u32 v4, 4294836224, v4
    v_add_u32 v5, 4294836224, v5
    v_add_u32 v6, 4294836224, v6
    v_add_u32 v7, 4294836224, v7
    ds_read_b64_tr_b16 v[80:81], v4 offset:0
    ds_read_b64_tr_b16 v[82:83], v4 offset:1024
    ds_read_b64_tr_b16 v[84:85], v5 offset:0
    ds_read_b64_tr_b16 v[86:87], v5 offset:1024
    s_mov_b32 s15, 0
    s_branch P3L0C
P3L0:
    s_mov_b32 s33, 0
    s_atomic_add s33, s[4:5], s29 offset:199424 glc
P3L0C:
    s_add_u32 s15, s15, 1
    s_waitcnt lgkmcnt(0)
    s_cmp_gt_u32 s15, 200000
    s_cbranch_scc1 P3L0X
    s_cmp_lt_u32 s33, 12
    s_cbranch_scc1 P3L0
P3L0X:
    s_setprio 0
    s_add_u32 s30, s1, 6144
    buffer_load_dwordx4 v[192:195], v26, s[4:7], s30 offen sc1
    buffer_load_dwordx4 v[196:199], v16, s[4:7], s30 offen sc1
    s_waitcnt vmcnt(16)
    v_mfma_f32_16x16x32_bf16 v[32:35], v[64:67], v[128:131], 0
    ds_read_b64_tr_b16 v[88:89], v6 offset:0
    v_mfma_f32_16x16x32_bf16 v[48:51], v[64:67], v[132:135], 0
    ds_read_b64_tr_b16 v[90:91], v6 offset:1024
    v_mfma_f32_16x16x32_bf16 v[36:39], v[68:71], v[128:131], 0
    ds_read_b64_tr_b16 v[92:93], v7 offset:0
    v_mfma_f32_16x16x32_bf16 v[52:55], v[68:71], v[132:135], 0
    ds_read_b64_tr_b16 v[94:95], v7 offset:1024
    v_mfma_f32_16x16x32_bf16 v[40:43], v[72:75], v[128:131], 0
    ds_read_b64_tr_b16 v[64:65], v4 offset:16384
    v_mfma_f32_16x16x32_bf16 v[56:59], v[72:75], v[132:135], 0
    ds_read_b64_tr_b16 v[66:67], v4 offset:17408
    v_mfma_f32_16x16x32_bf16 v[44:47], v[76:79], v[128:131], 0
    ds_read_b64_tr_b16 v[68:69], v5 offset:16384
    v_mfma_f32_16x16x32_bf16 v[60:63], v[76:79], v[132:135], 0
    ds_read_b64_tr_b16 v[70:71], v5 offset:17408
    s_add_u32 s30, s1, 14336
    buffer_load_dwordx4 v[200:203], v26, s[4:7], s30 offen sc1
    buffer_load_dwordx4 v[204:207], v16, s[4:7], s30 offen sc1
    s_waitcnt vmcnt(16)
    v_mfma_f32_16x16x32_bf16 v[32:35], v[80:83], v[136:139], v[32:35]
    ds_read_b64_tr_b16 v[72:73], v6 offset:16384
    v_mfma_f32_16x16x32_bf16 v[48:51], v[80:83], v[140:143], v[48:51]
    ds_read_b64_tr_b16 v[74:75], v6 offset:17408
    v_mfma_f32_16x16x32_bf16 v[36:39], v[84:87], v[136:139], v[36:39]
    ds_read_b64_tr_b16 v[76:77], v7 offset:16384
    v_mfma_f32_16x16x32_bf16 v[52:55], v[84:87], v[140:143], v[52:55]
    ds_read_b64_tr_b16 v[78:79], v7 offset:17408
    s_waitcnt lgkmcnt(8)
    v_mfma_f32_16x16x32_bf16 v[40:43], v[88:91], v[136:139], v[40:43]
    v_add_u32 v4, 65536, v4
    v_add_u32 v5, 65536, v5
    v_add_u32 v6, 65536, v6
    v_add_u32 v7, 65536, v7
    ds_read_b64_tr_b16 v[80:81], v4 offset:0
    v_mfma_f32_16x16x32_bf16 v[56:59], v[88:91], v[140:143], v[56:59]
    ds_read_b64_tr_b16 v[82:83], v4 offset:1024
    v_mfma_f32_16x16x32_bf16 v[44:47], v[92:95], v[136:139], v[44:47]
    ds_read_b64_tr_b16 v[84:85], v5 offset:0
    v_mfma_f32_16x16x32_bf16 v[60:63], v[92:95], v[140:143], v[60:63]
    ds_read_b64_tr_b16 v[86:87], v5 offset:1024
    s_add_u32 s30, s1, 22528
    buffer_load_dwordx4 v[208:211], v26, s[4:7], s30 offen sc1
    buffer_load_dwordx4 v[212:215], v16, s[4:7], s30 offen sc1
    s_waitcnt vmcnt(16) lgkmcnt(8)
    v_mfma_f32_16x16x32_bf16 v[32:35], v[64:67], v[144:147], v[32:35]
    ds_read_b64_tr_b16 v[88:89], v6 offset:0
    v_mfma_f32_16x16x32_bf16 v[48:51], v[64:67], v[148:151], v[48:51]
    ds_read_b64_tr_b16 v[90:91], v6 offset:1024
    v_mfma_f32_16x16x32_bf16 v[36:39], v[68:71], v[144:147], v[36:39]
    ds_read_b64_tr_b16 v[92:93], v7 offset:0
    v_mfma_f32_16x16x32_bf16 v[52:55], v[68:71], v[148:151], v[52:55]
    ds_read_b64_tr_b16 v[94:95], v7 offset:1024
    s_waitcnt lgkmcnt(8)
    v_mfma_f32_16x16x32_bf16 v[40:43], v[72:75], v[144:147], v[40:43]
    ds_read_b64_tr_b16 v[64:65], v4 offset:8192
    v_mfma_f32_16x16x32_bf16 v[56:59], v[72:75], v[148:151], v[56:59]
    ds_read_b64_tr_b16 v[66:67], v4 offset:9216
    v_mfma_f32_16x16x32_bf16 v[44:47], v[76:79], v[144:147], v[44:47]
    ds_read_b64_tr_b16 v[68:69], v5 offset:8192
    v_mfma_f32_16x16x32_bf16 v[60:63], v[76:79], v[148:151], v[60:63]
    ds_read_b64_tr_b16 v[70:71], v5 offset:9216
    s_add_u32 s30, s1, 4096
    buffer_load_dwordx4 v[216:219], v26, s[4:7], s30 offen sc1
    buffer_load_dwordx4 v[220:223], v16, s[4:7], s30 offen sc1
    s_waitcnt vmcnt(16) lgkmcnt(8)
    v_mfma_f32_16x16x32_bf16 v[32:35], v[80:83], v[152:155], v[32:35]
    ds_read_b64_tr_b16 v[72:73], v6 offset:8192
    v_mfma_f32_16x16x32_bf16 v[48:51], v[80:83], v[156:159], v[48:51]
    ds_read_b64_tr_b16 v[74:75], v6 offset:9216
    v_mfma_f32_16x16x32_bf16 v[36:39], v[84:87], v[152:155], v[36:39]
    ds_read_b64_tr_b16 v[76:77], v7 offset:8192
    v_mfma_f32_16x16x32_bf16 v[52:55], v[84:87], v[156:159], v[52:55]
    ds_read_b64_tr_b16 v[78:79], v7 offset:9216
    s_waitcnt lgkmcnt(8)
    v_mfma_f32_16x16x32_bf16 v[40:43], v[88:91], v[152:155], v[40:43]
    ds_read_b64_tr_b16 v[80:81], v4 offset:24576
    v_mfma_f32_16x16x32_bf16 v[56:59], v[88:91], v[156:159], v[56:59]
    ds_read_b64_tr_b16 v[82:83], v4 offset:25600
    v_mfma_f32_16x16x32_bf16 v[44:47], v[92:95], v[152:155], v[44:47]
    ds_read_b64_tr_b16 v[84:85], v5 offset:24576
    v_mfma_f32_16x16x32_bf16 v[60:63], v[92:95], v[156:159], v[60:63]
    ds_read_b64_tr_b16 v[86:87], v5 offset:25600
    s_add_u32 s30, s1, 12288
    buffer_load_dwordx4 v[224:227], v26, s[4:7], s30 offen sc1
    buffer_load_dwordx4 v[228:231], v16, s[4:7], s30 offen sc1
    s_waitcnt vmcnt(16) lgkmcnt(8)
    v_mfma_f32_16x16x32_bf16 v[32:35], v[64:67], v[160:163], v[32:35]
    ds_read_b64_tr_b16 v[88:89], v6 offset:24576
    v_mfma_f32_16x16x32_bf16 v[48:51], v[64:67], v[164:167], v[48:51]
    ds_read_b64_tr_b16 v[90:91], v6 offset:25600
    v_mfma_f32_16x16x32_bf16 v[36:39], v[68:71], v[160:163], v[36:39]
    ds_read_b64_tr_b16 v[92:93], v7 offset:24576
    v_mfma_f32_16x16x32_bf16 v[52:55], v[68:71], v[164:167], v[52:55]
    ds_read_b64_tr_b16 v[94:95], v7 offset:25600
    s_waitcnt lgkmcnt(8)
    v_mfma_f32_16x16x32_bf16 v[40:43], v[72:75], v[160:163], v[40:43]
    ds_read_b64_tr_b16 v[64:65], v4 offset:40960
    v_mfma_f32_16x16x32_bf16 v[56:59], v[72:75], v[164:167], v[56:59]
    ds_read_b64_tr_b16 v[66:67], v4 offset:41984
    v_mfma_f32_16x16x32_bf16 v[44:47], v[76:79], v[160:163], v[44:47]
    ds_read_b64_tr_b16 v[68:69], v5 offset:40960
    v_mfma_f32_16x16x32_bf16 v[60:63], v[76:79], v[164:167], v[60:63]
    ds_read_b64_tr_b16 v[70:71], v5 offset:41984
    s_add_u32 s30, s1, 20480
    buffer_load_dwordx4 v[232:235], v26, s[4:7], s30 offen sc1
    buffer_load_dwordx4 v[236:239], v16, s[4:7], s30 offen sc1
    s_waitcnt vmcnt(16) lgkmcnt(8)
    v_mfma_f32_16x16x32_bf16 v[32:35], v[80:83], v[168:171], v[32:35]
    ds_read_b64_tr_b16 v[72:73], v6 offset:40960
    v_mfma_f32_16x16x32_bf16 v[48:51], v[80:83], v[172:175], v[48:51]
    ds_read_b64_tr_b16 v[74:75], v6 offset:41984
    v_mfma_f32_16x16x32_bf16 v[36:39], v[84:87], v[168:171], v[36:39]
    ds_read_b64_tr_b16 v[76:77], v7 offset:40960
    v_mfma_f32_16x16x32_bf16 v[52:55], v[84:87], v[172:175], v[52:55]
    ds_read_b64_tr_b16 v[78:79], v7 offset:41984
    s_waitcnt lgkmcnt(8)
    v_mfma_f32_16x16x32_bf16 v[40:43], v[88:91], v[168:171], v[40:43]
    ds_read_b64_tr_b16 v[80:81], v4 offset:57344
    v_mfma_f32_16x16x32_bf16 v[56:59], v[88:91], v[172:175], v[56:59]
    ds_read_b64_tr_b16 v[82:83], v4 offset:58368
    v_mfma_f32_16x16x32_bf16 v[44:47], v[92:95], v[168:171], v[44:47]
    ds_read_b64_tr_b16 v[84:85], v5 offset:57344
    v_mfma_f32_16x16x32_bf16 v[60:63], v[92:95], v[172:175], v[60:63]
    ds_read_b64_tr_b16 v[86:87], v5 offset:58368
    s_waitcnt vmcnt(14) lgkmcnt(8)
    v_mfma_f32_16x16x32_bf16 v[32:35], v[64:67], v[176:179], v[32:35]
    ds_read_b64_tr_b16 v[88:89], v6 offset:57344
    v_mfma_f32_16x16x32_bf16 v[48:51], v[64:67], v[180:183], v[48:51]
    ds_read_b64_tr_b16 v[90:91], v6 offset:58368
    v_mfma_f32_16x16x32_bf16 v[36:39], v[68:71], v[176:179], v[36:39]
    ds_read_b64_tr_b16 v[92:93], v7 offset:57344
    v_mfma_f32_16x16x32_bf16 v[52:55], v[68:71], v[180:183], v[52:55]
    ds_read_b64_tr_b16 v[94:95], v7 offset:58368
    s_waitcnt lgkmcnt(8)
    v_mfma_f32_16x16x32_bf16 v[40:43], v[72:75], v[176:179], v[40:43]
    v_add_u32 v4, 65536, v4
    v_add_u32 v5, 65536, v5
    v_add_u32 v6, 65536, v6
    v_add_u32 v7, 65536, v7
    ds_read_b64_tr_b16 v[64:65], v4 offset:8192
    v_mfma_f32_16x16x32_bf16 v[56:59], v[72:75], v[180:183], v[56:59]
    ds_read_b64_tr_b16 v[66:67], v4 offset:9216
    v_mfma_f32_16x16x32_bf16 v[44:47], v[76:79], v[176:179], v[44:47]
    ds_read_b64_tr_b16 v[68:69], v5 offset:8192
    v_mfma_f32_16x16x32_bf16 v[60:63], v[76:79], v[180:183], v[60:63]
    ds_read_b64_tr_b16 v[70:71], v5 offset:9216
    v_mov_b32 v2, 161792
    v_mov_b32 v3, 1
    s_mov_b64 exec, 1
    ds_add_u32 v2, v3 offset:4
    s_mov_b64 exec, -1
    s_waitcnt vmcnt(12) lgkmcnt(9)
    v_mfma_f32_16x16x32_bf16 v[32:35], v[80:83], v[184:187], v[32:35]
    ds_read_b64_tr_b16 v[72:73], v6 offset:8192
    v_mfma_f32_16x16x32_bf16 v[48:51], v[80:83], v[188:191], v[48:51]
    ds_read_b64_tr_b16 v[74:75], v6 offset:9216
    v_mfma_f32_16x16x32_bf16 v[36:39], v[84:87], v[184:187], v[36:39]
    ds_read_b64_tr_b16 v[76:77], v7 offset:8192
    v_mfma_f32_16x16x32_bf16 v[52:55], v[84:87], v[188:191], v[52:55]
    ds_read_b64_tr_b16 v[78:79], v7 offset:9216
    s_waitcnt lgkmcnt(9)
    v_mfma_f32_16x16x32_bf16 v[40:43], v[88:91], v[184:187], v[40:43]
    v_add_u32 v4, 4294836224, v4
    v_add_u32 v5, 4294836224, v5
    v_add_u32 v6, 4294836224, v6
    v_add_u32 v7, 4294836224, v7
    ds_read_b64_tr_b16 v[80:81], v4 offset:8192
    v_mfma_f32_16x16x32_bf16 v[56:59], v[88:91], v[188:191], v[56:59]
    ds_read_b64_tr_b16 v[82:83], v4 offset:9216
    v_mfma_f32_16x16x32_bf16 v[44:47], v[92:95], v[184:187], v[44:47]
    ds_read_b64_tr_b16 v[84:85], v5 offset:8192
    v_mfma_f32_16x16x32_bf16 v[60:63], v[92:95], v[188:191], v[60:63]
    ds_read_b64_tr_b16 v[86:87], v5 offset:9216
    s_waitcnt vmcnt(10) lgkmcnt(9)
    v_mfma_f32_16x16x32_bf16 v[32:35], v[64:67], v[192:195], v[32:35]
    ds_read_b64_tr_b16 v[88:89], v6 offset:8192
    v_mfma_f32_16x16x32_bf16 v[48:51], v[64:67], v[196:199], v[48:51]
    ds_read_b64_tr_b16 v[90:91], v6 offset:9216
    v_mfma_f32_16x16x32_bf16 v[36:39], v[68:71], v[192:195], v[36:39]
    ds_read_b64_tr_b16 v[92:93], v7 offset:8192
    v_mfma_f32_16x16x32_bf16 v[52:55], v[68:71], v[196:199], v[52:55]
    ds_read_b64_tr_b16 v[94:95], v7 offset:9216
    s_waitcnt lgkmcnt(8)
    v_mfma_f32_16x16x32_bf16 v[40:43], v[72:75], v[192:195], v[40:43]
    ds_read_b64_tr_b16 v[64:65], v4 offset:24576
    v_mfma_f32_16x16x32_bf16 v[56:59], v[72:75], v[196:199], v[56:59]
    ds_read_b64_tr_b16 v[66:67], v4 offset:25600
    v_mfma_f32_16x16x32_bf16 v[44:47], v[76:79], v[192:195], v[44:47]
    ds_read_b64_tr_b16 v[68:69], v5 offset:24576
    v_mfma_f32_16x16x32_bf16 v[60:63], v[76:79], v[196:199], v[60:63]
    ds_read_b64_tr_b16 v[70:71], v5 offset:25600
    ds_read_b32 v8, v2 offset:8
    s_waitcnt vmcnt(8) lgkmcnt(9)
    v_mfma_f32_16x16x32_bf16 v[32:35], v[80:83], v[200:203], v[32:35]
    ds_read_b64_tr_b16 v[72:73], v6 offset:24576
    v_mfma_f32_16x16x32_bf16 v[48:51], v[80:83], v[204:207], v[48:51]
    ds_read_b64_tr_b16 v[74:75], v6 offset:25600
    v_mfma_f32_16x16x32_bf16 v[36:39], v[84:87], v[200:203], v[36:39]
    ds_read_b64_tr_b16 v[76:77], v7 offset:24576
    v_mfma_f32_16x16x32_bf16 v[52:55], v[84:87], v[204:207], v[52:55]
    ds_read_b64_tr_b16 v[78:79], v7 offset:25600
    s_waitcnt lgkmcnt(9)
    v_mfma_f32_16x16x32_bf16 v[40:43], v[88:91], v[200:203], v[40:43]
    v_add_u32 v4, 65536, v4
    v_add_u32 v5, 65536, v5
    v_add_u32 v6, 65536, v6
    v_add_u32 v7, 65536, v7
    ds_read_b64_tr_b16 v[80:81], v4 offset:16384
    v_mfma_f32_16x16x32_bf16 v[56:59], v[88:91], v[204:207], v[56:59]
    ds_read_b64_tr_b16 v[82:83], v4 offset:17408
    v_mfma_f32_16x16x32_bf16 v[44:47], v[92:95], v[200:203], v[44:47]
    ds_read_b64_tr_b16 v[84:85], v4 offset:32768
    v_mfma_f32_16x16x32_bf16 v[60:63], v[92:95], v[204:207], v[60:63]
    ds_read_b64_tr_b16 v[86:87], v4 offset:33792
    s_waitcnt vmcnt(6) lgkmcnt(9)
    v_mfma_f32_16x16x32_bf16 v[32:35], v[64:67], v[208:211], v[32:35]
    ds_read_b64_tr_b16 v[88:89], v4 offset:49152
    v_mfma_f32_16x16x32_bf16 v[48:51], v[64:67], v[212:215], v[48:51]
    ds_read_b64_tr_b16 v[90:91], v4 offset:50176
    v_mfma_f32_16x16x32_bf16 v[36:39], v[68:71], v[208:211], v[36:39]
    ds_read_b64_tr_b16 v[92:93], v5 offset:16384
    v_mfma_f32_16x16x32_bf16 v[52:55], v[68:71], v[212:215], v[52:55]
    ds_read_b64_tr_b16 v[94:95], v5 offset:17408
    s_waitcnt lgkmcnt(8)
    v_mfma_f32_16x16x32_bf16 v[40:43], v[72:75], v[208:211], v[40:43]
    ds_read_b64_tr_b16 v[64:65], v5 offset:32768
    v_mfma_f32_16x16x32_bf16 v[56:59], v[72:75], v[212:215], v[56:59]
    ds_read_b64_tr_b16 v[66:67], v5 offset:33792
    v_mfma_f32_16x16x32_bf16 v[44:47], v[76:79], v[208:211], v[44:47]
    ds_read_b64_tr_b16 v[68:69], v5 offset:49152
    v_mfma_f32_16x16x32_bf16 v[60:63], v[76:79], v[212:215], v[60:63]
    ds_read_b64_tr_b16 v[70:71], v5 offset:50176
    v_cmp_gt_u32 vcc, 4, v8
    s_cbranch_vccz QW0X
    v_mov_b32 v2, 161792
    s_mov_b32 s15, 0
    s_branch QW0C
QW0:
    s_sleep 1
QW0C:
    ds_read_b32 v3, v2 offset:8
    s_add_u32 s15, s15, 1
    s_waitcnt lgkmcnt(0)
    v_cmp_gt_u32 vcc, 4, v3
    s_cmp_gt_u32 s15, 200000
    s_cbranch_scc1 QW0X
    s_cbranch_vccnz QW0
QW0X:
    s_waitcnt vmcnt(2) lgkmcnt(8)
    v_mfma_f32_16x16x32_bf16 v[32:35], v[80:83], v[216:219], v[32:35]
    ds_read_b64_tr_b16 v[72:73], v6 offset:16384
    v_mfma_f32_16x16x32_bf16 v[48:51], v[80:83], v[220:223], v[48:51]
    ds_read_b64_tr_b16 v[74:75], v6 offset:17408
    v_mfma_f32_16x16x32_bf16 v[32:35], v[84:87], v[224:227], v[32:35]
    ds_read_b64_tr_b16 v[76:77], v6 offset:32768
    v_mfma_f32_16x16x32_bf16 v[48:51], v[84:87], v[228:231], v[48:51]
    ds_read_b64_tr_b16 v[78:79], v6 offset:33792
    s_waitcnt vmcnt(0) lgkmcnt(8)
    v_mfma_f32_16x16x32_bf16 v[32:35], v[88:91], v[232:235], v[32:35]
    ds_read_b64_tr_b16 v[80:81], v6 offset:49152
    v_mfma_f32_16x16x32_bf16 v[48:51], v[88:91], v[236:239], v[48:51]
    ds_read_b64_tr_b16 v[82:83], v6 offset:50176
    v_mfma_f32_16x16x32_bf16 v[36:39], v[92:95], v[216:219], v[36:39]
    ds_read_b64_tr_b16 v[84:85], v7 offset:16384
    v_mfma_f32_16x16x32_bf16 v[52:55], v[92:95], v[220:223], v[52:55]
    ds_read_b64_tr_b16 v[86:87], v7 offset:17408
    s_waitcnt lgkmcnt(8)
    v_mfma_f32_16x16x32_bf16 v[36:39], v[64:67], v[224:227], v[36:39]
    ds_read_b64_tr_b16 v[88:89], v7 offset:32768
    v_mfma_f32_16x16x32_bf16 v[52:55], v[64:67], v[228:231], v[52:55]
    ds_read_b64_tr_b16 v[90:91], v7 offset:33792
    ds_write_b128 v12, v[32:35] offset:32768
    v_mfma_f32_16x16x32_bf16 v[36:39], v[68:71], v[232:235], v[36:39]
    ds_read_b64_tr_b16 v[92:93], v7 offset:49152
    ds_write_b128 v12, v[48:51] offset:36864
    v_mfma_f32_16x16x32_bf16 v[52:55], v[68:71], v[236:239], v[52:55]
    ds_read_b64_tr_b16 v[94:95], v7 offset:50176
    s_waitcnt lgkmcnt(10)
    v_mfma_f32_16x16x32_bf16 v[40:43], v[72:75], v[216:219], v[40:43]
    v_mfma_f32_16x16x32_bf16 v[56:59], v[72:75], v[220:223], v[56:59]
    v_mfma_f32_16x16x32_bf16 v[40:43], v[76:79], v[224:227], v[40:43]
    v_mfma_f32_16x16x32_bf16 v[56:59], v[76:79], v[228:231], v[56:59]
    ds_write_b128 v13, v[36:39] offset:32768
    s_waitcnt lgkmcnt(7)
    v_mfma_f32_16x16x32_bf16 v[40:43], v[80:83], v[232:235], v[40:43]
    ds_write_b128 v13, v[52:55] offset:36864
    v_mfma_f32_16x16x32_bf16 v[56:59], v[80:83], v[236:239], v[56:59]
    v_mfma_f32_16x16x32_bf16 v[44:47], v[84:87], v[216:219], v[44:47]
    v_mfma_f32_16x16x32_bf16 v[60:63], v[84:87], v[220:223], v[60:63]
    s_waitcnt lgkmcnt(2)
    v_mfma_f32_16x16x32_bf16 v[44:47], v[88:91], v[224:227], v[44:47]
    v_mfma_f32_16x16x32_bf16 v[60:63], v[88:91], v[228:231], v[60:63]
    s_nop 0
    ds_write_b128 v14, v[40:43] offset:32768
    v_mfma_f32_16x16x32_bf16 v[44:47], v[92:95], v[232:235], v[44:47]
    ds_write_b128 v14, v[56:59] offset:36864
    v_mfma_f32_16x16x32_bf16 v[60:63], v[92:95], v[236:239], v[60:63]
    s_nop 5
    ds_write_b128 v15, v[44:47] offset:32768
    s_nop 0
    ds_write_b128 v15, v[60:63] offset:36864
    s_setprio 2
    s_waitcnt lgkmcnt(0)
    s_branch LATEJ
.p2align 12
LATE1:
    s_waitcnt vmcnt(0)
    s_atomic_add s32, s[4:5], s41 offset:199040
    s_mov_b32 s33, 0
    s_atomic_add s33, s[4:5], s29 offset:197888 glc
    s_barrier
    s_mov_b32 s15, 0
    s_branch P3M1C
P3M1:
    s_mov_b32 s33, 0
    s_atomic_add s33, s[4:5], s29 offset:197888 glc
P3M1C:
    s_add_u32 s15, s15, 1
    s_waitcnt lgkmcnt(0)
    s_cmp_gt_u32 s15, 200000
    s_cbranch_scc1 P3M1X
    s_cmp_lt_u32 s33, 12
    s_cbranch_scc1 P3M1
P3M1X:
    s_add_u32 s30, s1, 6144
    buffer_load_dwordx4 v[128:131], v26, s[4:7], s30 offen sc1
    buffer_load_dwordx4 v[132:135], v16, s[4:7], s30 offen sc1
    s_add_u32 s30, s1, 14336
    buffer_load_dwordx4 v[136:139], v26, s[4:7], s30 offen sc1
    buffer_load_dwordx4 v[140:143], v16, s[4:7], s30 offen sc1
    s_add_u32 s30, s1, 22528
    buffer_load_dwordx4 v[144:147], v26, s[4:7], s30 offen sc1
    buffer_load_dwordx4 v[148:151], v16, s[4:7], s30 offen sc1
    s_add_u32 s30, s1, 4096
    buffer_load_dwordx4 v[152:155], v26, s[4:7], s30 offen sc1
    buffer_load_dwordx4 v[156:159], v16, s[4:7], s30 offen sc1
    s_mov_b32 s33, 0
    s_atomic_add s33, s[4:5], s29 offset:198272 glc
    s_add_u32 s30, s1, 12288
    buffer_load_dwordx4 v[160:163], v26, s[4:7], s30 offen sc1
    buffer_load_dwordx4 v[164:167], v16, s[4:7], s30 offen sc1
    s_add_u32 s30, s1, 20480
    buffer_load_dwordx4 v[168:171], v26, s[4:7], s30 offen sc1
    buffer_load_dwordx4 v[172:175], v16, s[4:7], s30 offen sc1
    v_add_u32 v4, 131072, v4
    v_add_u32 v5, 131072, v5
    v_add_u32 v6, 131072, v6
    v_add_u32 v7, 131072, v7
    ds_read_b64_tr_b16 v[64:65], v4 offset:8192
    ds_read_b64_tr_b16 v[66:67], v4 offset:9216
    ds_read_b64_tr_b16 v[68:69], v5 offset:8192
    ds_read_b64_tr_b16 v[70:71], v5 offset:9216
    ds_read_b64_tr_b16 v[72:73], v6 offset:8192
    ds_read_b64_tr_b16 v[74:75], v6 offset:9216
    ds_read_b64_tr_b16 v[76:77], v7 offset:8192
    ds_read_b64_tr_b16 v[78:79], v7 offset:9216
    v_add_u32 v4, 4294836224, v4
    v_add_u32 v5, 4294836224, v5
    v_add_u32 v6, 4294836224, v6
    v_add_u32 v7, 4294836224, v7
    ds_read_b64_tr_b16 v[80:81], v4 offset:8192
    ds_read_b64_tr_b16 v[82:83], v4 offset:9216
    ds_read_b64_tr_b16 v[84:85], v5 offset:8192
    ds_read_b64_tr_b16 v[86:87], v5 offset:9216
    s_mov_b32 s15, 0
    s_branch P3L1C
P3L1:
    s_mov_b32 s33, 0
    s_atomic_add s33, s[4:5], s29 offset:198272 glc
P3L1C:
    s_add_u32 s15, s15, 1
    s_waitcnt lgkmcnt(0)
    s_cmp_gt_u32 s15, 200000
    s_cbranch_scc1 P3L1X
    s_cmp_lt_u32 s33, 16
    s_cbranch_scc1 P3L1
P3L1X:
    s_setprio 0
    s_add_u32 s30, s1, 2048
    buffer_load_dwordx4 v[176:179], v26, s[4:7], s30 offen sc1
    buffer_load_dwordx4 v[180:183], v16, s[4:7], s30 offen sc1
    s_waitcnt vmcnt(12)
    v_mfma_f32_16x16x32_bf16 v[32:35], v[64:67], v[128:131], 0
    ds_read_b64_tr_b16 v[88:89], v6 offset:8192
    v_mfma_f32_16x16x32_bf16 v[48:51], v[64:67], v[132:135], 0
    ds_read_b64_tr_b16 v[90:91], v6 offset:9216
    v_mfma_f32_16x16x32_bf16 v[36:39], v[68:71], v[128:131], 0
    ds_read_b64_tr_b16 v[92:93], v7 offset:8192
    v_mfma_f32_16x16x32_bf16 v[52:55], v[68:71], v[132:135], 0
    ds_read_b64_tr_b16 v[94:95], v7 offset:9216
    v_mfma_f32_16x16x32_bf16 v[40:43], v[72:75], v[128:131], 0
    ds_read_b64_tr_b16 v[64:65], v4 offset:24576
    v_mfma_f32_16x16x32_bf16 v[56:59], v[72:75], v[132:135], 0
    ds_read_b64_tr_b16 v[66:67], v4 offset:25600
    v_mfma_f32_16x16x32_bf16 v[44:47], v[76:79], v[128:131], 0
    ds_read_b64_tr_b16 v[68:69], v5 offset:24576
    v_mfma_f32_16x16x32_bf16 v[60:63], v[76:79], v[132:135], 0
    ds_read_b64_tr_b16 v[70:71], v5 offset:25600
    s_add_u32 s30, s1, 10240
    buffer_load_dwordx4 v[184:187], v26, s[4:7], s30 offen sc1
    buffer_load_dwordx4 v[188:191], v16, s[4:7], s30 offen sc1
    s_waitcnt vmcnt(12)
    v_mfma_f32_16x16x32_bf16 v[32:35], v[80:83], v[136:139], v[32:35]
    ds_read_b64_tr_b16 v[72:73], v6 offset:24576
    v_mfma_f32_16x16x32_bf16 v[48:51], v[80:83], v[140:143], v[48:51]
    ds_read_b64_tr_b16 v[74:75], v6 offset:25600
    v_mfma_f32_16x16x32_bf16 v[36:39], v[84:87], v[136:139], v[36:39]
    ds_read_b64_tr_b16 v[76:77], v7 offset:24576
    v_mfma_f32_16x16x32_bf16 v[52:55], v[84:87], v[140:143], v[52:55]
    ds_read_b64_tr_b16 v[78:79], v7 offset:25600
    s_waitcnt lgkmcnt(8)
    v_mfma_f32_16x16x32_bf16 v[40:43], v[88:91], v[136:139], v[40:43]
    v_add_u32 v4, 65536, v4
    v_add_u32 v5, 65536, v5
    v_add_u32 v6, 65536, v6
    v_add_u32 v7, 65536, v7
    ds_read_b64_tr_b16 v[80:81], v4 offset:16384
    v_mfma_f32_16x16x32_bf16 v[56:59], v[88:91], v[140:143], v[56:59]
    ds_read_b64_tr_b16 v[82:83], v4 offset:17408
    v_mfma_f32_16x16x32_bf16 v[44:47], v[92:95], v[136:139], v[44:47]
    ds_read_b64_tr_b16 v[84:85], v5 offset:16384
    v_mfma_f32_16x16x32_bf16 v[60:63], v[92:95], v[140:143], v[60:63]
    ds_read_b64_tr_b16 v[86:87], v5 offset:17408
    s_add_u32 s30, s1, 18432
    buffer_load_dwordx4 v[192:195], v26, s[4:7], s30 offen sc1
    buffer_load_dwordx4 v[196:199], v16, s[4:7], s30 offen sc1
    s_waitcnt vmcnt(12) lgkmcnt(8)
    v_mfma_f32_16x16x32_bf16 v[32:35], v[64:67], v[144:147], v[32:35]
    ds_read_b64_tr_b16 v[88:89], v6 offset:16384
    v_mfma_f32_16x16x32_bf16 v[48:51], v[64:67], v[148:151], v[48:51]
    ds_read_b64_tr_b16 v[90:91], v6 offset:17408
    v_mfma_f32_16x16x32_bf16 v[36:39], v[68:71], v[144:147], v[36:39]
    ds_read_b64_tr_b16 v[92:93], v7 offset:16384
    v_mfma_f32_16x16x32_bf16 v[52:55], v[68:71], v[148:151], v[52:55]
    ds_read_b64_tr_b16 v[94:95], v7 offset:17408
    s_waitcnt lgkmcnt(8)
    v_mfma_f32_16x16x32_bf16 v[40:43], v[72:75], v[144:147], v[40:43]
    ds_read_b64_tr_b16 v[64:65], v4 offset:32768
    v_mfma_f32_16x16x32_bf16 v[56:59], v[72:75], v[148:151], v[56:59]
    ds_read_b64_tr_b16 v[66:67], v4 offset:33792
    v_mfma_f32_16x16x32_bf16 v[44:47], v[76:79], v[144:147], v[44:47]
    ds_read_b64_tr_b16 v[68:69], v5 offset:32768
    v_mfma_f32_16x16x32_bf16 v[60:63], v[76:79], v[148:151], v[60:63]
    ds_read_b64_tr_b16 v[70:71], v5 offset:33792
    s_add_u32 s30, s1, 26624
    buffer_load_dwordx4 v[200:203], v26, s[4:7], s30 offen sc1
    buffer_load_dwordx4 v[204:207], v16, s[4:7], s30 offen sc1
    s_waitcnt vmcnt(12) lgkmcnt(8)
    v_mfma_f32_16x16x32_bf16 v[32:35], v[80:83], v[152:155], v[32:35]
    ds_read_b64_tr_b16 v[72:73], v6 offset:32768
    v_mfma_f32_16x16x32_bf16 v[48:51], v[80:83], v[156:159], v[48:51]
    ds_read_b64_tr_b16 v[74:75], v6 offset:33792
    v_mfma_f32_16x16x32_bf16 v[36:39], v[84:87], v[152:155], v[36:39]
    ds_read_b64_tr_b16 v[76:77], v7 offset:32768
    v_mfma_f32_16x16x32_bf16 v[52:55], v[84:87], v[156:159], v[52:55]
    ds_read_b64_tr_b16 v[78:79], v7 offset:33792
    s_waitcnt lgkmcnt(8)
    v_mfma_f32_16x16x32_bf16 v[40:43], v[88:91], v[152:155], v[40:43]
    ds_read_b64_tr_b16 v[80:81], v4 offset:49152
    v_mfma_f32_16x16x32_bf16 v[56:59], v[88:91], v[156:159], v[56:59]
    ds_read_b64_tr_b16 v[82:83], v4 offset:50176
    v_mfma_f32_16x16x32_bf16 v[44:47], v[92:95], v[152:155], v[44:47]
    ds_read_b64_tr_b16 v[84:85], v5 offset:49152
    v_mfma_f32_16x16x32_bf16 v[60:63], v[92:95], v[156:159], v[60:63]
    ds_read_b64_tr_b16 v[86:87], v5 offset:50176
    s_add_u32 s30, s1, 0
    buffer_load_dwordx4 v[208:211], v26, s[4:7], s30 offen sc1
    buffer_load_dwordx4 v[212:215], v16, s[4:7], s30 offen sc1
    s_waitcnt vmcnt(12) lgkmcnt(8)
    v_mfma_f32_16x16x32_bf16 v[32:35], v[64:67], v[160:163], v[32:35]
    ds_read_b64_tr_b16 v[88:89], v6 offset:49152
    v_mfma_f32_16x16x32_bf16 v[48:51], v[64:67], v[164:167], v[48:51]
    ds_read_b64_tr_b16 v[90:91], v6 offset:50176
    v_mfma_f32_16x16x32_bf16 v[36:39], v[68:71], v[160:163], v[36:39]
    ds_read_b64_tr_b16 v[92:93], v7 offset:49152
    v_mfma_f32_16x16x32_bf16 v[52:55], v[68:71], v[164:167], v[52:55]
    ds_read_b64_tr_b16 v[94:95], v7 offset:50176
    s_waitcnt lgkmcnt(8)
    v_mfma_f32_16x16x32_bf16 v[40:43], v[72:75], v[160:163], v[40:43]
    v_add_u32 v4, 65536, v4
    v_add_u32 v5, 65536, v5
    v_add_u32 v6, 65536, v6
    v_add_u32 v7, 65536, v7
    ds_read_b64_tr_b16 v[64:65], v4 offset:0
    v_mfma_f32_16x16x32_bf16 v[56:59], v[72:75], v[164:167], v[56:59]
    ds_read_b64_tr_b16 v[66:67], v4 offset:1024
    v_mfma_f32_16x16x32_bf16 v[44:47], v[76:79], v[160:163], v[44:47]
    ds_read_b64_tr_b16 v[68:69], v5 offset:0
    v_mfma_f32_16x16x32_bf16 v[60:63], v[76:79], v[164:167], v[60:63]
    ds_read_b64_tr_b16 v[70:71], v5 offset:1024
    s_add_u32 s30, s1, 8192
    buffer_load_dwordx4 v[216:219], v26, s[4:7], s30 offen sc1
    buffer_load_dwordx4 v[220:223], v16, s[4:7], s30 offen sc1
    s_waitcnt vmcnt(12) lgkmcnt(8)
    v_mfma_f32_16x16x32_bf16 v[32:35], v[80:83], v[168:171], v[32:35]
    ds_read_b64_tr_b16 v[72:73], v6 offset:0
    v_mfma_f32_16x16x32_bf16 v[48:51], v[80:83], v[172:175], v[48:51]
    ds_read_b64_tr_b16 v[74:75], v6 offset:1024
    v_mfma_f32_16x16x32_bf16 v[36:39], v[84:87], v[168:171], v[36:39]
    ds_read_b64_tr_b16 v[76:77], v7 offset:0
    v_mfma_f32_16x16x32_bf16 v[52:55], v[84:87], v[172:175], v[52:55]
    ds_read_b64_tr_b16 v[78:79], v7 offset:1024
    s_waitcnt lgkmcnt(8)
    v_mfma_f32_16x16x32_bf16 v[40:43], v[88:91], v[168:171], v[40:43]
    v_add_u32 v4, 4294836224, v4
    v_add_u32 v5, 4294836224, v5
    v_add_u32 v6, 4294836224, v6
    v_add_u32 v7, 4294836224, v7
    ds_read_b64_tr_b16 v[80:81], v4 offset:0
    v_mfma_f32_16x16x32_bf16 v[56:59], v[88:91], v[172:175], v[56:59]
    ds_read_b64_tr_b16 v[82:83], v4 offset:1024
    v_mfma_f32_16x16x32_bf16 v[44:47], v[92:95], v[168:171], v[44:47]
    ds_read_b64_tr_b16 v[84:85], v5 offset:0
    v_mfma_f32_16x16x32_bf16 v[60:63], v[92:95], v[172:175], v[60:63]
    ds_read_b64_tr_b16 v[86:87], v5 offset:1024
    s_add_u32 s30, s1, 16384
    buffer_load_dwordx4 v[224:227], v26, s[4:7], s30 offen sc1
    buffer_load_dwordx4 v[228:231], v16, s[4:7], s30 offen sc1
    s_waitcnt vmcnt(12) lgkmcnt(8)
    v_mfma_f32_16x16x32_bf16 v[32:35], v[64:67], v[176:179], v[32:35]
    ds_read_b64_tr_b16 v[88:89], v6 offset:0
    v_mfma_f32_16x16x32_bf16 v[48:51], v[64:67], v[180:183], v[48:51]
    ds_read_b64_tr_b16 v[90:91], v6 offset:1024
    v_mfma_f32_16x16x32_bf16 v[36:39], v[68:71], v[176:179], v[36:39]
    ds_read_b64_tr_b16 v[92:93], v7 offset:0
    v_mfma_f32_16x16x32_bf16 v[52:55], v[68:71], v[180:183], v[52:55]
    ds_read_b64_tr_b16 v[94:95], v7 offset:1024
    s_waitcnt lgkmcnt(8)
    v_mfma_f32_16x16x32_bf16 v[40:43], v[72:75], v[176:179], v[40:43]
    ds_read_b64_tr_b16 v[64:65], v4 offset:16384
    v_mfma_f32_16x16x32_bf16 v[56:59], v[72:75], v[180:183], v[56:59]
    ds_read_b64_tr_b16 v[66:67], v4 offset:17408
    v_mfma_f32_16x16x32_bf16 v[44:47], v[76:79], v[176:179], v[44:47]
    ds_read_b64_tr_b16 v[68:69], v5 offset:16384
    v_mfma_f32_16x16x32_bf16 v[60:63], v[76:79], v[180:183], v[60:63]
    ds_read_b64_tr_b16 v[70:71], v5 offset:17408
    s_add_u32 s30, s1, 24576
    buffer_load_dwordx4 v[232:235], v26, s[4:7], s30 offen sc1
    buffer_load_dwordx4 v[236:239], v16, s[4:7], s30 offen sc1
    v_mov_b32 v2, 161792
    v_mov_b32 v3, 1
    s_mov_b64 exec, 1
    ds_add_u32 v2, v3 offset:4
    s_mov_b64 exec, -1
    s_waitcnt vmcnt(12) lgkmcnt(9)
    v_mfma_f32_16x16x32_bf16 v[32:35], v[80:83], v[184:187], v[32:35]
    ds_read_b64_tr_b16 v[72:73], v6 offset:16384
    v_mfma_f32_16x16x32_bf16 v[48:51], v[80:83], v[188:191], v[48:51]
    ds_read_b64_tr_b16 v[74:75], v6 offset:17408
    v_mfma_f32_16x16x32_bf16 v[36:39], v[84:87], v[184:187], v[36:39]
    ds_read_b64_tr_b16 v[76:77], v7 offset:16384
    v_mfma_f32_16x16x32_bf16 v[52:55], v[84:87], v[188:191], v[52:55]
    ds_read_b64_tr_b16 v[78:79], v7 offset:17408
    s_waitcnt lgkmcnt(9)
    v_mfma_f32_16x16x32_bf16 v[40:43], v[88:91], v[184:187], v[40:43]
    v_add_u32 v4, 65536, v4
    v_add_u32 v5, 65536, v5
    v_add_u32 v6, 65536, v6
    v_add_u32 v7, 65536, v7
    ds_read_b64_tr_b16 v[80:81], v4 offset:0
    v_mfma_f32_16x16x32_bf16 v[56:59], v[88:91], v[188:191], v[56:59]
    ds_read_b64_tr_b16 v[82:83], v4 offset:1024
    v_mfma_f32_16x16x32_bf16 v[44:47], v[92:95], v[184:187], v[44:47]
    ds_read_b64_tr_b16 v[84:85], v5 offset:0
    v_mfma_f32_16x16x32_bf16 v[60:63], v[92:95], v[188:191], v[60:63]
    ds_read_b64_tr_b16 v[86:87], v5 offset:1024
    s_waitcnt vmcnt(10) lgkmcnt(9)
    v_mfma_f32_16x16x32_bf16 v[32:35], v[64:67], v[192:195], v[32:35]
    ds_read_b64_tr_b16 v[88:89], v6 offset:0
    v_mfma_f32_16x16x32_bf16 v[48:51], v[64:67], v[196:199], v[48:51]
    ds_read_b64_tr_b16 v[90:91], v6 offset:1024
    v_mfma_f32_16x16x32_bf16 v[36:39], v[68:71], v[192:195], v[36:39]
    ds_read_b64_tr_b16 v[92:93], v7 offset:0
    v_mfma_f32_16x16x32_bf16 v[52:55], v[68:71], v[196:199], v[52:55]
    ds_read_b64_tr_b16 v[94:95], v7 offset:1024
    s_waitcnt lgkmcnt(8)
    v_mfma_f32_16x16x32_bf16 v[40:43], v[72:75], v[192:195], v[40:43]
    ds_read_b64_tr_b16 v[64:65], v4 offset:8192
    v_mfma_f32_16x16x32_bf16 v[56:59], v[72:75], v[196:199], v[56:59]
    ds_read_b64_tr_b16 v[66:67], v4 offset:9216
    v_mfma_f32_16x16x32_bf16 v[44:47], v[76:79], v[192:195], v[44:47]
    ds_read_b64_tr_b16 v[68:69], v5 offset:8192
    v_mfma_f32_16x16x32_bf16 v[60:63], v[76:79], v[196:199], v[60:63]
    ds_read_b64_tr_b16 v[70:71], v5 offset:9216
    ds_read_b32 v8, v2 offset:8
    s_waitcnt vmcnt(8) lgkmcnt(9)
    v_mfma_f32_16x16x32_bf16 v[32:35], v[80:83], v[200:203], v[32:35]
    ds_read_b64_tr_b16 v[72:73], v6 offset:8192
    v_mfma_f32_16x16x32_bf16 v[48:51], v[80:83], v[204:207], v[48:51]
    ds_read_b64_tr_b16 v[74:75], v6 offset:9216
    v_mfma_f32_16x16x32_bf16 v[36:39], v[84:87], v[200:203], v[36:39]
    ds_read_b64_tr_b16 v[76:77], v7 offset:8192
    v_mfma_f32_16x16x32_bf16 v[52:55], v[84:87], v[204:207], v[52:55]
    ds_read_b64_tr_b16 v[78:79], v7 offset:9216
    s_waitcnt lgkmcnt(9)
    v_mfma_f32_16x16x32_bf16 v[40:43], v[88:91], v[200:203], v[40:43]
    ds_read_b64_tr_b16 v[80:81], v4 offset:24576
    v_mfma_f32_16x16x32_bf16 v[56:59], v[88:91], v[204:207], v[56:59]
    ds_read_b64_tr_b16 v[82:83], v4 offset:25600
    v_mfma_f32_16x16x32_bf16 v[44:47], v[92:95], v[200:203], v[44:47]
    ds_read_b64_tr_b16 v[84:85], v4 offset:40960
    v_mfma_f32_16x16x32_bf16 v[60:63], v[92:95], v[204:207], v[60:63]
    ds_read_b64_tr_b16 v[86:87], v4 offset:41984
    s_waitcnt vmcnt(6) lgkmcnt(9)
    v_mfma_f32_16x16x32_bf16 v[32:35], v[64:67], v[208:211], v[32:35]
    ds_read_b64_tr_b16 v[88:89], v4 offset:57344
    v_mfma_f32_16x16x32_bf16 v[48:51], v[64:67], v[212:215], v[48:51]
    ds_read_b64_tr_b16 v[90:91], v4 offset:58368
    v_mfma_f32_16x16x32_bf16 v[36:39], v[68:71], v[208:211], v[36:39]
    ds_read_b64_tr_b16 v[92:93], v5 offset:24576
    v_mfma_f32_16x16x32_bf16 v[52:55], v[68:71], v[212:215], v[52:55]
    ds_read_b64_tr_b16 v[94:95], v5 offset:25600
    s_waitcnt lgkmcnt(8)
    v_mfma_f32_16x16x32_bf16 v[40:43], v[72:75], v[208:211], v[40:43]
    ds_read_b64_tr_b16 v[64:65], v5 offset:40960
    v_mfma_f32_16x16x32_bf16 v[56:59], v[72:75], v[212:215], v[56:59]
    ds_read_b64_tr_b16 v[66:67], v5 offset:41984
    v_mfma_f32_16x16x32_bf16 v[44:47], v[76:79], v[208:211], v[44:47]
    ds_read_b64_tr_b16 v[68:69], v5 offset:57344
    v_mfma_f32_16x16x32_bf16 v[60:63], v[76:79], v[212:215], v[60:63]
    ds_read_b64_tr_b16 v[70:71], v5 offset:58368
    v_cmp_gt_u32 vcc, 4, v8
    s_cbranch_vccz QW1X
    v_mov_b32 v2, 161792
    s_mov_b32 s15, 0
    s_branch QW1C
QW1:
    s_sleep 1
QW1C:
    ds_read_b32 v3, v2 offset:8
    s_add_u32 s15, s15, 1
    s_waitcnt lgkmcnt(0)
    v_cmp_gt_u32 vcc, 4, v3
    s_cmp_gt_u32 s15, 200000
    s_cbranch_scc1 QW1X
    s_cbranch_vccnz QW1
QW1X:
    s_waitcnt vmcnt(2) lgkmcnt(8)
    v_mfma_f32_16x16x32_bf16 v[32:35], v[80:83], v[216:219], v[32:35]
    ds_read_b64_tr_b16 v[72:73], v6 offset:24576
    v_mfma_f32_16x16x32_bf16 v[48:51], v[80:83], v[220:223], v[48:51]
    ds_read_b64_tr_b16 v[74:75], v6 offset:25600
    v_mfma_f32_16x16x32_bf16 v[32:35], v[84:87], v[224:227], v[32:35]
    ds_read_b64_tr_b16 v[76:77], v6 offset:40960
    v_mfma_f32_16x16x32_bf16 v[48:51], v[84:87], v[228:231], v[48:51]
    ds_read_b64_tr_b16 v[78:79], v6 offset:41984
    s_waitcnt vmcnt(0) lgkmcnt(8)
    v_mfma_f32_16x16x32_bf16 v[32:35], v[88:91], v[232:235], v[32:35]
    ds_read_b64_tr_b16 v[80:81], v6 offset:57344
    v_mfma_f32_16x16x32_bf16 v[48:51], v[88:91], v[236:239], v[48:51]
    ds_read_b64_tr_b16 v[82:83], v6 offset:58368
    v_mfma_f32_16x16x32_bf16 v[36:39], v[92:95], v[216:219], v[36:39]
    ds_read_b64_tr_b16 v[84:85], v7 offset:24576
    v_mfma_f32_16x16x32_bf16 v[52:55], v[92:95], v[220:223], v[52:55]
    ds_read_b64_tr_b16 v[86:87], v7 offset:25600
    s_waitcnt lgkmcnt(8)
    v_mfma_f32_16x16x32_bf16 v[36:39], v[64:67], v[224:227], v[36:39]
    ds_read_b64_tr_b16 v[88:89], v7 offset:40960
    v_mfma_f32_16x16x32_bf16 v[52:55], v[64:67], v[228:231], v[52:55]
    ds_read_b64_tr_b16 v[90:91], v7 offset:41984
    ds_write_b128 v12, v[32:35] offset:32768
    v_mfma_f32_16x16x32_bf16 v[36:39], v[68:71], v[232:235], v[36:39]
    ds_read_b64_tr_b16 v[92:93], v7 offset:57344
    ds_write_b128 v12, v[48:51] offset:36864
    v_mfma_f32_16x16x32_bf16 v[52:55], v[68:71], v[236:239], v[52:55]
    ds_read_b64_tr_b16 v[94:95], v7 offset:58368
    s_waitcnt lgkmcnt(10)
    v_mfma_f32_16x16x32_bf16 v[40:43], v[72:75], v[216:219], v[40:43]
    v_mfma_f32_16x16x32_bf16 v[56:59], v[72:75], v[220:223], v[56:59]
    v_mfma_f32_16x16x32_bf16 v[40:43], v[76:79], v[224:227], v[40:43]
    v_mfma_f32_16x16x32_bf16 v[56:59], v[76:79], v[228:231], v[56:59]
    ds_write_b128 v13, v[36:39] offset:32768
    s_waitcnt lgkmcnt(7)
    v_mfma_f32_16x16x32_bf16 v[40:43], v[80:83], v[232:235], v[40:43]
    ds_write_b128 v13, v[52:55] offset:36864
    v_mfma_f32_16x16x32_bf16 v[56:59], v[80:83], v[236:239], v[56:59]
    v_mfma_f32_16x16x32_bf16 v[44:47], v[84:87], v[216:219], v[44:47]
    v_mfma_f32_16x16x32_bf16 v[60:63], v[84:87], v[220:223], v[60:63]
    s_waitcnt lgkmcnt(2)
    v_mfma_f32_16x16x32_bf16 v[44:47], v[88:91], v[224:227], v[44:47]
    v_mfma_f32_16x16x32_bf16 v[60:63], v[88:91], v[228:231], v[60:63]
    s_nop 0
    ds_write_b128 v14, v[40:43] offset:32768
    v_mfma_f32_16x16x32_bf16 v[44:47], v[92:95], v[232:235], v[44:47]
    ds_write_b128 v14, v[56:59] offset:36864
    v_mfma_f32_16x16x32_bf16 v[60:63], v[92:95], v[236:239], v[60:63]
    s_nop 5
    ds_write_b128 v15, v[44:47] offset:32768
    s_nop 0
    ds_write_b128 v15, v[60:63] offset:36864
    s_setprio 2
    s_waitcnt lgkmcnt(0)
LATEJ:
    s_barrier
FIN:
END:
    s_endpgm
.section .rodata,"a"
.p2align 6
.amdhsa_kernel adaLN_cond__ssm_conv_s4d__glu_gated_glu__prompt_kernel
  .amdhsa_next_free_vgpr 256
  .amdhsa_next_free_sgpr 102
  .amdhsa_accum_offset 256
  .amdhsa_group_segment_fixed_size 0
  .amdhsa_kernarg_size 128
  .amdhsa_user_sgpr_count 2
  .amdhsa_user_sgpr_kernarg_segment_ptr 1
  .amdhsa_system_sgpr_workgroup_id_x 1
  .amdhsa_float_denorm_mode_32 3
.end_amdhsa_kernel
```
